```python
import torch

def _softmax(x, axis=-1):
    return torch.softmax(x, dim=axis)
def _gelu(x):
    return torch.nn.functional.gelu(x, approximate="tanh")
def _silu(x):
    return torch.nn.functional.silu(x)
def _sigmoid(x):
    return torch.sigmoid(x)
def _layernorm(x, axis=-1, eps=1e-5):
    m = x.mean(dim=axis, keepdim=True)
    v = x.var(dim=axis, keepdim=True, unbiased=False)
    return (x - m) / torch.sqrt(v + eps)
def _scatter_add(tgt, idx, src, axis=0):
    return tgt.clone().index_add_(axis, idx, src)
def _segment_sum(src, seg, n):
    out = torch.zeros((n,) + src.shape[1:], dtype=src.dtype)
    return out.index_add_(0, seg, src)
def _pad(x, pw):
    flat = tuple(v for pair in reversed(pw) for v in pair)
    return torch.nn.functional.pad(x, flat)

kernel_name = 'gated_mix__sliding_local_dilated__dense_activation_relu__prompt'

def setup_inputs():

    _w = (lambda a: (lambda t: t.to(torch.bfloat16) if t.is_floating_point() else t)(torch.as_tensor(a)))
    def _A_setup():
        B, S, D = 1, 2048, 640
        return {
            "x": _w((lambda *s: torch.randn(*s, dtype=torch.bfloat16) * 0.05)(B, S, D)),
            "wqkv": _w((lambda *s: torch.randn(*s, dtype=torch.bfloat16) * 0.8)(D, 3 * D)),
            "wo": _w((lambda *s: torch.randn(*s, dtype=torch.bfloat16) * 0.05)(D, D)),
        }
    _A_in = _A_setup()

    def _B_setup():
        B, S, D, Dff = 1, 2048, 640, 1728
        return {
            "x": _w((lambda *s: torch.randn(*s, dtype=torch.bfloat16) * 0.05)(B, S, D)),
            "w1": _w((lambda *s: torch.randn(*s, dtype=torch.bfloat16) * 0.1)(D, Dff)),
            "w2": _w((lambda *s: torch.randn(*s, dtype=torch.bfloat16) * 0.1)(Dff, D)),
        }
    _B_in = _B_setup()

    return {
        "A_x": _A_in["x"],
        "A_wqkv": _A_in["wqkv"],
        "A_wo": _A_in["wo"],
        "B_x": _B_in["x"],
        "B_w1": _B_in["w1"],
        "B_w2": _B_in["w2"],
        "gate_w": _w((lambda *s: torch.randn(*s, dtype=torch.bfloat16) * 0.05)(640) * 16.0),
    }

def reference(A_x, A_wqkv, A_wo, B_x, B_w1, B_w2, gate_w):
    def _A_ref(x, wqkv, wo):
        B, S, D = x.shape
        H = 32; Dh = D // H
        W, dil = 8, 2
        qkv = (lambda x, *d: x.permute(*d))((x @ wqkv).reshape(B, S, 3, H, Dh), 2, 0, 3, 1, 4)
        q, k, v = qkv[0], qkv[1], qkv[2]
        scale = Dh ** -0.5
        pos = torch.arange(S)
        off = torch.arange(W) * dil
        idx = pos[:, None] - off[None, :]
        mask = idx >= 0
        idx_c = torch.where(mask, idx, 0).reshape(-1)
        kg = k[:, :, idx_c, :].reshape(B, H, S, W, Dh)
        vg = v[:, :, idx_c, :].reshape(B, H, S, W, Dh)
        logits = torch.einsum("bhsd,bhswd->bhsw", q, kg) * scale
        logits = torch.where(mask[None, None, :, :], logits, -1e9)
        attn = _softmax(logits, axis=-1)
        o = torch.einsum("bhsw,bhswd->bhsd", attn, vg)
        return (lambda x, *d: x.permute(*d))(o, 0, 2, 1, 3).reshape(B, S, D) @ wo

    def _B_ref(x, w1, w2):
        h = torch.einsum("bsd,df->bsf", x, w1)
        zero = torch.zeros_like(h)
        h = torch.maximum(h, zero)
        return torch.einsum("bsf,fd->bsd", h, w2)

    x = A_x
    g = _sigmoid((x * gate_w).sum(-1, keepdims=True))
    a = _A_ref(x, A_wqkv, A_wo)
    b = _B_ref(x, B_w1, B_w2)
    return g * a + (1 - g) * b
```

```asm
; @launch grid=(256,1,1) block=(256,1,1) lds=159488
.amdgcn_target "amdgcn-amd-amdhsa--gfx950"
.text
.globl gated_mix__sliding_local_dilated__dense_activation_relu__prompt_kernel
.p2align 8
.type gated_mix__sliding_local_dilated__dense_activation_relu__prompt_kernel,@function
gated_mix__sliding_local_dilated__dense_activation_relu__prompt_kernel:
    s_cmp_ge_u32 s2, 256
    s_cbranch_scc1 L_done
    s_load_dwordx2 s[8:9], s[0:1], 0
    s_load_dwordx2 s[44:45], s[0:1], 32
    s_load_dwordx2 s[12:13], s[0:1], 8
    s_getpc_b64 s[6:7]
    v_min_u32 v24, 15, v0
    v_lshlrev_b32 v24, 7, v24
    global_load_dword v23, v24, s[6:7]
    s_lshr_b32 s51, s2, 3
    s_lshl_b32 s3, s51, 11
    v_add_u32 v25, s3, v24
    global_load_dword v23, v25, s[6:7]
    s_load_dwordx2 s[16:17], s[0:1], 72
    s_load_dwordx2 s[20:21], s[0:1], 40
    s_load_dwordx2 s[24:25], s[0:1], 16
    s_load_dwordx2 s[28:29], s[0:1], 56
    s_load_dwordx2 s[40:41], s[0:1], 64
    s_load_dwordx2 s[32:33], s[0:1], 48
    v_lshrrev_b32 v2, 6, v0
    v_and_b32 v1, 63, v0
    s_and_b32 s60, s2, 7
    v_readfirstlane_b32 s48, v2
    s_mov_b32 s10, 2621440
    s_mov_b32 s11, 0x20000
    s_cmp_lt_u32 s51, 12
    s_cbranch_scc1 L_A
    s_cmp_ge_u32 s51, 30
    s_cbranch_scc1 L_P
    s_and_b32 s61, s2, 3
    s_mul_i32 s61, s61, 18
    s_and_b32 s49, s2, 4
    s_add_u32 s61, s61, s51
    s_lshl_b32 s49, s49, 1
    s_sub_u32 s61, s61, 12
    s_lshr_b32 s50, s61, 3
    s_and_b32 s61, s61, 7
    s_add_u32 s49, s49, s61
    v_lshrrev_b32 v24, 3, v1
    s_lshl_b32 s60, s49, 2
    v_and_b32 v26, 7, v1
    s_add_u32 s60, s60, s48
    v_lshrrev_b32 v27, 4, v1
    s_mul_i32 s60, s60, 40960
    v_mul_u32_u24 v25, 1280, v24
    s_lshl_b32 s53, s48, 12
    v_xor_b32 v28, v26, v27
    s_add_u32 s53, s53, 101376
    v_add_u32 v25, s60, v25
    v_xor_b32 v29, 4, v28
    v_lshl_add_u32 v6, v28, 4, v25
    v_lshl_add_u32 v7, v29, 4, v25
    v_add_u32 v8, 18432, v6
    v_add_u32 v7, 9216, v7
    v_add_u32 v9, 18432, v7
    s_add_u32 m0, s53, 0
    s_mov_b32 s55, 0
    s_waitcnt lgkmcnt(0)
    buffer_load_dwordx4 v6, s[8:11], s55 offen offset:0  lds
    buffer_load_dwordx4 v7, s[8:11], s55 offen offset:1024  lds
    buffer_load_dwordx4 v8, s[8:11], s55 offen offset:2048  lds
    buffer_load_dwordx4 v9, s[8:11], s55 offen offset:3072  lds
    s_mov_b32 s46, 2211840
    s_mov_b32 s47, 0x20000
    v_lshrrev_b32 v24, 5, v1
    s_mul_i32 s60, s48, 27648
    v_and_b32 v25, 31, v1
    s_mul_i32 s61, s50, 384
    v_mul_u32_u24 v24, 13824, v24
    s_add_u32 s60, s60, s61
    v_lshl_add_u32 v26, v25, 4, v24
    v_mov_b32 v27, 2146435072
    v_add_u32 v26, s60, v26
    v_cmp_gt_u32 vcc, 24, v25
    s_mul_i32 s66, s48, 4224
    s_add_u32 s52, s66, 16896
    v_cndmask_b32 v2, v27, v26, vcc
    v_add_u32 v3, 2400, v2
    v_add_u32 v4, 4800, v2
    v_add_u32 v5, 7200, v2
    s_add_u32 m0, s52, 0
    s_mov_b32 s54, 0
    buffer_load_dwordx4 v2, s[44:47], s54 offen offset:0  lds
    buffer_load_dwordx4 v3, s[44:47], s54 offen offset:1056  lds
    buffer_load_dwordx4 v4, s[44:47], s54 offen offset:2112  lds
    buffer_load_dwordx4 v5, s[44:47], s54 offen offset:3168  lds
    s_mov_b32 s18, 268435456
    s_mov_b32 s19, 0x20000
    s_mov_b32 s42, 256
    s_mov_b32 s43, 0x20000
    s_mov_b32 s22, 2211840
    s_mov_b32 s23, 0x20000
    s_mov_b32 s26, 819200
    s_mov_b32 s27, 0x20000
    s_mov_b32 s30, 2621440
    s_mov_b32 s31, 0x20000
    s_mov_b32 s38, 7077888
    s_mov_b32 s39, 0x20000
    s_mov_b32 s36, s16
    s_mov_b32 s37, s17
    s_mul_i32 s60, s49, 9
    s_add_u32 s60, s60, s50
    s_lshl_b32 s60, s60, 5
    s_add_u32 s60, s60, s48
    s_lshl_b32 s60, s60, 2
    s_add_u32 s60, s60, 9977856
    v_mov_b32 v251, 2146435072
    v_mov_b32 v252, 0
    v_writelane_b32 v251, s60, 0
    buffer_store_dword v252, v251, s[16:19], 0 offen sc1
    s_lshr_b32 s60, s48, 1
    s_lshl_b32 s60, s60, 13
    s_add_u32 s60, s60, 101376
    s_and_b32 s61, s48, 1
    s_mul_i32 s61, s61, 192
    s_add_u32 s61, s61, 16896
    v_and_b32 v24, 15, v1
    v_lshrrev_b32 v25, 4, v1
    v_lshrrev_b32 v26, 1, v24
    v_xor_b32 v26, v26, v25
    v_lshlrev_b32 v26, 4, v26
    v_lshl_add_u32 v26, v24, 7, v26
    v_xor_b32 v27, 64, v26
    v_add_u32 v12, s60, v26
    v_add_u32 v13, s60, v27
    v_lshrrev_b32 v28, 2, v1
    v_mul_u32_u24 v28, 1056, v28
    v_and_b32 v29, 3, v1
    v_lshl_add_u32 v17, v29, 3, v28
    v_add_u32 v17, s61, v17
    v_add_u32 v18, 50688, v17
    s_sub_u32 s60, s51, 12
    s_mul_i32 s61, s60, 43
    s_lshr_b32 s61, s61, 7
    s_mul_i32 s62, s61, 3
    s_sub_u32 s57, s60, s62
    s_and_b32 s60, s2, 7
    s_mul_i32 s60, s60, 6
    s_add_u32 s60, s60, s61
    s_lshl_b32 s60, s60, 2
    s_add_u32 s60, s60, s48
    s_mul_i32 s61, s57, 192
    s_add_u32 s60, s60, s61
    s_mul_i32 s60, s60, 5376
    v_min_u32 v92, 41, v1
    v_lshl_add_u32 v92, v92, 7, s60
    v_subrev_u32 v93, 2211840, v92
    s_mul_i32 s60, s50, 786432
    s_lshl_b32 s61, s49, 13
    s_add_u32 s60, s60, s61
    s_lshr_b32 s61, s48, 1
    s_lshl_b32 s61, s61, 12
    s_add_u32 s60, s60, s61
    s_and_b32 s61, s48, 1
    s_mul_i32 s61, s61, 393216
    s_add_u32 s91, s60, s61
    s_add_u32 s92, s91, 131072
    s_add_u32 s93, s91, 262144
    v_lshlrev_b32 v28, 4, v1
    s_sub_u32 s61, s51, 12
    s_mul_i32 s62, s61, 13
    s_lshr_b32 s62, s62, 6
    s_mul_i32 s63, s62, 5
    s_sub_u32 s65, s61, s63
    s_bitcmp1_b32 s2, 0
    s_cselect_b32 s63, 5, 0
    s_add_u32 s65, s65, s63
    s_bfe_u32 s60, s2, 0x20001
    s_lshl_b32 s60, s60, 2
    s_add_u32 s60, s60, s62
    s_lshl_b32 s64, s60, 3
    s_lshl_b32 s60, s65, 7
    v_lshrrev_b32 v24, 3, v1
    v_and_b32 v25, 7, v1
    v_lshrrev_b32 v26, 4, v1
    v_lshlrev_b32 v27, 1, v26
    v_xor_b32 v25, v25, v27
    v_lshl_add_u32 v25, v25, 4, s60
    v_mul_u32_u24 v27, 1280, v24
    v_add_u32 v240, v27, v25
    v_add_u32 v241, 9216, v240
    v_add_u32 v242, 18432, v240
    v_add_u32 v243, 27648, v240
    v_lshrrev_b32 v27, 2, v24
    v_mul_u32_u24 v27, 20480, v27
    v_add_u32 v244, v27, v240
    v_lshrrev_b32 v24, 2, v1
    v_lshrrev_b32 v25, 1, v24
    v_and_b32 v25, 3, v25
    v_and_b32 v26, 3, v1
    v_lshlrev_b32 v26, 3, v26
    v_lshl_add_u32 v26, v24, 7, v26
    v_add_u32 v26, s66, v26
    v_xor_b32 v27, 0, v25
    v_lshl_add_u32 v245, v27, 5, v26
    v_xor_b32 v27, 1, v25
    v_lshl_add_u32 v246, v27, 5, v26
    v_xor_b32 v27, 2, v25
    v_lshl_add_u32 v247, v27, 5, v26
    v_xor_b32 v27, 3, v25
    v_lshl_add_u32 v248, v27, 5, v26
    s_and_b32 s60, s51, 1
    s_lshl_b32 s61, s48, 1
    s_add_u32 s61, s61, s60
    s_mul_i32 s67, s61, 286720
    s_mul_i32 s68, s61, 917504
    s_mul_i32 s88, s60, -573440
    s_add_u32 s88, s88, 40960
    s_mul_i32 s89, s60, -1835008
    s_add_u32 s89, s89, 131072
    s_mul_i32 s69, s48, 204800
    s_mul_i32 s70, s48, 655360
    s_add_u32 s70, s70, 7077888
    s_add_u32 s71, s70, 131072
    s_add_u32 s72, s70, 262144
    s_add_u32 s73, s70, 393216
    s_add_u32 s74, s70, 524288
    s_lshr_b32 s60, s64, 3
    s_mul_i32 s60, s60, 1152
    s_add_u32 s60, s60, 9977856
    v_lshrrev_b32 v24, 2, v1
    v_min_u32 v24, 8, v24
    v_and_b32 v25, 3, v1
    v_lshlrev_b32 v25, 2, v25
    v_lshl_add_u32 v24, v24, 7, v25
    v_add_u32 v249, s60, v24
    s_mul_i32 s60, s64, 187
    s_lshr_b32 s60, s60, 11
    s_add_u32 s61, s64, 7
    s_mul_i32 s61, s61, 187
    s_lshr_b32 s61, s61, 11
    s_sub_u32 s61, s61, s60
    v_bfe_u32 v24, v1, 3, 1
    v_mul_u32_u24 v24, s61, v24
    v_add_u32 v24, s60, v24
    v_bfe_u32 v26, v1, 2, 1
    v_lshl_add_u32 v24, v24, 3, v26
    s_lshl_b32 s60, s48, 8
    s_add_u32 s60, s60, 9961472
    v_add_u32 v25, s60, v25
    v_lshl_add_u32 v250, v24, 7, v25
    v_and_b32 v26, 15, v1
    v_lshlrev_b32 v26, 4, v26
    s_add_u32 m0, s52, 16896
    s_add_u32 s54, s54, 110592
    buffer_load_dwordx4 v2, s[44:47], s54 offen offset:0  lds
    buffer_load_dwordx4 v3, s[44:47], s54 offen offset:1056  lds
    buffer_load_dwordx4 v4, s[44:47], s54 offen offset:2112  lds
    buffer_load_dwordx4 v5, s[44:47], s54 offen offset:3168  lds
    s_add_u32 m0, s53, 16896
    s_add_u32 s55, s55, 128
    buffer_load_dwordx4 v6, s[8:11], s55 offen offset:0  lds
    buffer_load_dwordx4 v7, s[8:11], s55 offen offset:1024  lds
    s_add_u32 m0, s53, 16896
    s_nop 0
    buffer_load_dwordx4 v8, s[8:11], s55 offen offset:2048  lds
    buffer_load_dwordx4 v9, s[8:11], s55 offen offset:3072  lds
    s_waitcnt vmcnt(9)
    s_barrier
    ds_read_b128 v[32:35], v12 offset:0
    ds_read_b64_tr_b16 v[64:65], v17 offset:0
    ds_read_b128 v[36:39], v12 offset:2048
    ds_read_b64_tr_b16 v[66:67], v17 offset:512
    ds_read_b128 v[40:43], v12 offset:4096
    ds_read_b128 v[44:47], v12 offset:6144
    ds_read_b64_tr_b16 v[68:69], v17 offset:32
    ds_read_b64_tr_b16 v[70:71], v17 offset:544
    s_waitcnt lgkmcnt(4)
    v_mfma_f32_16x16x32_bf16 v[96:99], v[64:67], v[32:35], 0
    ds_read_b64_tr_b16 v[72:73], v17 offset:64
    s_add_u32 m0, s52, 33792
    s_add_u32 s54, s54, 110592
    buffer_load_dwordx4 v2, s[44:47], s54 offen offset:0  lds
    v_mfma_f32_16x16x32_bf16 v[120:123], v[64:67], v[36:39], 0
    ds_read_b64_tr_b16 v[74:75], v17 offset:576
    buffer_load_dwordx4 v3, s[44:47], s54 offen offset:1056  lds
    s_waitcnt lgkmcnt(5)
    v_mfma_f32_16x16x32_bf16 v[144:147], v[64:67], v[40:43], 0
    buffer_load_dwordx4 v4, s[44:47], s54 offen offset:2112  lds
    s_waitcnt lgkmcnt(2)
    s_and_b32 s3, s2, 15
    v_mfma_f32_16x16x32_bf16 v[168:171], v[64:67], v[44:47], 0
    ds_read_b64_tr_b16 v[76:77], v17 offset:96
    buffer_load_dwordx4 v5, s[44:47], s54 offen offset:3168  lds
    s_add_u32 m0, s52, 50688
    s_add_u32 s54, s54, 110592
    s_lshl_b32 s3, s3, 4
    v_mfma_f32_16x16x32_bf16 v[100:103], v[68:71], v[32:35], 0
    ds_read_b64_tr_b16 v[78:79], v17 offset:608
    buffer_load_dwordx4 v2, s[44:47], s54 offen offset:0  lds
    s_cmp_eq_u32 s48, 0
    s_cselect_b32 s3, s3, 2146435072
    v_mfma_f32_16x16x32_bf16 v[124:127], v[68:71], v[36:39], 0
    buffer_load_dwordx4 v3, s[44:47], s54 offen offset:1056  lds
    v_mov_b32 v94, 2146435072
    v_mfma_f32_16x16x32_bf16 v[148:151], v[68:71], v[40:43], 0
    ds_read_b64_tr_b16 v[80:81], v17 offset:128
    buffer_load_dwordx4 v4, s[44:47], s54 offen offset:2112  lds
    s_waitcnt lgkmcnt(3)
    v_mov_b32 v95, 1
    v_mfma_f32_16x16x32_bf16 v[172:175], v[68:71], v[44:47], 0
    ds_read_b64_tr_b16 v[82:83], v17 offset:640
    buffer_load_dwordx4 v5, s[44:47], s54 offen offset:3168  lds
    s_add_u32 m0, s53, 33792
    s_add_u32 s55, s55, 128
    v_writelane_b32 v94, s3, 0
    v_mfma_f32_16x16x32_bf16 v[104:107], v[72:75], v[32:35], 0
    buffer_load_dwordx4 v6, s[8:11], s55 offen offset:0  lds
    v_mfma_f32_16x16x32_bf16 v[128:131], v[72:75], v[36:39], 0
    ds_read_b64_tr_b16 v[64:65], v17 offset:160
    buffer_load_dwordx4 v7, s[8:11], s55 offen offset:1024  lds
    s_add_u32 m0, s53, 33792
    v_mfma_f32_16x16x32_bf16 v[152:155], v[72:75], v[40:43], 0
    ds_read_b64_tr_b16 v[66:67], v17 offset:672
    buffer_load_dwordx4 v8, s[8:11], s55 offen offset:2048  lds
    s_waitcnt lgkmcnt(4)
    v_mfma_f32_16x16x32_bf16 v[176:179], v[72:75], v[44:47], 0
    buffer_load_dwordx4 v9, s[8:11], s55 offen offset:3072  lds
    v_mfma_f32_16x16x32_bf16 v[108:111], v[76:79], v[32:35], 0
    s_waitcnt vmcnt(16)
    s_barrier
    v_mfma_f32_16x16x32_bf16 v[132:135], v[76:79], v[36:39], 0
    ds_read_b128 v[48:51], v13 offset:0
    s_add_u32 m0, s52, 67584
    v_mfma_f32_16x16x32_bf16 v[156:159], v[76:79], v[40:43], 0
    ds_read_b64_tr_b16 v[68:69], v17 offset:16896
    s_add_u32 s54, s54, 110592
    v_mfma_f32_16x16x32_bf16 v[180:183], v[76:79], v[44:47], 0
    ds_read_b128 v[52:55], v13 offset:2048
    s_waitcnt lgkmcnt(5)
    v_mfma_f32_16x16x32_bf16 v[112:115], v[80:83], v[32:35], 0
    buffer_load_dwordx4 v2, s[44:47], s54 offen offset:0  lds
    v_mfma_f32_16x16x32_bf16 v[136:139], v[80:83], v[36:39], 0
    ds_read_b64_tr_b16 v[70:71], v17 offset:17408
    buffer_atomic_add v95, v94, s[40:43], 0 offen sc1
    v_mfma_f32_16x16x32_bf16 v[160:163], v[80:83], v[40:43], 0
    ds_read_b128 v[56:59], v13 offset:4096
    s_waitcnt lgkmcnt(5)
    v_mfma_f32_16x16x32_bf16 v[184:187], v[80:83], v[44:47], 0
    ds_read_b128 v[60:63], v13 offset:6144
    v_mfma_f32_16x16x32_bf16 v[116:119], v[64:67], v[32:35], 0
    v_mfma_f32_16x16x32_bf16 v[140:143], v[64:67], v[36:39], 0
    buffer_load_dwordx4 v3, s[44:47], s54 offen offset:1056  lds
    v_mfma_f32_16x16x32_bf16 v[164:167], v[64:67], v[40:43], 0
    ds_read_b64_tr_b16 v[72:73], v17 offset:16928
    s_waitcnt lgkmcnt(1)
    v_mfma_f32_16x16x32_bf16 v[188:191], v[64:67], v[44:47], 0
    ds_read_b64_tr_b16 v[74:75], v17 offset:17440
    v_mfma_f32_16x16x32_bf16 v[96:99], v[68:71], v[48:51], v[96:99]
    ds_read_b64_tr_b16 v[76:77], v17 offset:16960
    v_mfma_f32_16x16x32_bf16 v[120:123], v[68:71], v[52:55], v[120:123]
    ds_read_b64_tr_b16 v[78:79], v17 offset:17472
    v_mfma_f32_16x16x32_bf16 v[144:147], v[68:71], v[56:59], v[144:147]
    ds_read_b64_tr_b16 v[80:81], v17 offset:16992
    s_waitcnt lgkmcnt(3)
    v_mfma_f32_16x16x32_bf16 v[168:171], v[68:71], v[60:63], v[168:171]
    buffer_load_dwordx4 v4, s[44:47], s54 offen offset:2112  lds
    v_mfma_f32_16x16x32_bf16 v[100:103], v[72:75], v[48:51], v[100:103]
    v_mfma_f32_16x16x32_bf16 v[124:127], v[72:75], v[52:55], v[124:127]
    ds_read_b64_tr_b16 v[82:83], v17 offset:17504
    v_mfma_f32_16x16x32_bf16 v[148:151], v[72:75], v[56:59], v[148:151]
    ds_read_b64_tr_b16 v[64:65], v17 offset:17024
    s_waitcnt lgkmcnt(3)
    v_mfma_f32_16x16x32_bf16 v[172:175], v[72:75], v[60:63], v[172:175]
    ds_read_b64_tr_b16 v[66:67], v17 offset:17536
    v_mfma_f32_16x16x32_bf16 v[104:107], v[76:79], v[48:51], v[104:107]
    ds_read_b64_tr_b16 v[68:69], v17 offset:17056
    v_mfma_f32_16x16x32_bf16 v[128:131], v[76:79], v[52:55], v[128:131]
    buffer_load_dwordx4 v5, s[44:47], s54 offen offset:3168  lds
    v_mfma_f32_16x16x32_bf16 v[152:155], v[76:79], v[56:59], v[152:155]
    ds_read_b64_tr_b16 v[70:71], v17 offset:17568
    s_waitcnt lgkmcnt(4)
    v_mfma_f32_16x16x32_bf16 v[176:179], v[76:79], v[60:63], v[176:179]
    v_mfma_f32_16x16x32_bf16 v[108:111], v[80:83], v[48:51], v[108:111]
    s_waitcnt vmcnt(13)
    s_barrier
    v_mfma_f32_16x16x32_bf16 v[132:135], v[80:83], v[52:55], v[132:135]
    ds_read_b128 v[32:35], v12 offset:16896
    s_add_u32 m0, s52, 0
    v_mfma_f32_16x16x32_bf16 v[156:159], v[80:83], v[56:59], v[156:159]
    ds_read_b64_tr_b16 v[72:73], v17 offset:33792
    s_add_u32 s54, s54, 110592
    s_waitcnt lgkmcnt(4)
    v_mfma_f32_16x16x32_bf16 v[180:183], v[80:83], v[60:63], v[180:183]
    buffer_load_dwordx4 v2, s[44:47], s54 offen offset:0  lds
    v_mfma_f32_16x16x32_bf16 v[112:115], v[64:67], v[48:51], v[112:115]
    ds_read_b128 v[36:39], v12 offset:18944
    v_mfma_f32_16x16x32_bf16 v[136:139], v[64:67], v[52:55], v[136:139]
    ds_read_b64_tr_b16 v[74:75], v17 offset:34304
    v_mfma_f32_16x16x32_bf16 v[160:163], v[64:67], v[56:59], v[160:163]
    buffer_load_dwordx4 v3, s[44:47], s54 offen offset:1056  lds
    v_mfma_f32_16x16x32_bf16 v[184:187], v[64:67], v[60:63], v[184:187]
    ds_read_b128 v[40:43], v12 offset:20992
    s_waitcnt lgkmcnt(5)
    v_mfma_f32_16x16x32_bf16 v[116:119], v[68:71], v[48:51], v[116:119]
    ds_read_b128 v[44:47], v12 offset:23040
    v_mfma_f32_16x16x32_bf16 v[140:143], v[68:71], v[52:55], v[140:143]
    ds_read_b64_tr_b16 v[76:77], v17 offset:33824
    v_mfma_f32_16x16x32_bf16 v[164:167], v[68:71], v[56:59], v[164:167]
    buffer_load_dwordx4 v4, s[44:47], s54 offen offset:2112  lds
    v_mfma_f32_16x16x32_bf16 v[188:191], v[68:71], v[60:63], v[188:191]
    ds_read_b64_tr_b16 v[78:79], v17 offset:34336
    s_waitcnt lgkmcnt(2)
    v_mfma_f32_16x16x32_bf16 v[96:99], v[72:75], v[32:35], v[96:99]
    ds_read_b64_tr_b16 v[80:81], v17 offset:33856
    v_mfma_f32_16x16x32_bf16 v[120:123], v[72:75], v[36:39], v[120:123]
    ds_read_b64_tr_b16 v[82:83], v17 offset:34368
    v_mfma_f32_16x16x32_bf16 v[144:147], v[72:75], v[40:43], v[144:147]
    buffer_load_dwordx4 v5, s[44:47], s54 offen offset:3168  lds
    s_waitcnt lgkmcnt(2)
    v_mfma_f32_16x16x32_bf16 v[168:171], v[72:75], v[44:47], v[168:171]
    ds_read_b64_tr_b16 v[64:65], v17 offset:33888
    s_add_u32 m0, s53, 0
    v_mfma_f32_16x16x32_bf16 v[100:103], v[76:79], v[32:35], v[100:103]
    ds_read_b64_tr_b16 v[66:67], v17 offset:34400
    s_add_u32 s55, s55, 128
    v_mfma_f32_16x16x32_bf16 v[124:127], v[76:79], v[36:39], v[124:127]
    ds_read_b64_tr_b16 v[68:69], v17 offset:33920
    v_mfma_f32_16x16x32_bf16 v[148:151], v[76:79], v[40:43], v[148:151]
    buffer_load_dwordx4 v6, s[8:11], s55 offen offset:0  lds
    v_mfma_f32_16x16x32_bf16 v[172:175], v[76:79], v[44:47], v[172:175]
    ds_read_b64_tr_b16 v[70:71], v17 offset:34432
    s_waitcnt lgkmcnt(4)
    v_mfma_f32_16x16x32_bf16 v[104:107], v[80:83], v[32:35], v[104:107]
    ds_read_b64_tr_b16 v[72:73], v17 offset:33952
    v_mfma_f32_16x16x32_bf16 v[128:131], v[80:83], v[36:39], v[128:131]
    ds_read_b64_tr_b16 v[74:75], v17 offset:34464
    v_mfma_f32_16x16x32_bf16 v[152:155], v[80:83], v[40:43], v[152:155]
    buffer_load_dwordx4 v7, s[8:11], s55 offen offset:1024  lds
    v_mfma_f32_16x16x32_bf16 v[176:179], v[80:83], v[44:47], v[176:179]
    s_waitcnt lgkmcnt(4)
    v_mfma_f32_16x16x32_bf16 v[108:111], v[64:67], v[32:35], v[108:111]
    s_waitcnt vmcnt(15)
    s_barrier
    v_mfma_f32_16x16x32_bf16 v[132:135], v[64:67], v[36:39], v[132:135]
    ds_read_b128 v[48:51], v13 offset:16896
    s_add_u32 m0, s53, 0
    v_mfma_f32_16x16x32_bf16 v[156:159], v[64:67], v[40:43], v[156:159]
    ds_read_b64_tr_b16 v[76:77], v18 offset:0
    s_waitcnt lgkmcnt(4)
    v_mfma_f32_16x16x32_bf16 v[180:183], v[64:67], v[44:47], v[180:183]
    buffer_load_dwordx4 v8, s[8:11], s55 offen offset:2048  lds
    v_mfma_f32_16x16x32_bf16 v[112:115], v[68:71], v[32:35], v[112:115]
    ds_read_b128 v[52:55], v13 offset:18944
    v_mfma_f32_16x16x32_bf16 v[136:139], v[68:71], v[36:39], v[136:139]
    ds_read_b64_tr_b16 v[78:79], v18 offset:512
    v_mfma_f32_16x16x32_bf16 v[160:163], v[68:71], v[40:43], v[160:163]
    buffer_load_dwordx4 v9, s[8:11], s55 offen offset:3072  lds
    s_waitcnt lgkmcnt(4)
    v_mfma_f32_16x16x32_bf16 v[184:187], v[68:71], v[44:47], v[184:187]
    ds_read_b128 v[56:59], v13 offset:20992
    s_add_u32 m0, s52, 16896
    v_mfma_f32_16x16x32_bf16 v[116:119], v[72:75], v[32:35], v[116:119]
    ds_read_b128 v[60:63], v13 offset:23040
    s_add_u32 s54, s54, 110592
    v_mfma_f32_16x16x32_bf16 v[140:143], v[72:75], v[36:39], v[140:143]
    ds_read_b64_tr_b16 v[80:81], v18 offset:32
    v_mfma_f32_16x16x32_bf16 v[164:167], v[72:75], v[40:43], v[164:167]
    buffer_load_dwordx4 v2, s[44:47], s54 offen offset:0  lds
    v_mfma_f32_16x16x32_bf16 v[188:191], v[72:75], v[44:47], v[188:191]
    ds_read_b64_tr_b16 v[82:83], v18 offset:544
    s_waitcnt lgkmcnt(2)
    v_mfma_f32_16x16x32_bf16 v[96:99], v[76:79], v[48:51], v[96:99]
    ds_read_b64_tr_b16 v[64:65], v18 offset:64
    v_mfma_f32_16x16x32_bf16 v[120:123], v[76:79], v[52:55], v[120:123]
    ds_read_b64_tr_b16 v[66:67], v18 offset:576
    v_mfma_f32_16x16x32_bf16 v[144:147], v[76:79], v[56:59], v[144:147]
    buffer_load_dwordx4 v3, s[44:47], s54 offen offset:1056  lds
    v_mfma_f32_16x16x32_bf16 v[168:171], v[76:79], v[60:63], v[168:171]
    ds_read_b64_tr_b16 v[68:69], v18 offset:96
    s_waitcnt lgkmcnt(3)
    v_mfma_f32_16x16x32_bf16 v[100:103], v[80:83], v[48:51], v[100:103]
    ds_read_b64_tr_b16 v[70:71], v18 offset:608
    v_mfma_f32_16x16x32_bf16 v[124:127], v[80:83], v[52:55], v[124:127]
    ds_read_b64_tr_b16 v[72:73], v18 offset:128
    v_mfma_f32_16x16x32_bf16 v[148:151], v[80:83], v[56:59], v[148:151]
    buffer_load_dwordx4 v4, s[44:47], s54 offen offset:2112  lds
    v_mfma_f32_16x16x32_bf16 v[172:175], v[80:83], v[60:63], v[172:175]
    ds_read_b64_tr_b16 v[74:75], v18 offset:640
    s_waitcnt lgkmcnt(4)
    v_mfma_f32_16x16x32_bf16 v[104:107], v[64:67], v[48:51], v[104:107]
    ds_read_b64_tr_b16 v[76:77], v18 offset:160
    v_mfma_f32_16x16x32_bf16 v[128:131], v[64:67], v[52:55], v[128:131]
    ds_read_b64_tr_b16 v[78:79], v18 offset:672
    v_mfma_f32_16x16x32_bf16 v[152:155], v[64:67], v[56:59], v[152:155]
    buffer_load_dwordx4 v5, s[44:47], s54 offen offset:3168  lds
    v_mfma_f32_16x16x32_bf16 v[176:179], v[64:67], v[60:63], v[176:179]
    s_waitcnt lgkmcnt(4)
    v_mfma_f32_16x16x32_bf16 v[108:111], v[68:71], v[48:51], v[108:111]
    s_waitcnt vmcnt(12)
    s_barrier
    v_mfma_f32_16x16x32_bf16 v[132:135], v[68:71], v[52:55], v[132:135]
    ds_read_b128 v[32:35], v12 offset:33792
    s_add_u32 m0, s52, 33792
    v_mfma_f32_16x16x32_bf16 v[156:159], v[68:71], v[56:59], v[156:159]
    ds_read_b64_tr_b16 v[80:81], v18 offset:16896
    s_add_u32 s54, s54, 110592
    s_waitcnt lgkmcnt(4)
    v_mfma_f32_16x16x32_bf16 v[180:183], v[68:71], v[60:63], v[180:183]
    buffer_load_dwordx4 v2, s[44:47], s54 offen offset:0  lds
    v_mfma_f32_16x16x32_bf16 v[112:115], v[72:75], v[48:51], v[112:115]
    ds_read_b128 v[36:39], v12 offset:35840
    v_mfma_f32_16x16x32_bf16 v[136:139], v[72:75], v[52:55], v[136:139]
    ds_read_b64_tr_b16 v[82:83], v18 offset:17408
    v_mfma_f32_16x16x32_bf16 v[160:163], v[72:75], v[56:59], v[160:163]
    buffer_load_dwordx4 v3, s[44:47], s54 offen offset:1056  lds
    v_mfma_f32_16x16x32_bf16 v[184:187], v[72:75], v[60:63], v[184:187]
    ds_read_b128 v[40:43], v12 offset:37888
    s_waitcnt lgkmcnt(5)
    v_mfma_f32_16x16x32_bf16 v[116:119], v[76:79], v[48:51], v[116:119]
    ds_read_b128 v[44:47], v12 offset:39936
    v_mfma_f32_16x16x32_bf16 v[140:143], v[76:79], v[52:55], v[140:143]
    ds_read_b64_tr_b16 v[64:65], v18 offset:16928
    v_mfma_f32_16x16x32_bf16 v[164:167], v[76:79], v[56:59], v[164:167]
    buffer_load_dwordx4 v4, s[44:47], s54 offen offset:2112  lds
    v_mfma_f32_16x16x32_bf16 v[188:191], v[76:79], v[60:63], v[188:191]
    ds_read_b64_tr_b16 v[66:67], v18 offset:17440
    s_waitcnt lgkmcnt(2)
    v_mfma_f32_16x16x32_bf16 v[96:99], v[80:83], v[32:35], v[96:99]
    ds_read_b64_tr_b16 v[68:69], v18 offset:16960
    v_mfma_f32_16x16x32_bf16 v[120:123], v[80:83], v[36:39], v[120:123]
    ds_read_b64_tr_b16 v[70:71], v18 offset:17472
    v_mfma_f32_16x16x32_bf16 v[144:147], v[80:83], v[40:43], v[144:147]
    buffer_load_dwordx4 v5, s[44:47], s54 offen offset:3168  lds
    s_waitcnt lgkmcnt(2)
    v_mfma_f32_16x16x32_bf16 v[168:171], v[80:83], v[44:47], v[168:171]
    ds_read_b64_tr_b16 v[72:73], v18 offset:16992
    s_add_u32 m0, s53, 16896
    v_mfma_f32_16x16x32_bf16 v[100:103], v[64:67], v[32:35], v[100:103]
    ds_read_b64_tr_b16 v[74:75], v18 offset:17504
    s_add_u32 s55, s55, 128
    v_mfma_f32_16x16x32_bf16 v[124:127], v[64:67], v[36:39], v[124:127]
    ds_read_b64_tr_b16 v[76:77], v18 offset:17024
    v_mfma_f32_16x16x32_bf16 v[148:151], v[64:67], v[40:43], v[148:151]
    buffer_load_dwordx4 v6, s[8:11], s55 offen offset:0  lds
    v_mfma_f32_16x16x32_bf16 v[172:175], v[64:67], v[44:47], v[172:175]
    ds_read_b64_tr_b16 v[78:79], v18 offset:17536
    s_waitcnt lgkmcnt(4)
    v_mfma_f32_16x16x32_bf16 v[104:107], v[68:71], v[32:35], v[104:107]
    ds_read_b64_tr_b16 v[80:81], v18 offset:17056
    v_mfma_f32_16x16x32_bf16 v[128:131], v[68:71], v[36:39], v[128:131]
    ds_read_b64_tr_b16 v[82:83], v18 offset:17568
    v_mfma_f32_16x16x32_bf16 v[152:155], v[68:71], v[40:43], v[152:155]
    buffer_load_dwordx4 v7, s[8:11], s55 offen offset:1024  lds
    v_mfma_f32_16x16x32_bf16 v[176:179], v[68:71], v[44:47], v[176:179]
    s_waitcnt lgkmcnt(4)
    v_mfma_f32_16x16x32_bf16 v[108:111], v[72:75], v[32:35], v[108:111]
    s_waitcnt vmcnt(14)
    s_barrier
    v_mfma_f32_16x16x32_bf16 v[132:135], v[72:75], v[36:39], v[132:135]
    ds_read_b128 v[48:51], v13 offset:33792
    s_add_u32 m0, s53, 16896
    v_mfma_f32_16x16x32_bf16 v[156:159], v[72:75], v[40:43], v[156:159]
    ds_read_b64_tr_b16 v[64:65], v17 offset:0
    s_waitcnt lgkmcnt(4)
    v_mfma_f32_16x16x32_bf16 v[180:183], v[72:75], v[44:47], v[180:183]
    buffer_load_dwordx4 v8, s[8:11], s55 offen offset:2048  lds
    v_mfma_f32_16x16x32_bf16 v[112:115], v[76:79], v[32:35], v[112:115]
    ds_read_b128 v[52:55], v13 offset:35840
    v_mfma_f32_16x16x32_bf16 v[136:139], v[76:79], v[36:39], v[136:139]
    ds_read_b64_tr_b16 v[66:67], v17 offset:512
    v_mfma_f32_16x16x32_bf16 v[160:163], v[76:79], v[40:43], v[160:163]
    buffer_load_dwordx4 v9, s[8:11], s55 offen offset:3072  lds
    s_waitcnt lgkmcnt(4)
    v_mfma_f32_16x16x32_bf16 v[184:187], v[76:79], v[44:47], v[184:187]
    ds_read_b128 v[56:59], v13 offset:37888
    s_add_u32 m0, s52, 50688
    v_mfma_f32_16x16x32_bf16 v[116:119], v[80:83], v[32:35], v[116:119]
    ds_read_b128 v[60:63], v13 offset:39936
    s_add_u32 s54, s54, 110592
    v_mfma_f32_16x16x32_bf16 v[140:143], v[80:83], v[36:39], v[140:143]
    ds_read_b64_tr_b16 v[68:69], v17 offset:32
    v_mfma_f32_16x16x32_bf16 v[164:167], v[80:83], v[40:43], v[164:167]
    buffer_load_dwordx4 v2, s[44:47], s54 offen offset:0  lds
    v_mfma_f32_16x16x32_bf16 v[188:191], v[80:83], v[44:47], v[188:191]
    ds_read_b64_tr_b16 v[70:71], v17 offset:544
    s_waitcnt lgkmcnt(2)
    v_mfma_f32_16x16x32_bf16 v[96:99], v[64:67], v[48:51], v[96:99]
    ds_read_b64_tr_b16 v[72:73], v17 offset:64
    v_mfma_f32_16x16x32_bf16 v[120:123], v[64:67], v[52:55], v[120:123]
    ds_read_b64_tr_b16 v[74:75], v17 offset:576
    v_mfma_f32_16x16x32_bf16 v[144:147], v[64:67], v[56:59], v[144:147]
    buffer_load_dwordx4 v3, s[44:47], s54 offen offset:1056  lds
    v_mfma_f32_16x16x32_bf16 v[168:171], v[64:67], v[60:63], v[168:171]
    ds_read_b64_tr_b16 v[76:77], v17 offset:96
    s_waitcnt lgkmcnt(3)
    v_mfma_f32_16x16x32_bf16 v[100:103], v[68:71], v[48:51], v[100:103]
    ds_read_b64_tr_b16 v[78:79], v17 offset:608
    v_mfma_f32_16x16x32_bf16 v[124:127], v[68:71], v[52:55], v[124:127]
    ds_read_b64_tr_b16 v[80:81], v17 offset:128
    v_mfma_f32_16x16x32_bf16 v[148:151], v[68:71], v[56:59], v[148:151]
    buffer_load_dwordx4 v4, s[44:47], s54 offen offset:2112  lds
    v_mfma_f32_16x16x32_bf16 v[172:175], v[68:71], v[60:63], v[172:175]
    ds_read_b64_tr_b16 v[82:83], v17 offset:640
    s_waitcnt lgkmcnt(4)
    v_mfma_f32_16x16x32_bf16 v[104:107], v[72:75], v[48:51], v[104:107]
    ds_read_b64_tr_b16 v[64:65], v17 offset:160
    v_mfma_f32_16x16x32_bf16 v[128:131], v[72:75], v[52:55], v[128:131]
    ds_read_b64_tr_b16 v[66:67], v17 offset:672
    v_mfma_f32_16x16x32_bf16 v[152:155], v[72:75], v[56:59], v[152:155]
    buffer_load_dwordx4 v5, s[44:47], s54 offen offset:3168  lds
    v_mfma_f32_16x16x32_bf16 v[176:179], v[72:75], v[60:63], v[176:179]
    s_waitcnt lgkmcnt(4)
    v_mfma_f32_16x16x32_bf16 v[108:111], v[76:79], v[48:51], v[108:111]
    s_waitcnt vmcnt(12)
    s_barrier
    v_mfma_f32_16x16x32_bf16 v[132:135], v[76:79], v[52:55], v[132:135]
    ds_read_b128 v[32:35], v12 offset:0
    s_add_u32 m0, s52, 67584
    v_mfma_f32_16x16x32_bf16 v[156:159], v[76:79], v[56:59], v[156:159]
    ds_read_b64_tr_b16 v[68:69], v17 offset:16896
    s_add_u32 s54, s54, 110592
    s_waitcnt lgkmcnt(4)
    v_mfma_f32_16x16x32_bf16 v[180:183], v[76:79], v[60:63], v[180:183]
    buffer_load_dwordx4 v2, s[44:47], s54 offen offset:0  lds
    v_mfma_f32_16x16x32_bf16 v[112:115], v[80:83], v[48:51], v[112:115]
    ds_read_b128 v[36:39], v12 offset:2048
    v_mfma_f32_16x16x32_bf16 v[136:139], v[80:83], v[52:55], v[136:139]
    ds_read_b64_tr_b16 v[70:71], v17 offset:17408
    v_mfma_f32_16x16x32_bf16 v[160:163], v[80:83], v[56:59], v[160:163]
    buffer_load_dwordx4 v3, s[44:47], s54 offen offset:1056  lds
    v_mfma_f32_16x16x32_bf16 v[184:187], v[80:83], v[60:63], v[184:187]
    ds_read_b128 v[40:43], v12 offset:4096
    s_waitcnt lgkmcnt(5)
    v_mfma_f32_16x16x32_bf16 v[116:119], v[64:67], v[48:51], v[116:119]
    ds_read_b128 v[44:47], v12 offset:6144
    v_mfma_f32_16x16x32_bf16 v[140:143], v[64:67], v[52:55], v[140:143]
    ds_read_b64_tr_b16 v[72:73], v17 offset:16928
    v_mfma_f32_16x16x32_bf16 v[164:167], v[64:67], v[56:59], v[164:167]
    buffer_load_dwordx4 v4, s[44:47], s54 offen offset:2112  lds
    v_mfma_f32_16x16x32_bf16 v[188:191], v[64:67], v[60:63], v[188:191]
    ds_read_b64_tr_b16 v[74:75], v17 offset:17440
    s_waitcnt lgkmcnt(2)
    v_mfma_f32_16x16x32_bf16 v[96:99], v[68:71], v[32:35], v[96:99]
    ds_read_b64_tr_b16 v[76:77], v17 offset:16960
    v_mfma_f32_16x16x32_bf16 v[120:123], v[68:71], v[36:39], v[120:123]
    ds_read_b64_tr_b16 v[78:79], v17 offset:17472
    s_cmp_eq_u32 s57, 0
    s_cselect_b32 s56, 0, 2146435072
    v_mfma_f32_16x16x32_bf16 v[144:147], v[68:71], v[40:43], v[144:147]
    buffer_load_dwordx4 v5, s[44:47], s54 offen offset:3168  lds
    s_waitcnt lgkmcnt(2)
    v_mfma_f32_16x16x32_bf16 v[168:171], v[68:71], v[44:47], v[168:171]
    ds_read_b64_tr_b16 v[80:81], v17 offset:16992
    s_add_u32 m0, s53, 33792
    v_mfma_f32_16x16x32_bf16 v[100:103], v[72:75], v[32:35], v[100:103]
    ds_read_b64_tr_b16 v[82:83], v17 offset:17504
    s_add_u32 s55, s55, 128
    v_mfma_f32_16x16x32_bf16 v[124:127], v[72:75], v[36:39], v[124:127]
    ds_read_b64_tr_b16 v[64:65], v17 offset:17024
    buffer_load_dword v253, v92, s[20:23], s56 offen
    v_mfma_f32_16x16x32_bf16 v[148:151], v[72:75], v[40:43], v[148:151]
    buffer_load_dwordx4 v6, s[8:11], s55 offen offset:0  lds
    v_mfma_f32_16x16x32_bf16 v[172:175], v[72:75], v[44:47], v[172:175]
    ds_read_b64_tr_b16 v[66:67], v17 offset:17536
    s_waitcnt lgkmcnt(4)
    v_mfma_f32_16x16x32_bf16 v[104:107], v[76:79], v[32:35], v[104:107]
    ds_read_b64_tr_b16 v[68:69], v17 offset:17056
    buffer_load_dword v253, v93, s[24:27], s56 offen
    v_mfma_f32_16x16x32_bf16 v[128:131], v[76:79], v[36:39], v[128:131]
    ds_read_b64_tr_b16 v[70:71], v17 offset:17568
    v_mfma_f32_16x16x32_bf16 v[152:155], v[76:79], v[40:43], v[152:155]
    buffer_load_dwordx4 v7, s[8:11], s55 offen offset:1024  lds
    v_mfma_f32_16x16x32_bf16 v[176:179], v[76:79], v[44:47], v[176:179]
    s_waitcnt lgkmcnt(4)
    v_mfma_f32_16x16x32_bf16 v[108:111], v[80:83], v[32:35], v[108:111]
    s_waitcnt vmcnt(16)
    s_barrier
    v_mfma_f32_16x16x32_bf16 v[132:135], v[80:83], v[36:39], v[132:135]
    ds_read_b128 v[48:51], v13 offset:0
    s_add_u32 m0, s53, 33792
    v_mfma_f32_16x16x32_bf16 v[156:159], v[80:83], v[40:43], v[156:159]
    ds_read_b64_tr_b16 v[72:73], v17 offset:33792
    s_waitcnt lgkmcnt(4)
    v_mfma_f32_16x16x32_bf16 v[180:183], v[80:83], v[44:47], v[180:183]
    buffer_load_dwordx4 v8, s[8:11], s55 offen offset:2048  lds
    v_mfma_f32_16x16x32_bf16 v[112:115], v[64:67], v[32:35], v[112:115]
    ds_read_b128 v[52:55], v13 offset:2048
    v_mfma_f32_16x16x32_bf16 v[136:139], v[64:67], v[36:39], v[136:139]
    ds_read_b64_tr_b16 v[74:75], v17 offset:34304
    v_mfma_f32_16x16x32_bf16 v[160:163], v[64:67], v[40:43], v[160:163]
    buffer_load_dwordx4 v9, s[8:11], s55 offen offset:3072  lds
    s_waitcnt lgkmcnt(4)
    v_mfma_f32_16x16x32_bf16 v[184:187], v[64:67], v[44:47], v[184:187]
    ds_read_b128 v[56:59], v13 offset:4096
    s_add_u32 m0, s52, 0
    v_mfma_f32_16x16x32_bf16 v[116:119], v[68:71], v[32:35], v[116:119]
    ds_read_b128 v[60:63], v13 offset:6144
    s_add_u32 s54, s54, 110592
    v_mfma_f32_16x16x32_bf16 v[140:143], v[68:71], v[36:39], v[140:143]
    ds_read_b64_tr_b16 v[76:77], v17 offset:33824
    v_mfma_f32_16x16x32_bf16 v[164:167], v[68:71], v[40:43], v[164:167]
    buffer_load_dwordx4 v2, s[44:47], s54 offen offset:0  lds
    v_mfma_f32_16x16x32_bf16 v[188:191], v[68:71], v[44:47], v[188:191]
    ds_read_b64_tr_b16 v[78:79], v17 offset:34336
    s_waitcnt lgkmcnt(2)
    v_mfma_f32_16x16x32_bf16 v[96:99], v[72:75], v[48:51], v[96:99]
    ds_read_b64_tr_b16 v[80:81], v17 offset:33856
    v_mfma_f32_16x16x32_bf16 v[120:123], v[72:75], v[52:55], v[120:123]
    ds_read_b64_tr_b16 v[82:83], v17 offset:34368
    v_mfma_f32_16x16x32_bf16 v[144:147], v[72:75], v[56:59], v[144:147]
    buffer_load_dwordx4 v3, s[44:47], s54 offen offset:1056  lds
    v_mfma_f32_16x16x32_bf16 v[168:171], v[72:75], v[60:63], v[168:171]
    ds_read_b64_tr_b16 v[64:65], v17 offset:33888
    s_waitcnt lgkmcnt(3)
    v_mfma_f32_16x16x32_bf16 v[100:103], v[76:79], v[48:51], v[100:103]
    ds_read_b64_tr_b16 v[66:67], v17 offset:34400
    v_mfma_f32_16x16x32_bf16 v[124:127], v[76:79], v[52:55], v[124:127]
    ds_read_b64_tr_b16 v[68:69], v17 offset:33920
    v_mfma_f32_16x16x32_bf16 v[148:151], v[76:79], v[56:59], v[148:151]
    buffer_load_dwordx4 v4, s[44:47], s54 offen offset:2112  lds
    v_mfma_f32_16x16x32_bf16 v[172:175], v[76:79], v[60:63], v[172:175]
    ds_read_b64_tr_b16 v[70:71], v17 offset:34432
    s_waitcnt lgkmcnt(4)
    v_mfma_f32_16x16x32_bf16 v[104:107], v[80:83], v[48:51], v[104:107]
    ds_read_b64_tr_b16 v[72:73], v17 offset:33952
    v_mfma_f32_16x16x32_bf16 v[128:131], v[80:83], v[52:55], v[128:131]
    ds_read_b64_tr_b16 v[74:75], v17 offset:34464
    v_mfma_f32_16x16x32_bf16 v[152:155], v[80:83], v[56:59], v[152:155]
    buffer_load_dwordx4 v5, s[44:47], s54 offen offset:3168  lds
    v_mfma_f32_16x16x32_bf16 v[176:179], v[80:83], v[60:63], v[176:179]
    s_waitcnt lgkmcnt(4)
    v_mfma_f32_16x16x32_bf16 v[108:111], v[64:67], v[48:51], v[108:111]
    s_waitcnt vmcnt(14)
    s_barrier
    v_mfma_f32_16x16x32_bf16 v[132:135], v[64:67], v[52:55], v[132:135]
    ds_read_b128 v[32:35], v12 offset:16896
    s_add_u32 m0, s52, 16896
    v_mfma_f32_16x16x32_bf16 v[156:159], v[64:67], v[56:59], v[156:159]
    ds_read_b64_tr_b16 v[76:77], v18 offset:0
    s_add_u32 s54, s54, 110592
    s_waitcnt lgkmcnt(4)
    v_mfma_f32_16x16x32_bf16 v[180:183], v[64:67], v[60:63], v[180:183]
    buffer_load_dwordx4 v2, s[44:47], s54 offen offset:0  lds
    v_mfma_f32_16x16x32_bf16 v[112:115], v[68:71], v[48:51], v[112:115]
    ds_read_b128 v[36:39], v12 offset:18944
    v_mfma_f32_16x16x32_bf16 v[136:139], v[68:71], v[52:55], v[136:139]
    ds_read_b64_tr_b16 v[78:79], v18 offset:512
    v_mfma_f32_16x16x32_bf16 v[160:163], v[68:71], v[56:59], v[160:163]
    buffer_load_dwordx4 v3, s[44:47], s54 offen offset:1056  lds
    v_mfma_f32_16x16x32_bf16 v[184:187], v[68:71], v[60:63], v[184:187]
    ds_read_b128 v[40:43], v12 offset:20992
    s_waitcnt lgkmcnt(5)
    v_mfma_f32_16x16x32_bf16 v[116:119], v[72:75], v[48:51], v[116:119]
    ds_read_b128 v[44:47], v12 offset:23040
    v_mfma_f32_16x16x32_bf16 v[140:143], v[72:75], v[52:55], v[140:143]
    ds_read_b64_tr_b16 v[80:81], v18 offset:32
    v_mfma_f32_16x16x32_bf16 v[164:167], v[72:75], v[56:59], v[164:167]
    buffer_load_dwordx4 v4, s[44:47], s54 offen offset:2112  lds
    v_mfma_f32_16x16x32_bf16 v[188:191], v[72:75], v[60:63], v[188:191]
    ds_read_b64_tr_b16 v[82:83], v18 offset:544
    s_waitcnt lgkmcnt(2)
    v_mfma_f32_16x16x32_bf16 v[96:99], v[76:79], v[32:35], v[96:99]
    ds_read_b64_tr_b16 v[64:65], v18 offset:64
    v_mfma_f32_16x16x32_bf16 v[120:123], v[76:79], v[36:39], v[120:123]
    ds_read_b64_tr_b16 v[66:67], v18 offset:576
    v_mfma_f32_16x16x32_bf16 v[144:147], v[76:79], v[40:43], v[144:147]
    buffer_load_dwordx4 v5, s[44:47], s54 offen offset:3168  lds
    s_waitcnt lgkmcnt(2)
    v_mfma_f32_16x16x32_bf16 v[168:171], v[76:79], v[44:47], v[168:171]
    ds_read_b64_tr_b16 v[68:69], v18 offset:96
    s_add_u32 m0, s53, 0
    v_mfma_f32_16x16x32_bf16 v[100:103], v[80:83], v[32:35], v[100:103]
    ds_read_b64_tr_b16 v[70:71], v18 offset:608
    s_add_u32 s55, s55, 128
    v_mfma_f32_16x16x32_bf16 v[124:127], v[80:83], v[36:39], v[124:127]
    ds_read_b64_tr_b16 v[72:73], v18 offset:128
    v_mfma_f32_16x16x32_bf16 v[148:151], v[80:83], v[40:43], v[148:151]
    buffer_load_dwordx4 v6, s[8:11], s55 offen offset:0  lds
    v_mfma_f32_16x16x32_bf16 v[172:175], v[80:83], v[44:47], v[172:175]
    ds_read_b64_tr_b16 v[74:75], v18 offset:640
    s_waitcnt lgkmcnt(4)
    v_mfma_f32_16x16x32_bf16 v[104:107], v[64:67], v[32:35], v[104:107]
    ds_read_b64_tr_b16 v[76:77], v18 offset:160
    v_mfma_f32_16x16x32_bf16 v[128:131], v[64:67], v[36:39], v[128:131]
    ds_read_b64_tr_b16 v[78:79], v18 offset:672
    v_mfma_f32_16x16x32_bf16 v[152:155], v[64:67], v[40:43], v[152:155]
    buffer_load_dwordx4 v7, s[8:11], s55 offen offset:1024  lds
    v_mfma_f32_16x16x32_bf16 v[176:179], v[64:67], v[44:47], v[176:179]
    s_waitcnt lgkmcnt(4)
    v_mfma_f32_16x16x32_bf16 v[108:111], v[68:71], v[32:35], v[108:111]
    s_waitcnt vmcnt(16)
    s_barrier
    v_mfma_f32_16x16x32_bf16 v[132:135], v[68:71], v[36:39], v[132:135]
    ds_read_b128 v[48:51], v13 offset:16896
    s_add_u32 m0, s53, 0
    v_mfma_f32_16x16x32_bf16 v[156:159], v[68:71], v[40:43], v[156:159]
    ds_read_b64_tr_b16 v[80:81], v18 offset:16896
    s_waitcnt lgkmcnt(4)
    v_mfma_f32_16x16x32_bf16 v[180:183], v[68:71], v[44:47], v[180:183]
    buffer_load_dwordx4 v8, s[8:11], s55 offen offset:2048  lds
    v_mfma_f32_16x16x32_bf16 v[112:115], v[72:75], v[32:35], v[112:115]
    ds_read_b128 v[52:55], v13 offset:18944
    v_mfma_f32_16x16x32_bf16 v[136:139], v[72:75], v[36:39], v[136:139]
    ds_read_b64_tr_b16 v[82:83], v18 offset:17408
    v_mfma_f32_16x16x32_bf16 v[160:163], v[72:75], v[40:43], v[160:163]
    buffer_load_dwordx4 v9, s[8:11], s55 offen offset:3072  lds
    s_waitcnt lgkmcnt(4)
    v_mfma_f32_16x16x32_bf16 v[184:187], v[72:75], v[44:47], v[184:187]
    ds_read_b128 v[56:59], v13 offset:20992
    s_add_u32 m0, s52, 33792
    v_mfma_f32_16x16x32_bf16 v[116:119], v[76:79], v[32:35], v[116:119]
    ds_read_b128 v[60:63], v13 offset:23040
    s_add_u32 s54, s54, 110592
    v_mfma_f32_16x16x32_bf16 v[140:143], v[76:79], v[36:39], v[140:143]
    ds_read_b64_tr_b16 v[64:65], v18 offset:16928
    v_mfma_f32_16x16x32_bf16 v[164:167], v[76:79], v[40:43], v[164:167]
    buffer_load_dwordx4 v2, s[44:47], s54 offen offset:0  lds
    v_mfma_f32_16x16x32_bf16 v[188:191], v[76:79], v[44:47], v[188:191]
    ds_read_b64_tr_b16 v[66:67], v18 offset:17440
    s_waitcnt lgkmcnt(2)
    v_mfma_f32_16x16x32_bf16 v[96:99], v[80:83], v[48:51], v[96:99]
    ds_read_b64_tr_b16 v[68:69], v18 offset:16960
    v_mfma_f32_16x16x32_bf16 v[120:123], v[80:83], v[52:55], v[120:123]
    ds_read_b64_tr_b16 v[70:71], v18 offset:17472
    s_cmp_eq_u32 s57, 1
    s_cselect_b32 s56, 0, 2146435072
    v_mfma_f32_16x16x32_bf16 v[144:147], v[80:83], v[56:59], v[144:147]
    buffer_load_dwordx4 v3, s[44:47], s54 offen offset:1056  lds
    v_mfma_f32_16x16x32_bf16 v[168:171], v[80:83], v[60:63], v[168:171]
    ds_read_b64_tr_b16 v[72:73], v18 offset:16992
    s_waitcnt lgkmcnt(3)
    v_mfma_f32_16x16x32_bf16 v[100:103], v[64:67], v[48:51], v[100:103]
    ds_read_b64_tr_b16 v[74:75], v18 offset:17504
    buffer_load_dword v253, v92, s[20:23], s56 offen
    v_mfma_f32_16x16x32_bf16 v[124:127], v[64:67], v[52:55], v[124:127]
    ds_read_b64_tr_b16 v[76:77], v18 offset:17024
    buffer_load_dword v253, v93, s[24:27], s56 offen
    v_mfma_f32_16x16x32_bf16 v[148:151], v[64:67], v[56:59], v[148:151]
    buffer_load_dwordx4 v4, s[44:47], s54 offen offset:2112  lds
    v_mfma_f32_16x16x32_bf16 v[172:175], v[64:67], v[60:63], v[172:175]
    ds_read_b64_tr_b16 v[78:79], v18 offset:17536
    s_waitcnt lgkmcnt(4)
    v_mfma_f32_16x16x32_bf16 v[104:107], v[68:71], v[48:51], v[104:107]
    ds_read_b64_tr_b16 v[80:81], v18 offset:17056
    v_mfma_f32_16x16x32_bf16 v[128:131], v[68:71], v[52:55], v[128:131]
    ds_read_b64_tr_b16 v[82:83], v18 offset:17568
    v_mfma_f32_16x16x32_bf16 v[152:155], v[68:71], v[56:59], v[152:155]
    buffer_load_dwordx4 v5, s[44:47], s54 offen offset:3168  lds
    v_mfma_f32_16x16x32_bf16 v[176:179], v[68:71], v[60:63], v[176:179]
    s_waitcnt lgkmcnt(4)
    v_mfma_f32_16x16x32_bf16 v[108:111], v[72:75], v[48:51], v[108:111]
    s_waitcnt vmcnt(14)
    s_barrier
    v_mfma_f32_16x16x32_bf16 v[132:135], v[72:75], v[52:55], v[132:135]
    ds_read_b128 v[32:35], v12 offset:33792
    s_add_u32 m0, s52, 50688
    v_mfma_f32_16x16x32_bf16 v[156:159], v[72:75], v[56:59], v[156:159]
    ds_read_b64_tr_b16 v[64:65], v17 offset:0
    s_add_u32 s54, s54, 110592
    s_waitcnt lgkmcnt(4)
    v_mfma_f32_16x16x32_bf16 v[180:183], v[72:75], v[60:63], v[180:183]
    buffer_load_dwordx4 v2, s[44:47], s54 offen offset:0  lds
    v_mfma_f32_16x16x32_bf16 v[112:115], v[76:79], v[48:51], v[112:115]
    ds_read_b128 v[36:39], v12 offset:35840
    v_mfma_f32_16x16x32_bf16 v[136:139], v[76:79], v[52:55], v[136:139]
    ds_read_b64_tr_b16 v[66:67], v17 offset:512
    v_mfma_f32_16x16x32_bf16 v[160:163], v[76:79], v[56:59], v[160:163]
    buffer_load_dwordx4 v3, s[44:47], s54 offen offset:1056  lds
    v_mfma_f32_16x16x32_bf16 v[184:187], v[76:79], v[60:63], v[184:187]
    ds_read_b128 v[40:43], v12 offset:37888
    s_waitcnt lgkmcnt(5)
    v_mfma_f32_16x16x32_bf16 v[116:119], v[80:83], v[48:51], v[116:119]
    ds_read_b128 v[44:47], v12 offset:39936
    v_mfma_f32_16x16x32_bf16 v[140:143], v[80:83], v[52:55], v[140:143]
    ds_read_b64_tr_b16 v[68:69], v17 offset:32
    v_mfma_f32_16x16x32_bf16 v[164:167], v[80:83], v[56:59], v[164:167]
    buffer_load_dwordx4 v4, s[44:47], s54 offen offset:2112  lds
    v_mfma_f32_16x16x32_bf16 v[188:191], v[80:83], v[60:63], v[188:191]
    ds_read_b64_tr_b16 v[70:71], v17 offset:544
    s_waitcnt lgkmcnt(2)
    v_mfma_f32_16x16x32_bf16 v[96:99], v[64:67], v[32:35], v[96:99]
    ds_read_b64_tr_b16 v[72:73], v17 offset:64
    v_mfma_f32_16x16x32_bf16 v[120:123], v[64:67], v[36:39], v[120:123]
    ds_read_b64_tr_b16 v[74:75], v17 offset:576
    v_mfma_f32_16x16x32_bf16 v[144:147], v[64:67], v[40:43], v[144:147]
    buffer_load_dwordx4 v5, s[44:47], s54 offen offset:3168  lds
    s_waitcnt lgkmcnt(2)
    v_mfma_f32_16x16x32_bf16 v[168:171], v[64:67], v[44:47], v[168:171]
    ds_read_b64_tr_b16 v[76:77], v17 offset:96
    s_add_u32 m0, s53, 16896
    v_mfma_f32_16x16x32_bf16 v[100:103], v[68:71], v[32:35], v[100:103]
    ds_read_b64_tr_b16 v[78:79], v17 offset:608
    s_add_u32 s55, s55, 128
    v_mfma_f32_16x16x32_bf16 v[124:127], v[68:71], v[36:39], v[124:127]
    ds_read_b64_tr_b16 v[80:81], v17 offset:128
    v_mfma_f32_16x16x32_bf16 v[148:151], v[68:71], v[40:43], v[148:151]
    buffer_load_dwordx4 v6, s[8:11], s55 offen offset:0  lds
    v_mfma_f32_16x16x32_bf16 v[172:175], v[68:71], v[44:47], v[172:175]
    ds_read_b64_tr_b16 v[82:83], v17 offset:640
    s_waitcnt lgkmcnt(4)
    v_mfma_f32_16x16x32_bf16 v[104:107], v[72:75], v[32:35], v[104:107]
    ds_read_b64_tr_b16 v[64:65], v17 offset:160
    v_mfma_f32_16x16x32_bf16 v[128:131], v[72:75], v[36:39], v[128:131]
    ds_read_b64_tr_b16 v[66:67], v17 offset:672
    v_mfma_f32_16x16x32_bf16 v[152:155], v[72:75], v[40:43], v[152:155]
    buffer_load_dwordx4 v7, s[8:11], s55 offen offset:1024  lds
    v_mfma_f32_16x16x32_bf16 v[176:179], v[72:75], v[44:47], v[176:179]
    s_waitcnt lgkmcnt(4)
    v_mfma_f32_16x16x32_bf16 v[108:111], v[76:79], v[32:35], v[108:111]
    s_waitcnt vmcnt(16)
    s_barrier
    v_mfma_f32_16x16x32_bf16 v[132:135], v[76:79], v[36:39], v[132:135]
    ds_read_b128 v[48:51], v13 offset:33792
    s_add_u32 m0, s53, 16896
    v_mfma_f32_16x16x32_bf16 v[156:159], v[76:79], v[40:43], v[156:159]
    ds_read_b64_tr_b16 v[68:69], v17 offset:16896
    s_waitcnt lgkmcnt(4)
    v_mfma_f32_16x16x32_bf16 v[180:183], v[76:79], v[44:47], v[180:183]
    buffer_load_dwordx4 v8, s[8:11], s55 offen offset:2048  lds
    v_mfma_f32_16x16x32_bf16 v[112:115], v[80:83], v[32:35], v[112:115]
    ds_read_b128 v[52:55], v13 offset:35840
    v_mfma_f32_16x16x32_bf16 v[136:139], v[80:83], v[36:39], v[136:139]
    ds_read_b64_tr_b16 v[70:71], v17 offset:17408
    v_mfma_f32_16x16x32_bf16 v[160:163], v[80:83], v[40:43], v[160:163]
    buffer_load_dwordx4 v9, s[8:11], s55 offen offset:3072  lds
    s_waitcnt lgkmcnt(4)
    v_mfma_f32_16x16x32_bf16 v[184:187], v[80:83], v[44:47], v[184:187]
    ds_read_b128 v[56:59], v13 offset:37888
    s_add_u32 m0, s52, 67584
    v_mfma_f32_16x16x32_bf16 v[116:119], v[64:67], v[32:35], v[116:119]
    ds_read_b128 v[60:63], v13 offset:39936
    s_add_u32 s54, s54, 110592
    v_mfma_f32_16x16x32_bf16 v[140:143], v[64:67], v[36:39], v[140:143]
    ds_read_b64_tr_b16 v[72:73], v17 offset:16928
    v_mfma_f32_16x16x32_bf16 v[164:167], v[64:67], v[40:43], v[164:167]
    buffer_load_dwordx4 v2, s[44:47], s54 offen offset:0  lds
    v_mfma_f32_16x16x32_bf16 v[188:191], v[64:67], v[44:47], v[188:191]
    ds_read_b64_tr_b16 v[74:75], v17 offset:17440
    s_waitcnt lgkmcnt(2)
    v_mfma_f32_16x16x32_bf16 v[96:99], v[68:71], v[48:51], v[96:99]
    ds_read_b64_tr_b16 v[76:77], v17 offset:16960
    v_mfma_f32_16x16x32_bf16 v[120:123], v[68:71], v[52:55], v[120:123]
    ds_read_b64_tr_b16 v[78:79], v17 offset:17472
    v_mfma_f32_16x16x32_bf16 v[144:147], v[68:71], v[56:59], v[144:147]
    buffer_load_dwordx4 v3, s[44:47], s54 offen offset:1056  lds
    v_mfma_f32_16x16x32_bf16 v[168:171], v[68:71], v[60:63], v[168:171]
    ds_read_b64_tr_b16 v[80:81], v17 offset:16992
    s_waitcnt lgkmcnt(3)
    v_mfma_f32_16x16x32_bf16 v[100:103], v[72:75], v[48:51], v[100:103]
    ds_read_b64_tr_b16 v[82:83], v17 offset:17504
    v_mfma_f32_16x16x32_bf16 v[124:127], v[72:75], v[52:55], v[124:127]
    ds_read_b64_tr_b16 v[64:65], v17 offset:17024
    v_mfma_f32_16x16x32_bf16 v[148:151], v[72:75], v[56:59], v[148:151]
    buffer_load_dwordx4 v4, s[44:47], s54 offen offset:2112  lds
    v_mfma_f32_16x16x32_bf16 v[172:175], v[72:75], v[60:63], v[172:175]
    ds_read_b64_tr_b16 v[66:67], v17 offset:17536
    s_waitcnt lgkmcnt(4)
    v_mfma_f32_16x16x32_bf16 v[104:107], v[76:79], v[48:51], v[104:107]
    ds_read_b64_tr_b16 v[68:69], v17 offset:17056
    v_mfma_f32_16x16x32_bf16 v[128:131], v[76:79], v[52:55], v[128:131]
    ds_read_b64_tr_b16 v[70:71], v17 offset:17568
    v_mfma_f32_16x16x32_bf16 v[152:155], v[76:79], v[56:59], v[152:155]
    buffer_load_dwordx4 v5, s[44:47], s54 offen offset:3168  lds
    v_mfma_f32_16x16x32_bf16 v[176:179], v[76:79], v[60:63], v[176:179]
    s_waitcnt lgkmcnt(4)
    v_mfma_f32_16x16x32_bf16 v[108:111], v[80:83], v[48:51], v[108:111]
    s_waitcnt vmcnt(12)
    s_barrier
    v_mfma_f32_16x16x32_bf16 v[132:135], v[80:83], v[52:55], v[132:135]
    ds_read_b128 v[32:35], v12 offset:0
    s_add_u32 m0, s52, 0
    v_mfma_f32_16x16x32_bf16 v[156:159], v[80:83], v[56:59], v[156:159]
    ds_read_b64_tr_b16 v[72:73], v17 offset:33792
    s_add_u32 s54, s54, 110592
    s_waitcnt lgkmcnt(4)
    v_mfma_f32_16x16x32_bf16 v[180:183], v[80:83], v[60:63], v[180:183]
    buffer_load_dwordx4 v2, s[44:47], s54 offen offset:0  lds
    v_mfma_f32_16x16x32_bf16 v[112:115], v[64:67], v[48:51], v[112:115]
    ds_read_b128 v[36:39], v12 offset:2048
    v_mfma_f32_16x16x32_bf16 v[136:139], v[64:67], v[52:55], v[136:139]
    ds_read_b64_tr_b16 v[74:75], v17 offset:34304
    v_mfma_f32_16x16x32_bf16 v[160:163], v[64:67], v[56:59], v[160:163]
    buffer_load_dwordx4 v3, s[44:47], s54 offen offset:1056  lds
    v_mfma_f32_16x16x32_bf16 v[184:187], v[64:67], v[60:63], v[184:187]
    ds_read_b128 v[40:43], v12 offset:4096
    s_waitcnt lgkmcnt(5)
    v_mfma_f32_16x16x32_bf16 v[116:119], v[68:71], v[48:51], v[116:119]
    ds_read_b128 v[44:47], v12 offset:6144
    v_mfma_f32_16x16x32_bf16 v[140:143], v[68:71], v[52:55], v[140:143]
    ds_read_b64_tr_b16 v[76:77], v17 offset:33824
    v_mfma_f32_16x16x32_bf16 v[164:167], v[68:71], v[56:59], v[164:167]
    buffer_load_dwordx4 v4, s[44:47], s54 offen offset:2112  lds
    v_mfma_f32_16x16x32_bf16 v[188:191], v[68:71], v[60:63], v[188:191]
    ds_read_b64_tr_b16 v[78:79], v17 offset:34336
    s_waitcnt lgkmcnt(2)
    v_mfma_f32_16x16x32_bf16 v[96:99], v[72:75], v[32:35], v[96:99]
    ds_read_b64_tr_b16 v[80:81], v17 offset:33856
    v_mfma_f32_16x16x32_bf16 v[120:123], v[72:75], v[36:39], v[120:123]
    ds_read_b64_tr_b16 v[82:83], v17 offset:34368
    s_cmp_eq_u32 s57, 2
    s_cselect_b32 s56, 0, 2146435072
    v_mfma_f32_16x16x32_bf16 v[144:147], v[72:75], v[40:43], v[144:147]
    buffer_load_dwordx4 v5, s[44:47], s54 offen offset:3168  lds
    s_waitcnt lgkmcnt(2)
    v_mfma_f32_16x16x32_bf16 v[168:171], v[72:75], v[44:47], v[168:171]
    ds_read_b64_tr_b16 v[64:65], v17 offset:33888
    s_add_u32 m0, s53, 33792
    v_mfma_f32_16x16x32_bf16 v[100:103], v[76:79], v[32:35], v[100:103]
    ds_read_b64_tr_b16 v[66:67], v17 offset:34400
    s_add_u32 s55, s55, 128
    v_mfma_f32_16x16x32_bf16 v[124:127], v[76:79], v[36:39], v[124:127]
    ds_read_b64_tr_b16 v[68:69], v17 offset:33920
    buffer_load_dword v253, v92, s[20:23], s56 offen
    v_mfma_f32_16x16x32_bf16 v[148:151], v[76:79], v[40:43], v[148:151]
    buffer_load_dwordx4 v6, s[8:11], s55 offen offset:0  lds
    v_mfma_f32_16x16x32_bf16 v[172:175], v[76:79], v[44:47], v[172:175]
    ds_read_b64_tr_b16 v[70:71], v17 offset:34432
    s_waitcnt lgkmcnt(4)
    v_mfma_f32_16x16x32_bf16 v[104:107], v[80:83], v[32:35], v[104:107]
    ds_read_b64_tr_b16 v[72:73], v17 offset:33952
    buffer_load_dword v253, v93, s[24:27], s56 offen
    v_mfma_f32_16x16x32_bf16 v[128:131], v[80:83], v[36:39], v[128:131]
    ds_read_b64_tr_b16 v[74:75], v17 offset:34464
    v_mfma_f32_16x16x32_bf16 v[152:155], v[80:83], v[40:43], v[152:155]
    buffer_load_dwordx4 v7, s[8:11], s55 offen offset:1024  lds
    v_mfma_f32_16x16x32_bf16 v[176:179], v[80:83], v[44:47], v[176:179]
    s_waitcnt lgkmcnt(4)
    v_mfma_f32_16x16x32_bf16 v[108:111], v[64:67], v[32:35], v[108:111]
    s_waitcnt vmcnt(16)
    s_barrier
    v_mfma_f32_16x16x32_bf16 v[132:135], v[64:67], v[36:39], v[132:135]
    ds_read_b128 v[48:51], v13 offset:0
    s_add_u32 m0, s53, 33792
    v_mfma_f32_16x16x32_bf16 v[156:159], v[64:67], v[40:43], v[156:159]
    ds_read_b64_tr_b16 v[76:77], v18 offset:0
    s_waitcnt lgkmcnt(4)
    v_mfma_f32_16x16x32_bf16 v[180:183], v[64:67], v[44:47], v[180:183]
    buffer_load_dwordx4 v8, s[8:11], s55 offen offset:2048  lds
    v_mfma_f32_16x16x32_bf16 v[112:115], v[68:71], v[32:35], v[112:115]
    ds_read_b128 v[52:55], v13 offset:2048
    v_mfma_f32_16x16x32_bf16 v[136:139], v[68:71], v[36:39], v[136:139]
    ds_read_b64_tr_b16 v[78:79], v18 offset:512
    v_mfma_f32_16x16x32_bf16 v[160:163], v[68:71], v[40:43], v[160:163]
    buffer_load_dwordx4 v9, s[8:11], s55 offen offset:3072  lds
    s_waitcnt lgkmcnt(4)
    v_mfma_f32_16x16x32_bf16 v[184:187], v[68:71], v[44:47], v[184:187]
    ds_read_b128 v[56:59], v13 offset:4096
    s_add_u32 m0, s52, 16896
    v_mfma_f32_16x16x32_bf16 v[116:119], v[72:75], v[32:35], v[116:119]
    ds_read_b128 v[60:63], v13 offset:6144
    s_add_u32 s54, s54, 110592
    v_mfma_f32_16x16x32_bf16 v[140:143], v[72:75], v[36:39], v[140:143]
    ds_read_b64_tr_b16 v[80:81], v18 offset:32
    v_mfma_f32_16x16x32_bf16 v[164:167], v[72:75], v[40:43], v[164:167]
    buffer_load_dwordx4 v2, s[44:47], s54 offen offset:0  lds
    v_mfma_f32_16x16x32_bf16 v[188:191], v[72:75], v[44:47], v[188:191]
    ds_read_b64_tr_b16 v[82:83], v18 offset:544
    s_waitcnt lgkmcnt(2)
    v_mfma_f32_16x16x32_bf16 v[96:99], v[76:79], v[48:51], v[96:99]
    ds_read_b64_tr_b16 v[64:65], v18 offset:64
    v_mfma_f32_16x16x32_bf16 v[120:123], v[76:79], v[52:55], v[120:123]
    ds_read_b64_tr_b16 v[66:67], v18 offset:576
    v_mfma_f32_16x16x32_bf16 v[144:147], v[76:79], v[56:59], v[144:147]
    buffer_load_dwordx4 v3, s[44:47], s54 offen offset:1056  lds
    v_mfma_f32_16x16x32_bf16 v[168:171], v[76:79], v[60:63], v[168:171]
    ds_read_b64_tr_b16 v[68:69], v18 offset:96
    s_waitcnt lgkmcnt(3)
    v_mfma_f32_16x16x32_bf16 v[100:103], v[80:83], v[48:51], v[100:103]
    ds_read_b64_tr_b16 v[70:71], v18 offset:608
    v_mfma_f32_16x16x32_bf16 v[124:127], v[80:83], v[52:55], v[124:127]
    ds_read_b64_tr_b16 v[72:73], v18 offset:128
    v_mfma_f32_16x16x32_bf16 v[148:151], v[80:83], v[56:59], v[148:151]
    buffer_load_dwordx4 v4, s[44:47], s54 offen offset:2112  lds
    v_mfma_f32_16x16x32_bf16 v[172:175], v[80:83], v[60:63], v[172:175]
    ds_read_b64_tr_b16 v[74:75], v18 offset:640
    s_waitcnt lgkmcnt(4)
    v_mfma_f32_16x16x32_bf16 v[104:107], v[64:67], v[48:51], v[104:107]
    ds_read_b64_tr_b16 v[76:77], v18 offset:160
    v_mfma_f32_16x16x32_bf16 v[128:131], v[64:67], v[52:55], v[128:131]
    ds_read_b64_tr_b16 v[78:79], v18 offset:672
    v_mfma_f32_16x16x32_bf16 v[152:155], v[64:67], v[56:59], v[152:155]
    buffer_load_dwordx4 v5, s[44:47], s54 offen offset:3168  lds
    v_mfma_f32_16x16x32_bf16 v[176:179], v[64:67], v[60:63], v[176:179]
    s_waitcnt lgkmcnt(4)
    v_mfma_f32_16x16x32_bf16 v[108:111], v[68:71], v[48:51], v[108:111]
    s_waitcnt vmcnt(14)
    s_barrier
    v_mfma_f32_16x16x32_bf16 v[132:135], v[68:71], v[52:55], v[132:135]
    ds_read_b128 v[32:35], v12 offset:16896
    s_add_u32 m0, s52, 33792
    v_mfma_f32_16x16x32_bf16 v[156:159], v[68:71], v[56:59], v[156:159]
    ds_read_b64_tr_b16 v[80:81], v18 offset:16896
    s_add_u32 s54, s54, 110592
    s_waitcnt lgkmcnt(4)
    v_mfma_f32_16x16x32_bf16 v[180:183], v[68:71], v[60:63], v[180:183]
    buffer_load_dwordx4 v2, s[44:47], s54 offen offset:0  lds
    v_mfma_f32_16x16x32_bf16 v[112:115], v[72:75], v[48:51], v[112:115]
    ds_read_b128 v[36:39], v12 offset:18944
    v_mfma_f32_16x16x32_bf16 v[136:139], v[72:75], v[52:55], v[136:139]
    ds_read_b64_tr_b16 v[82:83], v18 offset:17408
    v_mfma_f32_16x16x32_bf16 v[160:163], v[72:75], v[56:59], v[160:163]
    buffer_load_dwordx4 v3, s[44:47], s54 offen offset:1056  lds
    v_mfma_f32_16x16x32_bf16 v[184:187], v[72:75], v[60:63], v[184:187]
    ds_read_b128 v[40:43], v12 offset:20992
    s_waitcnt lgkmcnt(5)
    v_mfma_f32_16x16x32_bf16 v[116:119], v[76:79], v[48:51], v[116:119]
    ds_read_b128 v[44:47], v12 offset:23040
    v_mfma_f32_16x16x32_bf16 v[140:143], v[76:79], v[52:55], v[140:143]
    ds_read_b64_tr_b16 v[64:65], v18 offset:16928
    v_mfma_f32_16x16x32_bf16 v[164:167], v[76:79], v[56:59], v[164:167]
    buffer_load_dwordx4 v4, s[44:47], s54 offen offset:2112  lds
    v_mfma_f32_16x16x32_bf16 v[188:191], v[76:79], v[60:63], v[188:191]
    ds_read_b64_tr_b16 v[66:67], v18 offset:17440
    s_waitcnt lgkmcnt(2)
    v_mfma_f32_16x16x32_bf16 v[96:99], v[80:83], v[32:35], v[96:99]
    ds_read_b64_tr_b16 v[68:69], v18 offset:16960
    v_mfma_f32_16x16x32_bf16 v[120:123], v[80:83], v[36:39], v[120:123]
    ds_read_b64_tr_b16 v[70:71], v18 offset:17472
    v_mfma_f32_16x16x32_bf16 v[144:147], v[80:83], v[40:43], v[144:147]
    buffer_load_dwordx4 v5, s[44:47], s54 offen offset:3168  lds
    s_waitcnt lgkmcnt(2)
    v_mfma_f32_16x16x32_bf16 v[168:171], v[80:83], v[44:47], v[168:171]
    ds_read_b64_tr_b16 v[72:73], v18 offset:16992
    s_add_u32 m0, s53, 0
    v_mfma_f32_16x16x32_bf16 v[100:103], v[64:67], v[32:35], v[100:103]
    ds_read_b64_tr_b16 v[74:75], v18 offset:17504
    s_add_u32 s55, s55, 128
    v_mfma_f32_16x16x32_bf16 v[124:127], v[64:67], v[36:39], v[124:127]
    ds_read_b64_tr_b16 v[76:77], v18 offset:17024
    v_mfma_f32_16x16x32_bf16 v[148:151], v[64:67], v[40:43], v[148:151]
    buffer_load_dwordx4 v6, s[8:11], s55 offen offset:0  lds
    v_mfma_f32_16x16x32_bf16 v[172:175], v[64:67], v[44:47], v[172:175]
    ds_read_b64_tr_b16 v[78:79], v18 offset:17536
    s_waitcnt lgkmcnt(4)
    v_mfma_f32_16x16x32_bf16 v[104:107], v[68:71], v[32:35], v[104:107]
    ds_read_b64_tr_b16 v[80:81], v18 offset:17056
    v_mfma_f32_16x16x32_bf16 v[128:131], v[68:71], v[36:39], v[128:131]
    ds_read_b64_tr_b16 v[82:83], v18 offset:17568
    v_mfma_f32_16x16x32_bf16 v[152:155], v[68:71], v[40:43], v[152:155]
    buffer_load_dwordx4 v7, s[8:11], s55 offen offset:1024  lds
    v_mfma_f32_16x16x32_bf16 v[176:179], v[68:71], v[44:47], v[176:179]
    s_waitcnt lgkmcnt(4)
    v_mfma_f32_16x16x32_bf16 v[108:111], v[72:75], v[32:35], v[108:111]
    s_waitcnt vmcnt(16)
    s_barrier
    v_mfma_f32_16x16x32_bf16 v[132:135], v[72:75], v[36:39], v[132:135]
    ds_read_b128 v[48:51], v13 offset:16896
    s_add_u32 m0, s53, 0
    v_mfma_f32_16x16x32_bf16 v[156:159], v[72:75], v[40:43], v[156:159]
    ds_read_b64_tr_b16 v[64:65], v17 offset:0
    s_waitcnt lgkmcnt(4)
    v_mfma_f32_16x16x32_bf16 v[180:183], v[72:75], v[44:47], v[180:183]
    buffer_load_dwordx4 v8, s[8:11], s55 offen offset:2048  lds
    v_mfma_f32_16x16x32_bf16 v[112:115], v[76:79], v[32:35], v[112:115]
    ds_read_b128 v[52:55], v13 offset:18944
    v_mfma_f32_16x16x32_bf16 v[136:139], v[76:79], v[36:39], v[136:139]
    ds_read_b64_tr_b16 v[66:67], v17 offset:512
    v_mfma_f32_16x16x32_bf16 v[160:163], v[76:79], v[40:43], v[160:163]
    buffer_load_dwordx4 v9, s[8:11], s55 offen offset:3072  lds
    s_waitcnt lgkmcnt(4)
    v_mfma_f32_16x16x32_bf16 v[184:187], v[76:79], v[44:47], v[184:187]
    ds_read_b128 v[56:59], v13 offset:20992
    s_add_u32 m0, s52, 50688
    v_mfma_f32_16x16x32_bf16 v[116:119], v[80:83], v[32:35], v[116:119]
    ds_read_b128 v[60:63], v13 offset:23040
    s_add_u32 s54, s54, 110592
    v_mfma_f32_16x16x32_bf16 v[140:143], v[80:83], v[36:39], v[140:143]
    ds_read_b64_tr_b16 v[68:69], v17 offset:32
    v_mfma_f32_16x16x32_bf16 v[164:167], v[80:83], v[40:43], v[164:167]
    buffer_load_dwordx4 v2, s[44:47], s54 offen offset:0  lds
    v_mfma_f32_16x16x32_bf16 v[188:191], v[80:83], v[44:47], v[188:191]
    ds_read_b64_tr_b16 v[70:71], v17 offset:544
    s_waitcnt lgkmcnt(2)
    v_mfma_f32_16x16x32_bf16 v[96:99], v[64:67], v[48:51], v[96:99]
    ds_read_b64_tr_b16 v[72:73], v17 offset:64
    buffer_load_dword v252, v26, s[40:43], 0 offen sc1
    v_mfma_f32_16x16x32_bf16 v[120:123], v[64:67], v[52:55], v[120:123]
    ds_read_b64_tr_b16 v[74:75], v17 offset:576
    v_mfma_f32_16x16x32_bf16 v[144:147], v[64:67], v[56:59], v[144:147]
    buffer_load_dwordx4 v3, s[44:47], s54 offen offset:1056  lds
    v_mfma_f32_16x16x32_bf16 v[168:171], v[64:67], v[60:63], v[168:171]
    ds_read_b64_tr_b16 v[76:77], v17 offset:96
    s_waitcnt lgkmcnt(3)
    v_mfma_f32_16x16x32_bf16 v[100:103], v[68:71], v[48:51], v[100:103]
    ds_read_b64_tr_b16 v[78:79], v17 offset:608
    v_mfma_f32_16x16x32_bf16 v[124:127], v[68:71], v[52:55], v[124:127]
    ds_read_b64_tr_b16 v[80:81], v17 offset:128
    v_mfma_f32_16x16x32_bf16 v[148:151], v[68:71], v[56:59], v[148:151]
    buffer_load_dwordx4 v4, s[44:47], s54 offen offset:2112  lds
    v_mfma_f32_16x16x32_bf16 v[172:175], v[68:71], v[60:63], v[172:175]
    ds_read_b64_tr_b16 v[82:83], v17 offset:640
    s_waitcnt lgkmcnt(4)
    v_mfma_f32_16x16x32_bf16 v[104:107], v[72:75], v[48:51], v[104:107]
    ds_read_b64_tr_b16 v[64:65], v17 offset:160
    v_mfma_f32_16x16x32_bf16 v[128:131], v[72:75], v[52:55], v[128:131]
    ds_read_b64_tr_b16 v[66:67], v17 offset:672
    v_mfma_f32_16x16x32_bf16 v[152:155], v[72:75], v[56:59], v[152:155]
    buffer_load_dwordx4 v5, s[44:47], s54 offen offset:3168  lds
    v_mfma_f32_16x16x32_bf16 v[176:179], v[72:75], v[60:63], v[176:179]
    s_waitcnt lgkmcnt(4)
    v_mfma_f32_16x16x32_bf16 v[108:111], v[76:79], v[48:51], v[108:111]
    s_waitcnt vmcnt(13)
    s_barrier
    v_mfma_f32_16x16x32_bf16 v[132:135], v[76:79], v[52:55], v[132:135]
    ds_read_b128 v[32:35], v12 offset:33792
    s_add_u32 m0, s52, 67584
    v_mfma_f32_16x16x32_bf16 v[156:159], v[76:79], v[56:59], v[156:159]
    ds_read_b64_tr_b16 v[68:69], v17 offset:16896
    s_add_u32 s54, s54, 110592
    v_mfma_f32_16x16x32_bf16 v[180:183], v[76:79], v[60:63], v[180:183]
    ds_read_b128 v[36:39], v12 offset:35840
    s_waitcnt lgkmcnt(5)
    v_mfma_f32_16x16x32_bf16 v[112:115], v[80:83], v[48:51], v[112:115]
    buffer_load_dwordx4 v2, s[44:47], s54 offen offset:0  lds
    v_mfma_f32_16x16x32_bf16 v[136:139], v[80:83], v[52:55], v[136:139]
    ds_read_b64_tr_b16 v[70:71], v17 offset:17408
    v_mfma_f32_16x16x32_bf16 v[160:163], v[80:83], v[56:59], v[160:163]
    ds_read_b128 v[40:43], v12 offset:37888
    s_waitcnt lgkmcnt(5)
    v_mfma_f32_16x16x32_bf16 v[184:187], v[80:83], v[60:63], v[184:187]
    ds_read_b128 v[44:47], v12 offset:39936
    v_mfma_f32_16x16x32_bf16 v[116:119], v[64:67], v[48:51], v[116:119]
    v_mfma_f32_16x16x32_bf16 v[140:143], v[64:67], v[52:55], v[140:143]
    buffer_load_dwordx4 v3, s[44:47], s54 offen offset:1056  lds
    v_mfma_f32_16x16x32_bf16 v[164:167], v[64:67], v[56:59], v[164:167]
    ds_read_b64_tr_b16 v[72:73], v17 offset:16928
    s_waitcnt lgkmcnt(1)
    v_mfma_f32_16x16x32_bf16 v[188:191], v[64:67], v[60:63], v[188:191]
    ds_read_b64_tr_b16 v[74:75], v17 offset:17440
    v_mfma_f32_16x16x32_bf16 v[96:99], v[68:71], v[32:35], v[96:99]
    ds_read_b64_tr_b16 v[76:77], v17 offset:16960
    v_mfma_f32_16x16x32_bf16 v[120:123], v[68:71], v[36:39], v[120:123]
    ds_read_b64_tr_b16 v[78:79], v17 offset:17472
    v_mfma_f32_16x16x32_bf16 v[144:147], v[68:71], v[40:43], v[144:147]
    ds_read_b64_tr_b16 v[80:81], v17 offset:16992
    s_waitcnt lgkmcnt(3)
    v_mfma_f32_16x16x32_bf16 v[168:171], v[68:71], v[44:47], v[168:171]
    buffer_load_dwordx4 v4, s[44:47], s54 offen offset:2112  lds
    v_mfma_f32_16x16x32_bf16 v[100:103], v[72:75], v[32:35], v[100:103]
    v_mfma_f32_16x16x32_bf16 v[124:127], v[72:75], v[36:39], v[124:127]
    ds_read_b64_tr_b16 v[82:83], v17 offset:17504
    v_mfma_f32_16x16x32_bf16 v[148:151], v[72:75], v[40:43], v[148:151]
    ds_read_b64_tr_b16 v[64:65], v17 offset:17024
    s_waitcnt lgkmcnt(3)
    v_mfma_f32_16x16x32_bf16 v[172:175], v[72:75], v[44:47], v[172:175]
    ds_read_b64_tr_b16 v[66:67], v17 offset:17536
    v_mfma_f32_16x16x32_bf16 v[104:107], v[76:79], v[32:35], v[104:107]
    ds_read_b64_tr_b16 v[68:69], v17 offset:17056
    v_mfma_f32_16x16x32_bf16 v[128:131], v[76:79], v[36:39], v[128:131]
    buffer_load_dwordx4 v5, s[44:47], s54 offen offset:3168  lds
    v_mfma_f32_16x16x32_bf16 v[152:155], v[76:79], v[40:43], v[152:155]
    ds_read_b64_tr_b16 v[70:71], v17 offset:17568
    s_waitcnt lgkmcnt(4)
    v_mfma_f32_16x16x32_bf16 v[176:179], v[76:79], v[44:47], v[176:179]
    v_mfma_f32_16x16x32_bf16 v[108:111], v[80:83], v[32:35], v[108:111]
    s_waitcnt vmcnt(13)
    s_barrier
    v_mfma_f32_16x16x32_bf16 v[132:135], v[80:83], v[36:39], v[132:135]
    ds_read_b128 v[48:51], v13 offset:33792
    s_add_u32 m0, s66, 0
    v_mfma_f32_16x16x32_bf16 v[156:159], v[80:83], v[40:43], v[156:159]
    ds_read_b64_tr_b16 v[72:73], v17 offset:33792
    buffer_load_dwordx4 v240, s[20:23], s67 offen offset:0 lds
    v_mfma_f32_16x16x32_bf16 v[180:183], v[80:83], v[44:47], v[180:183]
    ds_read_b128 v[52:55], v13 offset:35840
    s_waitcnt lgkmcnt(5)
    v_mfma_f32_16x16x32_bf16 v[112:115], v[64:67], v[32:35], v[112:115]
    v_mfma_f32_16x16x32_bf16 v[136:139], v[64:67], v[36:39], v[136:139]
    ds_read_b64_tr_b16 v[74:75], v17 offset:34304
    buffer_load_dwordx4 v241, s[20:23], s67 offen offset:1024 lds
    v_mfma_f32_16x16x32_bf16 v[160:163], v[64:67], v[40:43], v[160:163]
    ds_read_b128 v[56:59], v13 offset:37888
    s_waitcnt lgkmcnt(5)
    v_mfma_f32_16x16x32_bf16 v[184:187], v[64:67], v[44:47], v[184:187]
    v_mfma_f32_16x16x32_bf16 v[116:119], v[68:71], v[32:35], v[116:119]
    ds_read_b128 v[60:63], v13 offset:39936
    buffer_load_dwordx4 v242, s[20:23], s67 offen offset:2048 lds
    v_mfma_f32_16x16x32_bf16 v[140:143], v[68:71], v[36:39], v[140:143]
    ds_read_b64_tr_b16 v[76:77], v17 offset:33824
    v_mfma_f32_16x16x32_bf16 v[164:167], v[68:71], v[40:43], v[164:167]
    s_waitcnt lgkmcnt(1)
    v_mfma_f32_16x16x32_bf16 v[188:191], v[68:71], v[44:47], v[188:191]
    ds_read_b64_tr_b16 v[78:79], v17 offset:34336
    buffer_load_dwordx4 v243, s[20:23], s67 offen offset:3072 lds
    v_mfma_f32_16x16x32_bf16 v[96:99], v[72:75], v[48:51], v[96:99]
    ds_read_b64_tr_b16 v[80:81], v17 offset:33856
    s_add_u32 m0, s66, 16896
    v_mfma_f32_16x16x32_bf16 v[120:123], v[72:75], v[52:55], v[120:123]
    ds_read_b64_tr_b16 v[82:83], v17 offset:34368
    s_add_u32 s67, s67, 40960
    v_mfma_f32_16x16x32_bf16 v[144:147], v[72:75], v[56:59], v[144:147]
    buffer_load_dwordx4 v240, s[20:23], s67 offen offset:0 lds
    v_mfma_f32_16x16x32_bf16 v[168:171], v[72:75], v[60:63], v[168:171]
    ds_read_b64_tr_b16 v[64:65], v17 offset:33888
    s_waitcnt lgkmcnt(3)
    v_mfma_f32_16x16x32_bf16 v[100:103], v[76:79], v[48:51], v[100:103]
    ds_read_b64_tr_b16 v[66:67], v17 offset:34400
    buffer_load_dwordx4 v241, s[20:23], s67 offen offset:1024 lds
    v_mfma_f32_16x16x32_bf16 v[124:127], v[76:79], v[52:55], v[124:127]
    v_mfma_f32_16x16x32_bf16 v[148:151], v[76:79], v[56:59], v[148:151]
    ds_read_b64_tr_b16 v[68:69], v17 offset:33920
    s_waitcnt lgkmcnt(3)
    v_mfma_f32_16x16x32_bf16 v[172:175], v[76:79], v[60:63], v[172:175]
    ds_read_b64_tr_b16 v[70:71], v17 offset:34432
    buffer_load_dwordx4 v242, s[20:23], s67 offen offset:2048 lds
    v_mfma_f32_16x16x32_bf16 v[104:107], v[80:83], v[48:51], v[104:107]
    v_mfma_f32_16x16x32_bf16 v[128:131], v[80:83], v[52:55], v[128:131]
    ds_read_b64_tr_b16 v[72:73], v17 offset:33952
    v_mfma_f32_16x16x32_bf16 v[152:155], v[80:83], v[56:59], v[152:155]
    ds_read_b64_tr_b16 v[74:75], v17 offset:34464
    buffer_load_dwordx4 v243, s[20:23], s67 offen offset:3072 lds
    v_mfma_f32_16x16x32_bf16 v[176:179], v[80:83], v[60:63], v[176:179]
    s_waitcnt lgkmcnt(4)
    v_mfma_f32_16x16x32_bf16 v[108:111], v[64:67], v[48:51], v[108:111]
    s_waitcnt vmcnt(12)
    s_barrier
    v_mfma_f32_16x16x32_bf16 v[132:135], v[64:67], v[52:55], v[132:135]
    ds_read_b128 v[32:35], v12 offset:0
    s_add_u32 m0, s66, 33792
    v_mfma_f32_16x16x32_bf16 v[156:159], v[64:67], v[56:59], v[156:159]
    ds_read_b64_tr_b16 v[76:77], v18 offset:0
    s_add_u32 s67, s67, 40960
    v_mfma_f32_16x16x32_bf16 v[180:183], v[64:67], v[60:63], v[180:183]
    ds_read_b128 v[36:39], v12 offset:2048
    s_waitcnt lgkmcnt(5)
    v_mfma_f32_16x16x32_bf16 v[112:115], v[68:71], v[48:51], v[112:115]
    buffer_load_dwordx4 v240, s[20:23], s67 offen offset:0 lds
    v_mfma_f32_16x16x32_bf16 v[136:139], v[68:71], v[52:55], v[136:139]
    ds_read_b64_tr_b16 v[78:79], v18 offset:512
    v_mfma_f32_16x16x32_bf16 v[160:163], v[68:71], v[56:59], v[160:163]
    ds_read_b128 v[40:43], v12 offset:4096
    s_waitcnt lgkmcnt(5)
    v_mfma_f32_16x16x32_bf16 v[184:187], v[68:71], v[60:63], v[184:187]
    ds_read_b128 v[44:47], v12 offset:6144
    v_mfma_f32_16x16x32_bf16 v[116:119], v[72:75], v[48:51], v[116:119]
    v_mfma_f32_16x16x32_bf16 v[140:143], v[72:75], v[52:55], v[140:143]
    buffer_load_dwordx4 v241, s[20:23], s67 offen offset:1024 lds
    v_mfma_f32_16x16x32_bf16 v[164:167], v[72:75], v[56:59], v[164:167]
    ds_read_b64_tr_b16 v[80:81], v18 offset:32
    s_waitcnt lgkmcnt(1)
    v_mfma_f32_16x16x32_bf16 v[188:191], v[72:75], v[60:63], v[188:191]
    ds_read_b64_tr_b16 v[82:83], v18 offset:544
    v_mfma_f32_16x16x32_bf16 v[96:99], v[76:79], v[32:35], v[96:99]
    ds_read_b64_tr_b16 v[64:65], v18 offset:64
    v_mfma_f32_16x16x32_bf16 v[120:123], v[76:79], v[36:39], v[120:123]
    ds_read_b64_tr_b16 v[66:67], v18 offset:576
    v_mfma_f32_16x16x32_bf16 v[144:147], v[76:79], v[40:43], v[144:147]
    ds_read_b64_tr_b16 v[68:69], v18 offset:96
    s_waitcnt lgkmcnt(3)
    v_mfma_f32_16x16x32_bf16 v[168:171], v[76:79], v[44:47], v[168:171]
    buffer_load_dwordx4 v242, s[20:23], s67 offen offset:2048 lds
    v_mfma_f32_16x16x32_bf16 v[100:103], v[80:83], v[32:35], v[100:103]
    v_cmp_gt_u32 vcc, 15, v252
    s_nop 0
    s_cbranch_vccz F_poll1_ok
    s_mov_b32 s3, 0
F_poll1_spin:
    s_add_u32 s3, s3, 1
    s_cmp_gt_u32 s3, 0x8000
    s_cbranch_scc1 F_poll1_ok
    s_sleep 1
    buffer_load_dword v252, v26, s[40:43], 0 offen sc1
    s_waitcnt vmcnt(0)
    v_cmp_gt_u32 vcc, 15, v252
    s_nop 0
    s_cbranch_vccnz F_poll1_spin
F_poll1_ok:
    v_mfma_f32_16x16x32_bf16 v[124:127], v[80:83], v[36:39], v[124:127]
    ds_read_b64_tr_b16 v[70:71], v18 offset:608
    v_mfma_f32_16x16x32_bf16 v[148:151], v[80:83], v[40:43], v[148:151]
    ds_read_b64_tr_b16 v[72:73], v18 offset:128
    s_waitcnt lgkmcnt(3)
    v_mfma_f32_16x16x32_bf16 v[172:175], v[80:83], v[44:47], v[172:175]
    ds_read_b64_tr_b16 v[74:75], v18 offset:640
    v_mfma_f32_16x16x32_bf16 v[104:107], v[64:67], v[32:35], v[104:107]
    ds_read_b64_tr_b16 v[76:77], v18 offset:160
    v_mfma_f32_16x16x32_bf16 v[128:131], v[64:67], v[36:39], v[128:131]
    buffer_load_dwordx4 v243, s[20:23], s67 offen offset:3072 lds
    v_mfma_f32_16x16x32_bf16 v[152:155], v[64:67], v[40:43], v[152:155]
    ds_read_b64_tr_b16 v[78:79], v18 offset:672
    s_waitcnt lgkmcnt(4)
    v_mfma_f32_16x16x32_bf16 v[176:179], v[64:67], v[44:47], v[176:179]
    v_mfma_f32_16x16x32_bf16 v[108:111], v[68:71], v[32:35], v[108:111]
    s_waitcnt vmcnt(12)
    s_barrier
    v_mfma_f32_16x16x32_bf16 v[132:135], v[68:71], v[36:39], v[132:135]
    ds_read_b128 v[48:51], v13 offset:0
    s_add_u32 m0, s66, 50688
    v_mfma_f32_16x16x32_bf16 v[156:159], v[68:71], v[40:43], v[156:159]
    ds_read_b64_tr_b16 v[80:81], v18 offset:16896
    s_add_u32 s67, s67, 40960
    v_mfma_f32_16x16x32_bf16 v[180:183], v[68:71], v[44:47], v[180:183]
    ds_read_b128 v[52:55], v13 offset:2048
    s_waitcnt lgkmcnt(5)
    v_mfma_f32_16x16x32_bf16 v[112:115], v[72:75], v[32:35], v[112:115]
    buffer_load_dwordx4 v240, s[20:23], s67 offen offset:0 lds
    v_mfma_f32_16x16x32_bf16 v[136:139], v[72:75], v[36:39], v[136:139]
    ds_read_b64_tr_b16 v[82:83], v18 offset:17408
    v_mfma_f32_16x16x32_bf16 v[160:163], v[72:75], v[40:43], v[160:163]
    ds_read_b128 v[56:59], v13 offset:4096
    s_waitcnt lgkmcnt(5)
    v_mfma_f32_16x16x32_bf16 v[184:187], v[72:75], v[44:47], v[184:187]
    ds_read_b128 v[60:63], v13 offset:6144
    v_mfma_f32_16x16x32_bf16 v[116:119], v[76:79], v[32:35], v[116:119]
    v_mfma_f32_16x16x32_bf16 v[140:143], v[76:79], v[36:39], v[140:143]
    buffer_load_dwordx4 v241, s[20:23], s67 offen offset:1024 lds
    v_mfma_f32_16x16x32_bf16 v[164:167], v[76:79], v[40:43], v[164:167]
    ds_read_b64_tr_b16 v[64:65], v18 offset:16928
    s_waitcnt lgkmcnt(1)
    v_mfma_f32_16x16x32_bf16 v[188:191], v[76:79], v[44:47], v[188:191]
    ds_read_b64_tr_b16 v[66:67], v18 offset:17440
    v_mfma_f32_16x16x32_bf16 v[96:99], v[80:83], v[48:51], v[96:99]
    ds_read_b64_tr_b16 v[68:69], v18 offset:16960
    v_mfma_f32_16x16x32_bf16 v[120:123], v[80:83], v[52:55], v[120:123]
    ds_read_b64_tr_b16 v[70:71], v18 offset:17472
    v_mfma_f32_16x16x32_bf16 v[144:147], v[80:83], v[56:59], v[144:147]
    ds_read_b64_tr_b16 v[72:73], v18 offset:16992
    s_waitcnt lgkmcnt(3)
    v_mfma_f32_16x16x32_bf16 v[168:171], v[80:83], v[60:63], v[168:171]
    buffer_load_dwordx4 v242, s[20:23], s67 offen offset:2048 lds
    v_mfma_f32_16x16x32_bf16 v[100:103], v[64:67], v[48:51], v[100:103]
    v_mfma_f32_16x16x32_bf16 v[124:127], v[64:67], v[52:55], v[124:127]
    ds_read_b64_tr_b16 v[74:75], v18 offset:17504
    v_mfma_f32_16x16x32_bf16 v[148:151], v[64:67], v[56:59], v[148:151]
    ds_read_b64_tr_b16 v[76:77], v18 offset:17024
    s_waitcnt lgkmcnt(3)
    v_mfma_f32_16x16x32_bf16 v[172:175], v[64:67], v[60:63], v[172:175]
    ds_read_b64_tr_b16 v[78:79], v18 offset:17536
    v_mfma_f32_16x16x32_bf16 v[104:107], v[68:71], v[48:51], v[104:107]
    ds_read_b64_tr_b16 v[80:81], v18 offset:17056
    v_mfma_f32_16x16x32_bf16 v[128:131], v[68:71], v[52:55], v[128:131]
    buffer_load_dwordx4 v243, s[20:23], s67 offen offset:3072 lds
    v_cvt_pk_bf16_f32 v96, v96, v97
    v_cvt_pk_bf16_f32 v97, v98, v99
    v_mfma_f32_16x16x32_bf16 v[152:155], v[68:71], v[56:59], v[152:155]
    ds_read_b64_tr_b16 v[82:83], v18 offset:17568
    s_waitcnt lgkmcnt(4)
    v_mfma_f32_16x16x32_bf16 v[176:179], v[68:71], v[60:63], v[176:179]
    v_cvt_pk_bf16_f32 v98, v100, v101
    v_cvt_pk_bf16_f32 v99, v102, v103
    v_mfma_f32_16x16x32_bf16 v[108:111], v[72:75], v[48:51], v[108:111]
    v_pk_max_i16 v96, v96, 0
    v_pk_max_i16 v97, v97, 0
    v_mfma_f32_16x16x32_bf16 v[132:135], v[72:75], v[52:55], v[132:135]
    v_pk_max_i16 v98, v98, 0
    v_pk_max_i16 v99, v99, 0
    v_mfma_f32_16x16x32_bf16 v[156:159], v[72:75], v[56:59], v[156:159]
    buffer_store_dwordx4 v[96:99], v28, s[16:19], s91 offen offset:0 sc1
    s_waitcnt lgkmcnt(2)
    v_cvt_pk_bf16_f32 v120, v120, v121
    v_cvt_pk_bf16_f32 v121, v122, v123
    v_mfma_f32_16x16x32_bf16 v[180:183], v[72:75], v[60:63], v[180:183]
    v_cvt_pk_bf16_f32 v122, v124, v125
    v_cvt_pk_bf16_f32 v123, v126, v127
    v_mfma_f32_16x16x32_bf16 v[112:115], v[76:79], v[48:51], v[112:115]
    v_pk_max_i16 v120, v120, 0
    v_pk_max_i16 v121, v121, 0
    v_mfma_f32_16x16x32_bf16 v[136:139], v[76:79], v[52:55], v[136:139]
    v_pk_max_i16 v122, v122, 0
    v_pk_max_i16 v123, v123, 0
    v_mfma_f32_16x16x32_bf16 v[160:163], v[76:79], v[56:59], v[160:163]
    buffer_store_dwordx4 v[120:123], v28, s[16:19], s91 offen offset:1024 sc1
    s_waitcnt lgkmcnt(0)
    v_cvt_pk_bf16_f32 v144, v144, v145
    v_cvt_pk_bf16_f32 v145, v146, v147
    v_mfma_f32_16x16x32_bf16 v[184:187], v[76:79], v[60:63], v[184:187]
    v_cvt_pk_bf16_f32 v146, v148, v149
    v_cvt_pk_bf16_f32 v147, v150, v151
    v_mfma_f32_16x16x32_bf16 v[116:119], v[80:83], v[48:51], v[116:119]
    v_pk_max_i16 v144, v144, 0
    v_pk_max_i16 v145, v145, 0
    v_mfma_f32_16x16x32_bf16 v[140:143], v[80:83], v[52:55], v[140:143]
    v_pk_max_i16 v146, v146, 0
    v_pk_max_i16 v147, v147, 0
    v_mfma_f32_16x16x32_bf16 v[164:167], v[80:83], v[56:59], v[164:167]
    buffer_store_dwordx4 v[144:147], v28, s[16:19], s91 offen offset:2048 sc1
    v_mfma_f32_16x16x32_bf16 v[188:191], v[80:83], v[60:63], v[188:191]
    v_cvt_pk_bf16_f32 v168, v168, v169
    v_cvt_pk_bf16_f32 v169, v170, v171
    v_cvt_pk_bf16_f32 v170, v172, v173
    v_cvt_pk_bf16_f32 v171, v174, v175
    v_pk_max_i16 v168, v168, 0
    v_pk_max_i16 v169, v169, 0
    v_pk_max_i16 v170, v170, 0
    v_pk_max_i16 v171, v171, 0
    buffer_store_dwordx4 v[168:171], v28, s[16:19], s91 offen offset:3072 sc1
    v_cvt_pk_bf16_f32 v104, v104, v105
    v_cvt_pk_bf16_f32 v105, v106, v107
    v_cvt_pk_bf16_f32 v106, v108, v109
    v_cvt_pk_bf16_f32 v107, v110, v111
    v_pk_max_i16 v104, v104, 0
    v_pk_max_i16 v105, v105, 0
    v_pk_max_i16 v106, v106, 0
    v_pk_max_i16 v107, v107, 0
    buffer_store_dwordx4 v[104:107], v28, s[16:19], s92 offen offset:0 sc1
    v_cvt_pk_bf16_f32 v128, v128, v129
    v_cvt_pk_bf16_f32 v129, v130, v131
    v_cvt_pk_bf16_f32 v130, v132, v133
    v_cvt_pk_bf16_f32 v131, v134, v135
    v_pk_max_i16 v128, v128, 0
    v_pk_max_i16 v129, v129, 0
    v_pk_max_i16 v130, v130, 0
    v_pk_max_i16 v131, v131, 0
    buffer_store_dwordx4 v[128:131], v28, s[16:19], s92 offen offset:1024 sc1
    v_cvt_pk_bf16_f32 v152, v152, v153
    v_cvt_pk_bf16_f32 v153, v154, v155
    v_cvt_pk_bf16_f32 v154, v156, v157
    v_cvt_pk_bf16_f32 v155, v158, v159
    v_pk_max_i16 v152, v152, 0
    v_pk_max_i16 v153, v153, 0
    v_pk_max_i16 v154, v154, 0
    v_pk_max_i16 v155, v155, 0
    buffer_store_dwordx4 v[152:155], v28, s[16:19], s92 offen offset:2048 sc1
    v_cvt_pk_bf16_f32 v176, v176, v177
    v_cvt_pk_bf16_f32 v177, v178, v179
    v_cvt_pk_bf16_f32 v178, v180, v181
    v_cvt_pk_bf16_f32 v179, v182, v183
    v_pk_max_i16 v176, v176, 0
    v_pk_max_i16 v177, v177, 0
    v_pk_max_i16 v178, v178, 0
    v_pk_max_i16 v179, v179, 0
    buffer_store_dwordx4 v[176:179], v28, s[16:19], s92 offen offset:3072 sc1
    v_cvt_pk_bf16_f32 v112, v112, v113
    v_cvt_pk_bf16_f32 v113, v114, v115
    v_cvt_pk_bf16_f32 v114, v116, v117
    v_cvt_pk_bf16_f32 v115, v118, v119
    v_pk_max_i16 v112, v112, 0
    v_pk_max_i16 v113, v113, 0
    v_pk_max_i16 v114, v114, 0
    v_pk_max_i16 v115, v115, 0
    buffer_store_dwordx4 v[112:115], v28, s[16:19], s93 offen offset:0 sc1
    v_cvt_pk_bf16_f32 v136, v136, v137
    v_cvt_pk_bf16_f32 v137, v138, v139
    v_cvt_pk_bf16_f32 v138, v140, v141
    v_cvt_pk_bf16_f32 v139, v142, v143
    v_pk_max_i16 v136, v136, 0
    v_pk_max_i16 v137, v137, 0
    v_pk_max_i16 v138, v138, 0
    v_pk_max_i16 v139, v139, 0
    buffer_store_dwordx4 v[136:139], v28, s[16:19], s93 offen offset:1024 sc1
    v_cvt_pk_bf16_f32 v160, v160, v161
    v_cvt_pk_bf16_f32 v161, v162, v163
    v_cvt_pk_bf16_f32 v162, v164, v165
    v_cvt_pk_bf16_f32 v163, v166, v167
    v_pk_max_i16 v160, v160, 0
    v_pk_max_i16 v161, v161, 0
    v_pk_max_i16 v162, v162, 0
    v_pk_max_i16 v163, v163, 0
    buffer_store_dwordx4 v[160:163], v28, s[16:19], s93 offen offset:2048 sc1
    v_cvt_pk_bf16_f32 v184, v184, v185
    v_cvt_pk_bf16_f32 v185, v186, v187
    v_cvt_pk_bf16_f32 v186, v188, v189
    v_cvt_pk_bf16_f32 v187, v190, v191
    v_pk_max_i16 v184, v184, 0
    v_pk_max_i16 v185, v185, 0
    v_pk_max_i16 v186, v186, 0
    v_pk_max_i16 v187, v187, 0
    buffer_store_dwordx4 v[184:187], v28, s[16:19], s93 offen offset:3072 sc1
L_post:
    s_barrier
    v_add_u32 v20, 67584, v245
    v_add_u32 v21, 67584, v246
    v_add_u32 v22, 67584, v247
    v_add_u32 v23, 67584, v248
    s_add_u32 m0, s66, 67584
    s_add_u32 s67, s67, 40960
    buffer_load_dwordx4 v240, s[20:23], s67 offen offset:0 lds
    buffer_load_dwordx4 v241, s[20:23], s67 offen offset:1024 lds
    buffer_load_dwordx4 v242, s[20:23], s67 offen offset:2048 lds
    buffer_load_dwordx4 v243, s[20:23], s67 offen offset:3072 lds
    s_add_u32 m0, s66, 84480
    s_add_u32 s67, s67, 40960
    buffer_load_dwordx4 v240, s[20:23], s67 offen offset:0 lds
    buffer_load_dwordx4 v241, s[20:23], s67 offen offset:1024 lds
    buffer_load_dwordx4 v242, s[20:23], s67 offen offset:2048 lds
    buffer_load_dwordx4 v243, s[20:23], s67 offen offset:3072 lds
    s_lshl_b32 s60, s64, 10
    v_lshl_add_u32 v11, v1, 4, s60
    v_add_u32 v12, 4096, v11
    v_lshl_add_u32 v13, v1, 3, s60
    v_add_u32 v14, 4096, v13
    v_and_b32 v24, 15, v1
    v_lshrrev_b32 v25, 4, v1
    v_and_b32 v26, 7, v1
    v_xor_b32 v26, v26, v25
    v_lshl_add_u32 v27, v24, 8, s66
    v_lshl_add_u32 v15, v26, 4, v27
    v_xor_b32 v26, 4, v26
    v_lshl_add_u32 v16, v26, 4, v27
    s_lshl_b32 s60, s48, 2
    v_add_u32 v26, s60, v25
    v_and_b32 v27, 7, v26
    v_xor_b32 v27, v27, v24
    v_lshlrev_b32 v27, 4, v27
    v_lshl_add_u32 v17, v26, 8, v27
    s_lshl_b32 s60, s64, 4
    v_add_u32 v26, s60, v26
    v_mul_u32_u24 v26, 1280, v26
    s_lshl_b32 s60, s65, 7
    v_lshl_add_u32 v27, v24, 3, s60
    v_add_u32 v18, v26, v27
    s_lshl_b32 s60, s64, 6
    s_lshl_b32 s61, s48, 13
    s_add_u32 s60, s60, s61
    s_add_u32 s60, s60, 9699328
    v_lshl_add_u32 v19, v24, 2, s60
    s_waitcnt vmcnt(32)
    ds_read_b64_tr_b16 a[0:1], v245 offset:0
    ds_read_b64_tr_b16 a[2:3], v245 offset:2048
    ds_read_b64_tr_b16 a[4:5], v246 offset:0
    ds_read_b64_tr_b16 a[6:7], v246 offset:2048
    ds_read_b64_tr_b16 a[8:9], v247 offset:0
    ds_read_b64_tr_b16 a[10:11], v247 offset:2048
    ds_read_b64_tr_b16 a[12:13], v248 offset:0
    ds_read_b64_tr_b16 a[14:15], v248 offset:2048
    s_waitcnt vmcnt(28)
    ds_read_b64_tr_b16 a[16:17], v245 offset:16896
    ds_read_b64_tr_b16 a[18:19], v245 offset:18944
    ds_read_b64_tr_b16 a[20:21], v246 offset:16896
    ds_read_b64_tr_b16 a[22:23], v246 offset:18944
    ds_read_b64_tr_b16 a[24:25], v247 offset:16896
    ds_read_b64_tr_b16 a[26:27], v247 offset:18944
    ds_read_b64_tr_b16 a[28:29], v248 offset:16896
    ds_read_b64_tr_b16 a[30:31], v248 offset:18944
    s_waitcnt vmcnt(24)
    ds_read_b64_tr_b16 a[32:33], v245 offset:33792
    ds_read_b64_tr_b16 a[34:35], v245 offset:35840
    ds_read_b64_tr_b16 a[36:37], v246 offset:33792
    ds_read_b64_tr_b16 a[38:39], v246 offset:35840
    ds_read_b64_tr_b16 a[40:41], v247 offset:33792
    ds_read_b64_tr_b16 a[42:43], v247 offset:35840
    ds_read_b64_tr_b16 a[44:45], v248 offset:33792
    ds_read_b64_tr_b16 a[46:47], v248 offset:35840
    s_waitcnt vmcnt(20)
    ds_read_b64_tr_b16 a[48:49], v245 offset:50688
    ds_read_b64_tr_b16 a[50:51], v245 offset:52736
    ds_read_b64_tr_b16 a[52:53], v246 offset:50688
    ds_read_b64_tr_b16 a[54:55], v246 offset:52736
    ds_read_b64_tr_b16 a[56:57], v247 offset:50688
    ds_read_b64_tr_b16 a[58:59], v247 offset:52736
    ds_read_b64_tr_b16 a[60:61], v248 offset:50688
    ds_read_b64_tr_b16 a[62:63], v248 offset:52736
    v_mov_b32 v25, 1
    s_waitcnt vmcnt(8)
    buffer_store_dword v25, v251, s[16:19], 0 offen sc1
    s_add_u32 m0, s66, 101376
    s_add_u32 s67, s67, 40960
    buffer_load_dwordx4 v240, s[20:23], s67 offen offset:0 lds
    buffer_load_dwordx4 v241, s[20:23], s67 offen offset:1024 lds
    buffer_load_dwordx4 v242, s[20:23], s67 offen offset:2048 lds
    buffer_load_dwordx4 v243, s[20:23], s67 offen offset:3072 lds
    s_add_u32 m0, s66, 118272
    s_add_u32 s67, s67, s88
    buffer_load_dwordx4 v240, s[20:23], s67 offen offset:0 lds
    buffer_load_dwordx4 v241, s[20:23], s67 offen offset:1024 lds
    buffer_load_dwordx4 v242, s[20:23], s67 offen offset:2048 lds
    buffer_load_dwordx4 v243, s[20:23], s67 offen offset:3072 lds
    s_waitcnt lgkmcnt(15)
    s_add_u32 m0, s66, 0
    s_add_u32 s67, s67, 40960
    buffer_load_dwordx4 v240, s[20:23], s67 offen offset:0 lds
    buffer_load_dwordx4 v241, s[20:23], s67 offen offset:1024 lds
    buffer_load_dwordx4 v242, s[20:23], s67 offen offset:2048 lds
    buffer_load_dwordx4 v243, s[20:23], s67 offen offset:3072 lds
    s_add_u32 m0, s66, 16896
    s_add_u32 s67, s67, 40960
    buffer_load_dwordx4 v240, s[20:23], s67 offen offset:0 lds
    buffer_load_dwordx4 v241, s[20:23], s67 offen offset:1024 lds
    buffer_load_dwordx4 v242, s[20:23], s67 offen offset:2048 lds
    buffer_load_dwordx4 v243, s[20:23], s67 offen offset:3072 lds
    s_waitcnt lgkmcnt(8)
    s_add_u32 m0, s66, 33792
    s_add_u32 s67, s67, 40960
    buffer_load_dwordx4 v240, s[20:23], s67 offen offset:0 lds
    buffer_load_dwordx4 v241, s[20:23], s67 offen offset:1024 lds
    buffer_load_dwordx4 v242, s[20:23], s67 offen offset:2048 lds
    buffer_load_dwordx4 v243, s[20:23], s67 offen offset:3072 lds
    s_waitcnt lgkmcnt(0)
    s_add_u32 m0, s66, 50688
    s_add_u32 s67, s67, 40960
    buffer_load_dwordx4 v240, s[20:23], s67 offen offset:0 lds
    buffer_load_dwordx4 v241, s[20:23], s67 offen offset:1024 lds
    buffer_load_dwordx4 v242, s[20:23], s67 offen offset:2048 lds
    buffer_load_dwordx4 v243, s[20:23], s67 offen offset:3072 lds
    s_waitcnt vmcnt(29)
    ds_read_b64_tr_b16 a[64:65], v20 offset:0
    ds_read_b64_tr_b16 a[66:67], v20 offset:2048
    ds_read_b64_tr_b16 a[68:69], v21 offset:0
    ds_read_b64_tr_b16 a[70:71], v21 offset:2048
    ds_read_b64_tr_b16 a[72:73], v22 offset:0
    ds_read_b64_tr_b16 a[74:75], v22 offset:2048
    ds_read_b64_tr_b16 a[76:77], v23 offset:0
    ds_read_b64_tr_b16 a[78:79], v23 offset:2048
    s_waitcnt lgkmcnt(0)
    s_add_u32 m0, s66, 67584
    s_add_u32 s67, s67, 40960
    buffer_load_dwordx4 v240, s[20:23], s67 offen offset:0 lds
    buffer_load_dwordx4 v241, s[20:23], s67 offen offset:1024 lds
    buffer_load_dwordx4 v242, s[20:23], s67 offen offset:2048 lds
    buffer_load_dwordx4 v243, s[20:23], s67 offen offset:3072 lds
    s_waitcnt vmcnt(29)
    ds_read_b64_tr_b16 a[80:81], v20 offset:16896
    ds_read_b64_tr_b16 a[82:83], v20 offset:18944
    ds_read_b64_tr_b16 a[84:85], v21 offset:16896
    ds_read_b64_tr_b16 a[86:87], v21 offset:18944
    ds_read_b64_tr_b16 a[88:89], v22 offset:16896
    ds_read_b64_tr_b16 a[90:91], v22 offset:18944
    ds_read_b64_tr_b16 a[92:93], v23 offset:16896
    ds_read_b64_tr_b16 a[94:95], v23 offset:18944
    s_waitcnt lgkmcnt(0)
    s_add_u32 m0, s66, 84480
    s_add_u32 s67, s67, 40960
    buffer_load_dwordx4 v240, s[20:23], s67 offen offset:0 lds
    buffer_load_dwordx4 v241, s[20:23], s67 offen offset:1024 lds
    buffer_load_dwordx4 v242, s[20:23], s67 offen offset:2048 lds
    buffer_load_dwordx4 v243, s[20:23], s67 offen offset:3072 lds
    s_waitcnt vmcnt(28)
    ds_read_b64_tr_b16 a[96:97], v20 offset:33792
    ds_read_b64_tr_b16 a[98:99], v20 offset:35840
    ds_read_b64_tr_b16 a[100:101], v21 offset:33792
    ds_read_b64_tr_b16 a[102:103], v21 offset:35840
    ds_read_b64_tr_b16 a[104:105], v22 offset:33792
    ds_read_b64_tr_b16 a[106:107], v22 offset:35840
    ds_read_b64_tr_b16 a[108:109], v23 offset:33792
    ds_read_b64_tr_b16 a[110:111], v23 offset:35840
    s_waitcnt lgkmcnt(0)
    s_add_u32 m0, s66, 101376
    s_add_u32 s67, s69, 0
    buffer_load_dwordx4 v240, s[24:27], s67 offen offset:0 lds
    buffer_load_dwordx4 v241, s[24:27], s67 offen offset:1024 lds
    s_add_u32 s67, s67, 5120
    buffer_load_dwordx4 v242, s[24:27], s67 offen offset:2048 lds
    buffer_load_dwordx4 v243, s[24:27], s67 offen offset:3072 lds
    s_waitcnt vmcnt(28)
    ds_read_b64_tr_b16 a[112:113], v20 offset:50688
    ds_read_b64_tr_b16 a[114:115], v20 offset:52736
    ds_read_b64_tr_b16 a[116:117], v21 offset:50688
    ds_read_b64_tr_b16 a[118:119], v21 offset:52736
    ds_read_b64_tr_b16 a[120:121], v22 offset:50688
    ds_read_b64_tr_b16 a[122:123], v22 offset:52736
    ds_read_b64_tr_b16 a[124:125], v23 offset:50688
    ds_read_b64_tr_b16 a[126:127], v23 offset:52736
    s_waitcnt lgkmcnt(0)
    s_add_u32 m0, s66, 118272
    s_add_u32 s67, s69, 51200
    buffer_load_dwordx4 v240, s[24:27], s67 offen offset:0 lds
    buffer_load_dwordx4 v241, s[24:27], s67 offen offset:1024 lds
    s_add_u32 s67, s67, 5120
    buffer_load_dwordx4 v242, s[24:27], s67 offen offset:2048 lds
    buffer_load_dwordx4 v243, s[24:27], s67 offen offset:3072 lds
    s_waitcnt vmcnt(28)
    ds_read_b64_tr_b16 a[128:129], v245 offset:0
    ds_read_b64_tr_b16 a[130:131], v245 offset:2048
    ds_read_b64_tr_b16 a[132:133], v246 offset:0
    ds_read_b64_tr_b16 a[134:135], v246 offset:2048
    ds_read_b64_tr_b16 a[136:137], v247 offset:0
    ds_read_b64_tr_b16 a[138:139], v247 offset:2048
    ds_read_b64_tr_b16 a[140:141], v248 offset:0
    ds_read_b64_tr_b16 a[142:143], v248 offset:2048
    s_waitcnt lgkmcnt(0)
    s_add_u32 m0, s66, 0
    s_add_u32 s67, s69, 20480
    buffer_load_dwordx4 v244, s[24:27], s67 offen offset:0 lds
    s_add_u32 s67, s69, 70656
    buffer_load_dwordx4 v244, s[24:27], s67 offen offset:1024 lds
    s_add_u32 s67, s69, 120832
    buffer_load_dwordx4 v244, s[24:27], s67 offen offset:2048 lds
    s_add_u32 s67, s69, 171008
    buffer_load_dwordx4 v244, s[24:27], s67 offen offset:3072 lds
    buffer_load_dword v252, v249, s[16:19], 0 offen sc1
    s_waitcnt vmcnt(29)
    ds_read_b64_tr_b16 a[144:145], v245 offset:16896
    ds_read_b64_tr_b16 a[146:147], v245 offset:18944
    ds_read_b64_tr_b16 a[148:149], v246 offset:16896
    ds_read_b64_tr_b16 a[150:151], v246 offset:18944
    ds_read_b64_tr_b16 a[152:153], v247 offset:16896
    ds_read_b64_tr_b16 a[154:155], v247 offset:18944
    ds_read_b64_tr_b16 a[156:157], v248 offset:16896
    ds_read_b64_tr_b16 a[158:159], v248 offset:18944
    s_waitcnt lgkmcnt(0)
    s_add_u32 m0, s66, 16896
    s_add_u32 s67, s69, 102400
    buffer_load_dwordx4 v240, s[24:27], s67 offen offset:0 lds
    buffer_load_dwordx4 v241, s[24:27], s67 offen offset:1024 lds
    s_add_u32 s67, s67, 5120
    buffer_load_dwordx4 v242, s[24:27], s67 offen offset:2048 lds
    buffer_load_dwordx4 v243, s[24:27], s67 offen offset:3072 lds
    s_waitcnt vmcnt(29)
    ds_read_b64_tr_b16 a[160:161], v245 offset:33792
    ds_read_b64_tr_b16 a[162:163], v245 offset:35840
    ds_read_b64_tr_b16 a[164:165], v246 offset:33792
    ds_read_b64_tr_b16 a[166:167], v246 offset:35840
    ds_read_b64_tr_b16 a[168:169], v247 offset:33792
    ds_read_b64_tr_b16 a[170:171], v247 offset:35840
    ds_read_b64_tr_b16 a[172:173], v248 offset:33792
    ds_read_b64_tr_b16 a[174:175], v248 offset:35840
    s_waitcnt lgkmcnt(0)
    s_add_u32 m0, s66, 33792
    s_add_u32 s67, s69, 153600
    buffer_load_dwordx4 v240, s[24:27], s67 offen offset:0 lds
    buffer_load_dwordx4 v241, s[24:27], s67 offen offset:1024 lds
    s_add_u32 s67, s67, 5120
    buffer_load_dwordx4 v242, s[24:27], s67 offen offset:2048 lds
    buffer_load_dwordx4 v243, s[24:27], s67 offen offset:3072 lds
    s_waitcnt vmcnt(29)
    ds_read_b64_tr_b16 a[176:177], v245 offset:50688
    ds_read_b64_tr_b16 a[178:179], v245 offset:52736
    ds_read_b64_tr_b16 a[180:181], v246 offset:50688
    ds_read_b64_tr_b16 a[182:183], v246 offset:52736
    ds_read_b64_tr_b16 a[184:185], v247 offset:50688
    ds_read_b64_tr_b16 a[186:187], v247 offset:52736
    ds_read_b64_tr_b16 a[188:189], v248 offset:50688
    ds_read_b64_tr_b16 a[190:191], v248 offset:52736
    s_waitcnt vmcnt(8)
    v_cmp_gt_u32 vcc, 1, v252
    s_nop 0
    s_cbranch_vccz F_poll2_ok
    s_mov_b32 s3, 0
F_poll2_spin:
    s_add_u32 s3, s3, 1
    s_cmp_gt_u32 s3, 0x8000
    s_cbranch_scc1 F_poll2_ok
    s_sleep 1
    buffer_load_dword v252, v249, s[16:19], 0 offen sc1
    s_waitcnt vmcnt(0)
    v_cmp_gt_u32 vcc, 1, v252
    s_nop 0
    s_cbranch_vccnz F_poll2_spin
F_poll2_ok:
    buffer_load_dwordx4 v[160:163], v11, s[36:39], s68 offen offset:0 sc1
    buffer_load_dwordx4 v[164:167], v11, s[36:39], s68 offen offset:1024 sc1
    buffer_load_dwordx4 v[168:171], v11, s[36:39], s68 offen offset:2048 sc1
    buffer_load_dwordx4 v[172:175], v11, s[36:39], s68 offen offset:3072 sc1
    buffer_load_dwordx4 v[176:179], v12, s[36:39], s68 offen offset:0 sc1
    buffer_load_dwordx4 v[180:183], v12, s[36:39], s68 offen offset:1024 sc1
    buffer_load_dwordx4 v[184:187], v12, s[36:39], s68 offen offset:2048 sc1
    buffer_load_dwordx4 v[188:191], v12, s[36:39], s68 offen offset:3072 sc1
    s_add_u32 s68, s68, 131072
    ds_read_b64_tr_b16 a[192:193], v20 offset:0
    ds_read_b64_tr_b16 a[194:195], v20 offset:2048
    ds_read_b64_tr_b16 a[196:197], v21 offset:0
    ds_read_b64_tr_b16 a[198:199], v21 offset:2048
    ds_read_b64_tr_b16 a[200:201], v22 offset:0
    ds_read_b64_tr_b16 a[202:203], v22 offset:2048
    buffer_load_dwordx4 v[192:195], v11, s[36:39], s68 offen offset:0 sc1
    ds_read_b64_tr_b16 a[204:205], v23 offset:0
    ds_read_b64_tr_b16 a[206:207], v23 offset:2048
    ds_read_b64_tr_b16 a[208:209], v20 offset:16896
    ds_read_b64_tr_b16 a[210:211], v20 offset:18944
    ds_read_b64_tr_b16 a[212:213], v21 offset:16896
    ds_read_b64_tr_b16 a[214:215], v21 offset:18944
    buffer_load_dwordx4 v[196:199], v11, s[36:39], s68 offen offset:1024 sc1
    ds_read_b64_tr_b16 a[216:217], v22 offset:16896
    ds_read_b64_tr_b16 a[218:219], v22 offset:18944
    ds_read_b64_tr_b16 a[220:221], v23 offset:16896
    ds_read_b64_tr_b16 a[222:223], v23 offset:18944
    ds_read_b64_tr_b16 a[224:225], v20 offset:33792
    ds_read_b64_tr_b16 a[226:227], v20 offset:35840
    buffer_load_dwordx4 v[200:203], v11, s[36:39], s68 offen offset:2048 sc1
    ds_read_b64_tr_b16 a[228:229], v21 offset:33792
    ds_read_b64_tr_b16 a[230:231], v21 offset:35840
    ds_read_b64_tr_b16 a[232:233], v22 offset:33792
    ds_read_b64_tr_b16 a[234:235], v22 offset:35840
    ds_read_b64_tr_b16 a[236:237], v23 offset:33792
    ds_read_b64_tr_b16 a[238:239], v23 offset:35840
    buffer_load_dwordx4 v[204:207], v11, s[36:39], s68 offen offset:3072 sc1
    ds_read_b64_tr_b16 a[240:241], v20 offset:50688
    ds_read_b64_tr_b16 a[242:243], v20 offset:52736
    ds_read_b64_tr_b16 a[244:245], v21 offset:50688
    ds_read_b64_tr_b16 a[246:247], v21 offset:52736
    ds_read_b64_tr_b16 a[248:249], v22 offset:50688
    ds_read_b64_tr_b16 a[250:251], v22 offset:52736
    ds_read_b64_tr_b16 a[252:253], v23 offset:50688
    ds_read_b64_tr_b16 a[254:255], v23 offset:52736
    s_waitcnt vmcnt(11)
    v_mfma_f32_16x16x32_bf16 v[32:35], a[0:3], v[160:163], 0
    v_mfma_f32_16x16x32_bf16 v[36:39], a[4:7], v[160:163], 0
    v_mfma_f32_16x16x32_bf16 v[40:43], a[8:11], v[160:163], 0
    v_mfma_f32_16x16x32_bf16 v[44:47], a[12:15], v[160:163], 0
    s_waitcnt vmcnt(10)
    v_mfma_f32_16x16x32_bf16 v[48:51], a[0:3], v[164:167], 0
    buffer_load_dwordx4 v[160:163], v12, s[36:39], s68 offen offset:0 sc1
    v_mfma_f32_16x16x32_bf16 v[52:55], a[4:7], v[164:167], 0
    v_mfma_f32_16x16x32_bf16 v[56:59], a[8:11], v[164:167], 0
    v_mfma_f32_16x16x32_bf16 v[60:63], a[12:15], v[164:167], 0
    s_waitcnt vmcnt(10)
    v_mfma_f32_16x16x32_bf16 v[64:67], a[0:3], v[168:171], 0
    buffer_load_dwordx4 v[164:167], v12, s[36:39], s68 offen offset:1024 sc1
    v_mfma_f32_16x16x32_bf16 v[68:71], a[4:7], v[168:171], 0
    v_mfma_f32_16x16x32_bf16 v[72:75], a[8:11], v[168:171], 0
    v_mfma_f32_16x16x32_bf16 v[76:79], a[12:15], v[168:171], 0
    s_waitcnt vmcnt(10)
    v_mfma_f32_16x16x32_bf16 v[80:83], a[0:3], v[172:175], 0
    buffer_load_dwordx4 v[168:171], v12, s[36:39], s68 offen offset:2048 sc1
    v_mfma_f32_16x16x32_bf16 v[84:87], a[4:7], v[172:175], 0
    v_mfma_f32_16x16x32_bf16 v[88:91], a[8:11], v[172:175], 0
    v_mfma_f32_16x16x32_bf16 v[92:95], a[12:15], v[172:175], 0
    s_waitcnt vmcnt(10)
    v_mfma_f32_16x16x32_bf16 v[96:99], a[0:3], v[176:179], 0
    buffer_load_dwordx4 v[172:175], v12, s[36:39], s68 offen offset:3072 sc1
    v_mfma_f32_16x16x32_bf16 v[100:103], a[4:7], v[176:179], 0
    v_mfma_f32_16x16x32_bf16 v[104:107], a[8:11], v[176:179], 0
    v_mfma_f32_16x16x32_bf16 v[108:111], a[12:15], v[176:179], 0
    s_add_u32 s68, s68, 131072
    s_waitcnt vmcnt(10)
    v_mfma_f32_16x16x32_bf16 v[112:115], a[0:3], v[180:183], 0
    buffer_load_dwordx4 v[176:179], v11, s[36:39], s68 offen offset:0 sc1
    v_mfma_f32_16x16x32_bf16 v[116:119], a[4:7], v[180:183], 0
    v_mfma_f32_16x16x32_bf16 v[120:123], a[8:11], v[180:183], 0
    v_mfma_f32_16x16x32_bf16 v[124:127], a[12:15], v[180:183], 0
    s_waitcnt vmcnt(10)
    v_mfma_f32_16x16x32_bf16 v[128:131], a[0:3], v[184:187], 0
    buffer_load_dwordx4 v[180:183], v11, s[36:39], s68 offen offset:1024 sc1
    v_mfma_f32_16x16x32_bf16 v[132:135], a[4:7], v[184:187], 0
    v_mfma_f32_16x16x32_bf16 v[136:139], a[8:11], v[184:187], 0
    v_mfma_f32_16x16x32_bf16 v[140:143], a[12:15], v[184:187], 0
    s_waitcnt vmcnt(10)
    v_mfma_f32_16x16x32_bf16 v[144:147], a[0:3], v[188:191], 0
    buffer_load_dwordx4 v[184:187], v11, s[36:39], s68 offen offset:2048 sc1
    v_mfma_f32_16x16x32_bf16 v[148:151], a[4:7], v[188:191], 0
    v_mfma_f32_16x16x32_bf16 v[152:155], a[8:11], v[188:191], 0
    v_mfma_f32_16x16x32_bf16 v[156:159], a[12:15], v[188:191], 0
    s_waitcnt vmcnt(10)
    v_mfma_f32_16x16x32_bf16 v[32:35], a[16:19], v[192:195], v[32:35]
    buffer_load_dwordx4 v[188:191], v11, s[36:39], s68 offen offset:3072 sc1
    v_mfma_f32_16x16x32_bf16 v[36:39], a[20:23], v[192:195], v[36:39]
    v_mfma_f32_16x16x32_bf16 v[40:43], a[24:27], v[192:195], v[40:43]
    v_mfma_f32_16x16x32_bf16 v[44:47], a[28:31], v[192:195], v[44:47]
    ds_read_b64_tr_b16 a[0:1], v245 offset:0
    s_waitcnt vmcnt(10)
    v_mfma_f32_16x16x32_bf16 v[48:51], a[16:19], v[196:199], v[48:51]
    buffer_load_dwordx4 v[192:195], v12, s[36:39], s68 offen offset:0 sc1
    v_mfma_f32_16x16x32_bf16 v[52:55], a[20:23], v[196:199], v[52:55]
    v_mfma_f32_16x16x32_bf16 v[56:59], a[24:27], v[196:199], v[56:59]
    v_mfma_f32_16x16x32_bf16 v[60:63], a[28:31], v[196:199], v[60:63]
    ds_read_b64_tr_b16 a[2:3], v245 offset:2048
    s_waitcnt vmcnt(10)
    v_mfma_f32_16x16x32_bf16 v[64:67], a[16:19], v[200:203], v[64:67]
    buffer_load_dwordx4 v[196:199], v12, s[36:39], s68 offen offset:1024 sc1
    v_mfma_f32_16x16x32_bf16 v[68:71], a[20:23], v[200:203], v[68:71]
    v_mfma_f32_16x16x32_bf16 v[72:75], a[24:27], v[200:203], v[72:75]
    ds_read_b64_tr_b16 a[4:5], v246 offset:0
    v_mfma_f32_16x16x32_bf16 v[76:79], a[28:31], v[200:203], v[76:79]
    s_waitcnt vmcnt(10)
    v_mfma_f32_16x16x32_bf16 v[80:83], a[16:19], v[204:207], v[80:83]
    buffer_load_dwordx4 v[200:203], v12, s[36:39], s68 offen offset:2048 sc1
    v_mfma_f32_16x16x32_bf16 v[84:87], a[20:23], v[204:207], v[84:87]
    v_mfma_f32_16x16x32_bf16 v[88:91], a[24:27], v[204:207], v[88:91]
    ds_read_b64_tr_b16 a[6:7], v246 offset:2048
    v_mfma_f32_16x16x32_bf16 v[92:95], a[28:31], v[204:207], v[92:95]
    s_waitcnt vmcnt(10)
    v_mfma_f32_16x16x32_bf16 v[96:99], a[16:19], v[160:163], v[96:99]
    buffer_load_dwordx4 v[204:207], v12, s[36:39], s68 offen offset:3072 sc1
    v_mfma_f32_16x16x32_bf16 v[100:103], a[20:23], v[160:163], v[100:103]
    ds_read_b64_tr_b16 a[8:9], v247 offset:0
    v_mfma_f32_16x16x32_bf16 v[104:107], a[24:27], v[160:163], v[104:107]
    v_mfma_f32_16x16x32_bf16 v[108:111], a[28:31], v[160:163], v[108:111]
    s_add_u32 s68, s68, 131072
    s_waitcnt vmcnt(10)
    v_mfma_f32_16x16x32_bf16 v[112:115], a[16:19], v[164:167], v[112:115]
    buffer_load_dwordx4 v[160:163], v11, s[36:39], s68 offen offset:0 sc1
    v_mfma_f32_16x16x32_bf16 v[116:119], a[20:23], v[164:167], v[116:119]
    ds_read_b64_tr_b16 a[10:11], v247 offset:2048
    v_mfma_f32_16x16x32_bf16 v[120:123], a[24:27], v[164:167], v[120:123]
    v_mfma_f32_16x16x32_bf16 v[124:127], a[28:31], v[164:167], v[124:127]
    s_waitcnt vmcnt(10)
    v_mfma_f32_16x16x32_bf16 v[128:131], a[16:19], v[168:171], v[128:131]
    buffer_load_dwordx4 v[164:167], v11, s[36:39], s68 offen offset:1024 sc1
    v_mfma_f32_16x16x32_bf16 v[132:135], a[20:23], v[168:171], v[132:135]
    ds_read_b64_tr_b16 a[12:13], v248 offset:0
    v_mfma_f32_16x16x32_bf16 v[136:139], a[24:27], v[168:171], v[136:139]
    v_mfma_f32_16x16x32_bf16 v[140:143], a[28:31], v[168:171], v[140:143]
    s_waitcnt vmcnt(10)
    v_mfma_f32_16x16x32_bf16 v[144:147], a[16:19], v[172:175], v[144:147]
    buffer_load_dwordx4 v[168:171], v11, s[36:39], s68 offen offset:2048 sc1
    v_mfma_f32_16x16x32_bf16 v[148:151], a[20:23], v[172:175], v[148:151]
    ds_read_b64_tr_b16 a[14:15], v248 offset:2048
    v_mfma_f32_16x16x32_bf16 v[152:155], a[24:27], v[172:175], v[152:155]
    v_mfma_f32_16x16x32_bf16 v[156:159], a[28:31], v[172:175], v[156:159]
    s_waitcnt vmcnt(10)
    v_mfma_f32_16x16x32_bf16 v[32:35], a[32:35], v[176:179], v[32:35]
    buffer_load_dwordx4 v[172:175], v11, s[36:39], s68 offen offset:3072 sc1
    v_mfma_f32_16x16x32_bf16 v[36:39], a[36:39], v[176:179], v[36:39]
    v_mfma_f32_16x16x32_bf16 v[40:43], a[40:43], v[176:179], v[40:43]
    v_mfma_f32_16x16x32_bf16 v[44:47], a[44:47], v[176:179], v[44:47]
    s_waitcnt vmcnt(10)
    v_mfma_f32_16x16x32_bf16 v[48:51], a[32:35], v[180:183], v[48:51]
    buffer_load_dwordx4 v[176:179], v12, s[36:39], s68 offen offset:0 sc1
    v_mfma_f32_16x16x32_bf16 v[52:55], a[36:39], v[180:183], v[52:55]
    v_mfma_f32_16x16x32_bf16 v[56:59], a[40:43], v[180:183], v[56:59]
    v_mfma_f32_16x16x32_bf16 v[60:63], a[44:47], v[180:183], v[60:63]
    s_waitcnt vmcnt(10)
    v_mfma_f32_16x16x32_bf16 v[64:67], a[32:35], v[184:187], v[64:67]
    buffer_load_dwordx4 v[180:183], v12, s[36:39], s68 offen offset:1024 sc1
    v_mfma_f32_16x16x32_bf16 v[68:71], a[36:39], v[184:187], v[68:71]
    v_mfma_f32_16x16x32_bf16 v[72:75], a[40:43], v[184:187], v[72:75]
    v_mfma_f32_16x16x32_bf16 v[76:79], a[44:47], v[184:187], v[76:79]
    s_waitcnt vmcnt(10)
    v_mfma_f32_16x16x32_bf16 v[80:83], a[32:35], v[188:191], v[80:83]
    buffer_load_dwordx4 v[184:187], v12, s[36:39], s68 offen offset:2048 sc1
    v_mfma_f32_16x16x32_bf16 v[84:87], a[36:39], v[188:191], v[84:87]
    v_mfma_f32_16x16x32_bf16 v[88:91], a[40:43], v[188:191], v[88:91]
    v_mfma_f32_16x16x32_bf16 v[92:95], a[44:47], v[188:191], v[92:95]
    s_waitcnt vmcnt(10)
    v_mfma_f32_16x16x32_bf16 v[96:99], a[32:35], v[192:195], v[96:99]
    buffer_load_dwordx4 v[188:191], v12, s[36:39], s68 offen offset:3072 sc1
    v_mfma_f32_16x16x32_bf16 v[100:103], a[36:39], v[192:195], v[100:103]
    v_mfma_f32_16x16x32_bf16 v[104:107], a[40:43], v[192:195], v[104:107]
    v_mfma_f32_16x16x32_bf16 v[108:111], a[44:47], v[192:195], v[108:111]
    s_add_u32 s68, s68, 131072
    s_waitcnt vmcnt(10)
    v_mfma_f32_16x16x32_bf16 v[112:115], a[32:35], v[196:199], v[112:115]
    buffer_load_dwordx4 v[192:195], v11, s[36:39], s68 offen offset:0 sc1
    v_mfma_f32_16x16x32_bf16 v[116:119], a[36:39], v[196:199], v[116:119]
    v_mfma_f32_16x16x32_bf16 v[120:123], a[40:43], v[196:199], v[120:123]
    v_mfma_f32_16x16x32_bf16 v[124:127], a[44:47], v[196:199], v[124:127]
    s_waitcnt vmcnt(10)
    v_mfma_f32_16x16x32_bf16 v[128:131], a[32:35], v[200:203], v[128:131]
    buffer_load_dwordx4 v[196:199], v11, s[36:39], s68 offen offset:1024 sc1
    v_mfma_f32_16x16x32_bf16 v[132:135], a[36:39], v[200:203], v[132:135]
    v_mfma_f32_16x16x32_bf16 v[136:139], a[40:43], v[200:203], v[136:139]
    v_mfma_f32_16x16x32_bf16 v[140:143], a[44:47], v[200:203], v[140:143]
    s_waitcnt vmcnt(10)
    v_mfma_f32_16x16x32_bf16 v[144:147], a[32:35], v[204:207], v[144:147]
    buffer_load_dwordx4 v[200:203], v11, s[36:39], s68 offen offset:2048 sc1
    v_mfma_f32_16x16x32_bf16 v[148:151], a[36:39], v[204:207], v[148:151]
    v_mfma_f32_16x16x32_bf16 v[152:155], a[40:43], v[204:207], v[152:155]
    v_mfma_f32_16x16x32_bf16 v[156:159], a[44:47], v[204:207], v[156:159]
    s_waitcnt vmcnt(10)
    v_mfma_f32_16x16x32_bf16 v[32:35], a[48:51], v[160:163], v[32:35]
    buffer_load_dwordx4 v[204:207], v11, s[36:39], s68 offen offset:3072 sc1
    v_mfma_f32_16x16x32_bf16 v[36:39], a[52:55], v[160:163], v[36:39]
    v_mfma_f32_16x16x32_bf16 v[40:43], a[56:59], v[160:163], v[40:43]
    v_mfma_f32_16x16x32_bf16 v[44:47], a[60:63], v[160:163], v[44:47]
    s_waitcnt vmcnt(10)
    v_mfma_f32_16x16x32_bf16 v[48:51], a[48:51], v[164:167], v[48:51]
    buffer_load_dwordx4 v[160:163], v12, s[36:39], s68 offen offset:0 sc1
    v_mfma_f32_16x16x32_bf16 v[52:55], a[52:55], v[164:167], v[52:55]
    v_mfma_f32_16x16x32_bf16 v[56:59], a[56:59], v[164:167], v[56:59]
    v_mfma_f32_16x16x32_bf16 v[60:63], a[60:63], v[164:167], v[60:63]
    s_waitcnt vmcnt(10)
    v_mfma_f32_16x16x32_bf16 v[64:67], a[48:51], v[168:171], v[64:67]
    buffer_load_dwordx4 v[164:167], v12, s[36:39], s68 offen offset:1024 sc1
    v_mfma_f32_16x16x32_bf16 v[68:71], a[52:55], v[168:171], v[68:71]
    v_mfma_f32_16x16x32_bf16 v[72:75], a[56:59], v[168:171], v[72:75]
    v_mfma_f32_16x16x32_bf16 v[76:79], a[60:63], v[168:171], v[76:79]
    s_waitcnt vmcnt(10)
    v_mfma_f32_16x16x32_bf16 v[80:83], a[48:51], v[172:175], v[80:83]
    buffer_load_dwordx4 v[168:171], v12, s[36:39], s68 offen offset:2048 sc1
    v_mfma_f32_16x16x32_bf16 v[84:87], a[52:55], v[172:175], v[84:87]
    v_mfma_f32_16x16x32_bf16 v[88:91], a[56:59], v[172:175], v[88:91]
    v_mfma_f32_16x16x32_bf16 v[92:95], a[60:63], v[172:175], v[92:95]
    s_waitcnt vmcnt(10)
    v_mfma_f32_16x16x32_bf16 v[96:99], a[48:51], v[176:179], v[96:99]
    buffer_load_dwordx4 v[172:175], v12, s[36:39], s68 offen offset:3072 sc1
    v_mfma_f32_16x16x32_bf16 v[100:103], a[52:55], v[176:179], v[100:103]
    v_mfma_f32_16x16x32_bf16 v[104:107], a[56:59], v[176:179], v[104:107]
    v_mfma_f32_16x16x32_bf16 v[108:111], a[60:63], v[176:179], v[108:111]
    s_add_u32 s68, s68, 131072
    s_waitcnt vmcnt(10)
    v_mfma_f32_16x16x32_bf16 v[112:115], a[48:51], v[180:183], v[112:115]
    buffer_load_dwordx4 v[176:179], v11, s[36:39], s68 offen offset:0 sc1
    v_mfma_f32_16x16x32_bf16 v[116:119], a[52:55], v[180:183], v[116:119]
    v_mfma_f32_16x16x32_bf16 v[120:123], a[56:59], v[180:183], v[120:123]
    v_mfma_f32_16x16x32_bf16 v[124:127], a[60:63], v[180:183], v[124:127]
    s_waitcnt vmcnt(10)
    v_mfma_f32_16x16x32_bf16 v[128:131], a[48:51], v[184:187], v[128:131]
    buffer_load_dwordx4 v[180:183], v11, s[36:39], s68 offen offset:1024 sc1
    v_mfma_f32_16x16x32_bf16 v[132:135], a[52:55], v[184:187], v[132:135]
    v_mfma_f32_16x16x32_bf16 v[136:139], a[56:59], v[184:187], v[136:139]
    v_mfma_f32_16x16x32_bf16 v[140:143], a[60:63], v[184:187], v[140:143]
    s_waitcnt vmcnt(10)
    v_mfma_f32_16x16x32_bf16 v[144:147], a[48:51], v[188:191], v[144:147]
    buffer_load_dwordx4 v[184:187], v11, s[36:39], s68 offen offset:2048 sc1
    v_mfma_f32_16x16x32_bf16 v[148:151], a[52:55], v[188:191], v[148:151]
    v_mfma_f32_16x16x32_bf16 v[152:155], a[56:59], v[188:191], v[152:155]
    v_mfma_f32_16x16x32_bf16 v[156:159], a[60:63], v[188:191], v[156:159]
    s_waitcnt vmcnt(10)
    v_mfma_f32_16x16x32_bf16 v[32:35], a[64:67], v[192:195], v[32:35]
    buffer_load_dwordx4 v[188:191], v11, s[36:39], s68 offen offset:3072 sc1
    v_mfma_f32_16x16x32_bf16 v[36:39], a[68:71], v[192:195], v[36:39]
    v_mfma_f32_16x16x32_bf16 v[40:43], a[72:75], v[192:195], v[40:43]
    v_mfma_f32_16x16x32_bf16 v[44:47], a[76:79], v[192:195], v[44:47]
    ds_read_b64_tr_b16 a[16:17], v245 offset:16896
    s_waitcnt vmcnt(10)
    v_mfma_f32_16x16x32_bf16 v[48:51], a[64:67], v[196:199], v[48:51]
    buffer_load_dwordx4 v[192:195], v12, s[36:39], s68 offen offset:0 sc1
    v_mfma_f32_16x16x32_bf16 v[52:55], a[68:71], v[196:199], v[52:55]
    v_mfma_f32_16x16x32_bf16 v[56:59], a[72:75], v[196:199], v[56:59]
    v_mfma_f32_16x16x32_bf16 v[60:63], a[76:79], v[196:199], v[60:63]
    ds_read_b64_tr_b16 a[18:19], v245 offset:18944
    s_waitcnt vmcnt(10)
    v_mfma_f32_16x16x32_bf16 v[64:67], a[64:67], v[200:203], v[64:67]
    buffer_load_dwordx4 v[196:199], v12, s[36:39], s68 offen offset:1024 sc1
    v_mfma_f32_16x16x32_bf16 v[68:71], a[68:71], v[200:203], v[68:71]
    v_mfma_f32_16x16x32_bf16 v[72:75], a[72:75], v[200:203], v[72:75]
    ds_read_b64_tr_b16 a[20:21], v246 offset:16896
    v_mfma_f32_16x16x32_bf16 v[76:79], a[76:79], v[200:203], v[76:79]
    s_waitcnt vmcnt(10)
    v_mfma_f32_16x16x32_bf16 v[80:83], a[64:67], v[204:207], v[80:83]
    buffer_load_dwordx4 v[200:203], v12, s[36:39], s68 offen offset:2048 sc1
    v_mfma_f32_16x16x32_bf16 v[84:87], a[68:71], v[204:207], v[84:87]
    v_mfma_f32_16x16x32_bf16 v[88:91], a[72:75], v[204:207], v[88:91]
    ds_read_b64_tr_b16 a[22:23], v246 offset:18944
    v_mfma_f32_16x16x32_bf16 v[92:95], a[76:79], v[204:207], v[92:95]
    s_waitcnt vmcnt(10)
    v_mfma_f32_16x16x32_bf16 v[96:99], a[64:67], v[160:163], v[96:99]
    buffer_load_dwordx4 v[204:207], v12, s[36:39], s68 offen offset:3072 sc1
    v_mfma_f32_16x16x32_bf16 v[100:103], a[68:71], v[160:163], v[100:103]
    ds_read_b64_tr_b16 a[24:25], v247 offset:16896
    v_mfma_f32_16x16x32_bf16 v[104:107], a[72:75], v[160:163], v[104:107]
    v_mfma_f32_16x16x32_bf16 v[108:111], a[76:79], v[160:163], v[108:111]
    s_add_u32 s68, s68, 131072
    s_waitcnt vmcnt(10)
    v_mfma_f32_16x16x32_bf16 v[112:115], a[64:67], v[164:167], v[112:115]
    buffer_load_dwordx4 v[160:163], v11, s[36:39], s68 offen offset:0 sc1
    v_mfma_f32_16x16x32_bf16 v[116:119], a[68:71], v[164:167], v[116:119]
    ds_read_b64_tr_b16 a[26:27], v247 offset:18944
    v_mfma_f32_16x16x32_bf16 v[120:123], a[72:75], v[164:167], v[120:123]
    v_mfma_f32_16x16x32_bf16 v[124:127], a[76:79], v[164:167], v[124:127]
    s_waitcnt vmcnt(10)
    v_mfma_f32_16x16x32_bf16 v[128:131], a[64:67], v[168:171], v[128:131]
    buffer_load_dwordx4 v[164:167], v11, s[36:39], s68 offen offset:1024 sc1
    v_mfma_f32_16x16x32_bf16 v[132:135], a[68:71], v[168:171], v[132:135]
    ds_read_b64_tr_b16 a[28:29], v248 offset:16896
    v_mfma_f32_16x16x32_bf16 v[136:139], a[72:75], v[168:171], v[136:139]
    v_mfma_f32_16x16x32_bf16 v[140:143], a[76:79], v[168:171], v[140:143]
    s_waitcnt vmcnt(10)
    v_mfma_f32_16x16x32_bf16 v[144:147], a[64:67], v[172:175], v[144:147]
    buffer_load_dwordx4 v[168:171], v11, s[36:39], s68 offen offset:2048 sc1
    v_mfma_f32_16x16x32_bf16 v[148:151], a[68:71], v[172:175], v[148:151]
    ds_read_b64_tr_b16 a[30:31], v248 offset:18944
    v_mfma_f32_16x16x32_bf16 v[152:155], a[72:75], v[172:175], v[152:155]
    v_mfma_f32_16x16x32_bf16 v[156:159], a[76:79], v[172:175], v[156:159]
    s_waitcnt vmcnt(10)
    v_mfma_f32_16x16x32_bf16 v[32:35], a[80:83], v[176:179], v[32:35]
    buffer_load_dwordx4 v[172:175], v11, s[36:39], s68 offen offset:3072 sc1
    v_mfma_f32_16x16x32_bf16 v[36:39], a[84:87], v[176:179], v[36:39]
    v_mfma_f32_16x16x32_bf16 v[40:43], a[88:91], v[176:179], v[40:43]
    v_mfma_f32_16x16x32_bf16 v[44:47], a[92:95], v[176:179], v[44:47]
    s_waitcnt vmcnt(10)
    v_mfma_f32_16x16x32_bf16 v[48:51], a[80:83], v[180:183], v[48:51]
    buffer_load_dwordx4 v[176:179], v12, s[36:39], s68 offen offset:0 sc1
    v_mfma_f32_16x16x32_bf16 v[52:55], a[84:87], v[180:183], v[52:55]
    v_mfma_f32_16x16x32_bf16 v[56:59], a[88:91], v[180:183], v[56:59]
    v_mfma_f32_16x16x32_bf16 v[60:63], a[92:95], v[180:183], v[60:63]
    s_waitcnt vmcnt(10)
    v_mfma_f32_16x16x32_bf16 v[64:67], a[80:83], v[184:187], v[64:67]
    buffer_load_dwordx4 v[180:183], v12, s[36:39], s68 offen offset:1024 sc1
    v_mfma_f32_16x16x32_bf16 v[68:71], a[84:87], v[184:187], v[68:71]
    v_mfma_f32_16x16x32_bf16 v[72:75], a[88:91], v[184:187], v[72:75]
    v_mfma_f32_16x16x32_bf16 v[76:79], a[92:95], v[184:187], v[76:79]
    s_waitcnt vmcnt(10)
    v_mfma_f32_16x16x32_bf16 v[80:83], a[80:83], v[188:191], v[80:83]
    buffer_load_dwordx4 v[184:187], v12, s[36:39], s68 offen offset:2048 sc1
    v_mfma_f32_16x16x32_bf16 v[84:87], a[84:87], v[188:191], v[84:87]
    v_mfma_f32_16x16x32_bf16 v[88:91], a[88:91], v[188:191], v[88:91]
    v_mfma_f32_16x16x32_bf16 v[92:95], a[92:95], v[188:191], v[92:95]
    s_waitcnt vmcnt(10)
    v_mfma_f32_16x16x32_bf16 v[96:99], a[80:83], v[192:195], v[96:99]
    buffer_load_dwordx4 v[188:191], v12, s[36:39], s68 offen offset:3072 sc1
    v_mfma_f32_16x16x32_bf16 v[100:103], a[84:87], v[192:195], v[100:103]
    v_mfma_f32_16x16x32_bf16 v[104:107], a[88:91], v[192:195], v[104:107]
    v_mfma_f32_16x16x32_bf16 v[108:111], a[92:95], v[192:195], v[108:111]
    s_add_u32 s68, s68, s89
    s_waitcnt vmcnt(10)
    v_mfma_f32_16x16x32_bf16 v[112:115], a[80:83], v[196:199], v[112:115]
    buffer_load_dwordx4 v[192:195], v11, s[36:39], s68 offen offset:0 sc1
    v_mfma_f32_16x16x32_bf16 v[116:119], a[84:87], v[196:199], v[116:119]
    v_mfma_f32_16x16x32_bf16 v[120:123], a[88:91], v[196:199], v[120:123]
    v_mfma_f32_16x16x32_bf16 v[124:127], a[92:95], v[196:199], v[124:127]
    s_waitcnt vmcnt(10)
    v_mfma_f32_16x16x32_bf16 v[128:131], a[80:83], v[200:203], v[128:131]
    buffer_load_dwordx4 v[196:199], v11, s[36:39], s68 offen offset:1024 sc1
    v_mfma_f32_16x16x32_bf16 v[132:135], a[84:87], v[200:203], v[132:135]
    v_mfma_f32_16x16x32_bf16 v[136:139], a[88:91], v[200:203], v[136:139]
    v_mfma_f32_16x16x32_bf16 v[140:143], a[92:95], v[200:203], v[140:143]
    s_waitcnt vmcnt(10)
    v_mfma_f32_16x16x32_bf16 v[144:147], a[80:83], v[204:207], v[144:147]
    buffer_load_dwordx4 v[200:203], v11, s[36:39], s68 offen offset:2048 sc1
    v_mfma_f32_16x16x32_bf16 v[148:151], a[84:87], v[204:207], v[148:151]
    v_mfma_f32_16x16x32_bf16 v[152:155], a[88:91], v[204:207], v[152:155]
    v_mfma_f32_16x16x32_bf16 v[156:159], a[92:95], v[204:207], v[156:159]
    s_waitcnt vmcnt(10)
    v_mfma_f32_16x16x32_bf16 v[32:35], a[96:99], v[160:163], v[32:35]
    buffer_load_dwordx4 v[204:207], v11, s[36:39], s68 offen offset:3072 sc1
    v_mfma_f32_16x16x32_bf16 v[36:39], a[100:103], v[160:163], v[36:39]
    v_mfma_f32_16x16x32_bf16 v[40:43], a[104:107], v[160:163], v[40:43]
    v_mfma_f32_16x16x32_bf16 v[44:47], a[108:111], v[160:163], v[44:47]
    s_waitcnt vmcnt(10)
    v_mfma_f32_16x16x32_bf16 v[48:51], a[96:99], v[164:167], v[48:51]
    buffer_load_dwordx4 v[160:163], v12, s[36:39], s68 offen offset:0 sc1
    v_mfma_f32_16x16x32_bf16 v[52:55], a[100:103], v[164:167], v[52:55]
    v_mfma_f32_16x16x32_bf16 v[56:59], a[104:107], v[164:167], v[56:59]
    v_mfma_f32_16x16x32_bf16 v[60:63], a[108:111], v[164:167], v[60:63]
    s_waitcnt vmcnt(10)
    v_mfma_f32_16x16x32_bf16 v[64:67], a[96:99], v[168:171], v[64:67]
    buffer_load_dwordx4 v[164:167], v12, s[36:39], s68 offen offset:1024 sc1
    v_mfma_f32_16x16x32_bf16 v[68:71], a[100:103], v[168:171], v[68:71]
    v_mfma_f32_16x16x32_bf16 v[72:75], a[104:107], v[168:171], v[72:75]
    v_mfma_f32_16x16x32_bf16 v[76:79], a[108:111], v[168:171], v[76:79]
    s_waitcnt vmcnt(10)
    v_mfma_f32_16x16x32_bf16 v[80:83], a[96:99], v[172:175], v[80:83]
    buffer_load_dwordx4 v[168:171], v12, s[36:39], s68 offen offset:2048 sc1
    v_mfma_f32_16x16x32_bf16 v[84:87], a[100:103], v[172:175], v[84:87]
    v_mfma_f32_16x16x32_bf16 v[88:91], a[104:107], v[172:175], v[88:91]
    v_mfma_f32_16x16x32_bf16 v[92:95], a[108:111], v[172:175], v[92:95]
    s_waitcnt vmcnt(10)
    v_mfma_f32_16x16x32_bf16 v[96:99], a[96:99], v[176:179], v[96:99]
    buffer_load_dwordx4 v[172:175], v12, s[36:39], s68 offen offset:3072 sc1
    v_mfma_f32_16x16x32_bf16 v[100:103], a[100:103], v[176:179], v[100:103]
    v_mfma_f32_16x16x32_bf16 v[104:107], a[104:107], v[176:179], v[104:107]
    v_mfma_f32_16x16x32_bf16 v[108:111], a[108:111], v[176:179], v[108:111]
    s_add_u32 s68, s68, 131072
    s_waitcnt vmcnt(10)
    v_mfma_f32_16x16x32_bf16 v[112:115], a[96:99], v[180:183], v[112:115]
    buffer_load_dwordx4 v[176:179], v11, s[36:39], s68 offen offset:0 sc1
    v_mfma_f32_16x16x32_bf16 v[116:119], a[100:103], v[180:183], v[116:119]
    v_mfma_f32_16x16x32_bf16 v[120:123], a[104:107], v[180:183], v[120:123]
    v_mfma_f32_16x16x32_bf16 v[124:127], a[108:111], v[180:183], v[124:127]
    s_waitcnt vmcnt(10)
    v_mfma_f32_16x16x32_bf16 v[128:131], a[96:99], v[184:187], v[128:131]
    buffer_load_dwordx4 v[180:183], v11, s[36:39], s68 offen offset:1024 sc1
    v_mfma_f32_16x16x32_bf16 v[132:135], a[100:103], v[184:187], v[132:135]
    v_mfma_f32_16x16x32_bf16 v[136:139], a[104:107], v[184:187], v[136:139]
    v_mfma_f32_16x16x32_bf16 v[140:143], a[108:111], v[184:187], v[140:143]
    s_waitcnt vmcnt(10)
    v_mfma_f32_16x16x32_bf16 v[144:147], a[96:99], v[188:191], v[144:147]
    buffer_load_dwordx4 v[184:187], v11, s[36:39], s68 offen offset:2048 sc1
    v_mfma_f32_16x16x32_bf16 v[148:151], a[100:103], v[188:191], v[148:151]
    v_mfma_f32_16x16x32_bf16 v[152:155], a[104:107], v[188:191], v[152:155]
    v_mfma_f32_16x16x32_bf16 v[156:159], a[108:111], v[188:191], v[156:159]
    s_waitcnt vmcnt(10)
    v_mfma_f32_16x16x32_bf16 v[32:35], a[112:115], v[192:195], v[32:35]
    buffer_load_dwordx4 v[188:191], v11, s[36:39], s68 offen offset:3072 sc1
    v_mfma_f32_16x16x32_bf16 v[36:39], a[116:119], v[192:195], v[36:39]
    v_mfma_f32_16x16x32_bf16 v[40:43], a[120:123], v[192:195], v[40:43]
    v_mfma_f32_16x16x32_bf16 v[44:47], a[124:127], v[192:195], v[44:47]
    s_waitcnt vmcnt(10)
    v_mfma_f32_16x16x32_bf16 v[48:51], a[112:115], v[196:199], v[48:51]
    buffer_load_dwordx4 v[192:195], v12, s[36:39], s68 offen offset:0 sc1
    v_mfma_f32_16x16x32_bf16 v[52:55], a[116:119], v[196:199], v[52:55]
    v_mfma_f32_16x16x32_bf16 v[56:59], a[120:123], v[196:199], v[56:59]
    v_mfma_f32_16x16x32_bf16 v[60:63], a[124:127], v[196:199], v[60:63]
    s_waitcnt vmcnt(10)
    v_mfma_f32_16x16x32_bf16 v[64:67], a[112:115], v[200:203], v[64:67]
    buffer_load_dwordx4 v[196:199], v12, s[36:39], s68 offen offset:1024 sc1
    v_mfma_f32_16x16x32_bf16 v[68:71], a[116:119], v[200:203], v[68:71]
    v_mfma_f32_16x16x32_bf16 v[72:75], a[120:123], v[200:203], v[72:75]
    v_mfma_f32_16x16x32_bf16 v[76:79], a[124:127], v[200:203], v[76:79]
    s_waitcnt vmcnt(10)
    v_mfma_f32_16x16x32_bf16 v[80:83], a[112:115], v[204:207], v[80:83]
    buffer_load_dwordx4 v[200:203], v12, s[36:39], s68 offen offset:2048 sc1
    v_mfma_f32_16x16x32_bf16 v[84:87], a[116:119], v[204:207], v[84:87]
    v_mfma_f32_16x16x32_bf16 v[88:91], a[120:123], v[204:207], v[88:91]
    v_mfma_f32_16x16x32_bf16 v[92:95], a[124:127], v[204:207], v[92:95]
    s_waitcnt vmcnt(10)
    v_mfma_f32_16x16x32_bf16 v[96:99], a[112:115], v[160:163], v[96:99]
    buffer_load_dwordx4 v[204:207], v12, s[36:39], s68 offen offset:3072 sc1
    v_mfma_f32_16x16x32_bf16 v[100:103], a[116:119], v[160:163], v[100:103]
    v_mfma_f32_16x16x32_bf16 v[104:107], a[120:123], v[160:163], v[104:107]
    v_mfma_f32_16x16x32_bf16 v[108:111], a[124:127], v[160:163], v[108:111]
    s_add_u32 s68, s68, 131072
    s_waitcnt vmcnt(10)
    v_mfma_f32_16x16x32_bf16 v[112:115], a[112:115], v[164:167], v[112:115]
    buffer_load_dwordx4 v[160:163], v11, s[36:39], s68 offen offset:0 sc1
    v_mfma_f32_16x16x32_bf16 v[116:119], a[116:119], v[164:167], v[116:119]
    v_mfma_f32_16x16x32_bf16 v[120:123], a[120:123], v[164:167], v[120:123]
    v_mfma_f32_16x16x32_bf16 v[124:127], a[124:127], v[164:167], v[124:127]
    s_waitcnt vmcnt(10)
    v_mfma_f32_16x16x32_bf16 v[128:131], a[112:115], v[168:171], v[128:131]
    buffer_load_dwordx4 v[164:167], v11, s[36:39], s68 offen offset:1024 sc1
    v_mfma_f32_16x16x32_bf16 v[132:135], a[116:119], v[168:171], v[132:135]
    v_mfma_f32_16x16x32_bf16 v[136:139], a[120:123], v[168:171], v[136:139]
    v_mfma_f32_16x16x32_bf16 v[140:143], a[124:127], v[168:171], v[140:143]
    s_waitcnt vmcnt(10)
    v_mfma_f32_16x16x32_bf16 v[144:147], a[112:115], v[172:175], v[144:147]
    buffer_load_dwordx4 v[168:171], v11, s[36:39], s68 offen offset:2048 sc1
    v_mfma_f32_16x16x32_bf16 v[148:151], a[116:119], v[172:175], v[148:151]
    v_mfma_f32_16x16x32_bf16 v[152:155], a[120:123], v[172:175], v[152:155]
    v_mfma_f32_16x16x32_bf16 v[156:159], a[124:127], v[172:175], v[156:159]
    s_waitcnt vmcnt(10)
    v_mfma_f32_16x16x32_bf16 v[32:35], a[128:131], v[176:179], v[32:35]
    buffer_load_dwordx4 v[172:175], v11, s[36:39], s68 offen offset:3072 sc1
    v_mfma_f32_16x16x32_bf16 v[36:39], a[132:135], v[176:179], v[36:39]
    v_mfma_f32_16x16x32_bf16 v[40:43], a[136:139], v[176:179], v[40:43]
    v_mfma_f32_16x16x32_bf16 v[44:47], a[140:143], v[176:179], v[44:47]
    ds_read_b64_tr_b16 a[32:33], v245 offset:33792
    s_waitcnt vmcnt(10)
    v_mfma_f32_16x16x32_bf16 v[48:51], a[128:131], v[180:183], v[48:51]
    buffer_load_dwordx4 v[176:179], v12, s[36:39], s68 offen offset:0 sc1
    v_mfma_f32_16x16x32_bf16 v[52:55], a[132:135], v[180:183], v[52:55]
    v_mfma_f32_16x16x32_bf16 v[56:59], a[136:139], v[180:183], v[56:59]
    v_mfma_f32_16x16x32_bf16 v[60:63], a[140:143], v[180:183], v[60:63]
    ds_read_b64_tr_b16 a[34:35], v245 offset:35840
    s_waitcnt vmcnt(10)
    v_mfma_f32_16x16x32_bf16 v[64:67], a[128:131], v[184:187], v[64:67]
    buffer_load_dwordx4 v[180:183], v12, s[36:39], s68 offen offset:1024 sc1
    v_mfma_f32_16x16x32_bf16 v[68:71], a[132:135], v[184:187], v[68:71]
    v_mfma_f32_16x16x32_bf16 v[72:75], a[136:139], v[184:187], v[72:75]
    ds_read_b64_tr_b16 a[36:37], v246 offset:33792
    v_mfma_f32_16x16x32_bf16 v[76:79], a[140:143], v[184:187], v[76:79]
    s_waitcnt vmcnt(10)
    v_mfma_f32_16x16x32_bf16 v[80:83], a[128:131], v[188:191], v[80:83]
    buffer_load_dwordx4 v[184:187], v12, s[36:39], s68 offen offset:2048 sc1
    v_mfma_f32_16x16x32_bf16 v[84:87], a[132:135], v[188:191], v[84:87]
    v_mfma_f32_16x16x32_bf16 v[88:91], a[136:139], v[188:191], v[88:91]
    ds_read_b64_tr_b16 a[38:39], v246 offset:35840
    v_mfma_f32_16x16x32_bf16 v[92:95], a[140:143], v[188:191], v[92:95]
    s_waitcnt vmcnt(10)
    v_mfma_f32_16x16x32_bf16 v[96:99], a[128:131], v[192:195], v[96:99]
    buffer_load_dwordx4 v[188:191], v12, s[36:39], s68 offen offset:3072 sc1
    v_mfma_f32_16x16x32_bf16 v[100:103], a[132:135], v[192:195], v[100:103]
    ds_read_b64_tr_b16 a[40:41], v247 offset:33792
    v_mfma_f32_16x16x32_bf16 v[104:107], a[136:139], v[192:195], v[104:107]
    v_mfma_f32_16x16x32_bf16 v[108:111], a[140:143], v[192:195], v[108:111]
    s_add_u32 s68, s68, 131072
    s_waitcnt vmcnt(10)
    v_mfma_f32_16x16x32_bf16 v[112:115], a[128:131], v[196:199], v[112:115]
    buffer_load_dwordx4 v[192:195], v11, s[36:39], s68 offen offset:0 sc1
    v_mfma_f32_16x16x32_bf16 v[116:119], a[132:135], v[196:199], v[116:119]
    ds_read_b64_tr_b16 a[42:43], v247 offset:35840
    v_mfma_f32_16x16x32_bf16 v[120:123], a[136:139], v[196:199], v[120:123]
    v_mfma_f32_16x16x32_bf16 v[124:127], a[140:143], v[196:199], v[124:127]
    s_waitcnt vmcnt(10)
    v_mfma_f32_16x16x32_bf16 v[128:131], a[128:131], v[200:203], v[128:131]
    buffer_load_dwordx4 v[196:199], v11, s[36:39], s68 offen offset:1024 sc1
    v_mfma_f32_16x16x32_bf16 v[132:135], a[132:135], v[200:203], v[132:135]
    ds_read_b64_tr_b16 a[44:45], v248 offset:33792
    v_mfma_f32_16x16x32_bf16 v[136:139], a[136:139], v[200:203], v[136:139]
    v_mfma_f32_16x16x32_bf16 v[140:143], a[140:143], v[200:203], v[140:143]
    s_waitcnt vmcnt(10)
    v_mfma_f32_16x16x32_bf16 v[144:147], a[128:131], v[204:207], v[144:147]
    buffer_load_dwordx4 v[200:203], v11, s[36:39], s68 offen offset:2048 sc1
    v_mfma_f32_16x16x32_bf16 v[148:151], a[132:135], v[204:207], v[148:151]
    ds_read_b64_tr_b16 a[46:47], v248 offset:35840
    v_mfma_f32_16x16x32_bf16 v[152:155], a[136:139], v[204:207], v[152:155]
    v_mfma_f32_16x16x32_bf16 v[156:159], a[140:143], v[204:207], v[156:159]
    s_waitcnt vmcnt(10)
    v_mfma_f32_16x16x32_bf16 v[32:35], a[144:147], v[160:163], v[32:35]
    buffer_load_dwordx4 v[204:207], v11, s[36:39], s68 offen offset:3072 sc1
    v_mfma_f32_16x16x32_bf16 v[36:39], a[148:151], v[160:163], v[36:39]
    v_mfma_f32_16x16x32_bf16 v[40:43], a[152:155], v[160:163], v[40:43]
    v_mfma_f32_16x16x32_bf16 v[44:47], a[156:159], v[160:163], v[44:47]
    s_waitcnt vmcnt(10)
    v_mfma_f32_16x16x32_bf16 v[48:51], a[144:147], v[164:167], v[48:51]
    buffer_load_dwordx4 v[160:163], v12, s[36:39], s68 offen offset:0 sc1
    v_mfma_f32_16x16x32_bf16 v[52:55], a[148:151], v[164:167], v[52:55]
    v_mfma_f32_16x16x32_bf16 v[56:59], a[152:155], v[164:167], v[56:59]
    v_mfma_f32_16x16x32_bf16 v[60:63], a[156:159], v[164:167], v[60:63]
    s_waitcnt vmcnt(10)
    v_mfma_f32_16x16x32_bf16 v[64:67], a[144:147], v[168:171], v[64:67]
    buffer_load_dwordx4 v[164:167], v12, s[36:39], s68 offen offset:1024 sc1
    v_mfma_f32_16x16x32_bf16 v[68:71], a[148:151], v[168:171], v[68:71]
    v_mfma_f32_16x16x32_bf16 v[72:75], a[152:155], v[168:171], v[72:75]
    v_mfma_f32_16x16x32_bf16 v[76:79], a[156:159], v[168:171], v[76:79]
    s_waitcnt vmcnt(10)
    v_mfma_f32_16x16x32_bf16 v[80:83], a[144:147], v[172:175], v[80:83]
    buffer_load_dwordx4 v[168:171], v12, s[36:39], s68 offen offset:2048 sc1
    v_mfma_f32_16x16x32_bf16 v[84:87], a[148:151], v[172:175], v[84:87]
    v_mfma_f32_16x16x32_bf16 v[88:91], a[152:155], v[172:175], v[88:91]
    v_mfma_f32_16x16x32_bf16 v[92:95], a[156:159], v[172:175], v[92:95]
    s_waitcnt vmcnt(10)
    v_mfma_f32_16x16x32_bf16 v[96:99], a[144:147], v[176:179], v[96:99]
    buffer_load_dwordx4 v[172:175], v12, s[36:39], s68 offen offset:3072 sc1
    v_mfma_f32_16x16x32_bf16 v[100:103], a[148:151], v[176:179], v[100:103]
    v_mfma_f32_16x16x32_bf16 v[104:107], a[152:155], v[176:179], v[104:107]
    v_mfma_f32_16x16x32_bf16 v[108:111], a[156:159], v[176:179], v[108:111]
    s_add_u32 s68, s68, 131072
    s_waitcnt vmcnt(10)
    v_mfma_f32_16x16x32_bf16 v[112:115], a[144:147], v[180:183], v[112:115]
    buffer_load_dwordx4 v[176:179], v11, s[36:39], s68 offen offset:0 sc1
    v_mfma_f32_16x16x32_bf16 v[116:119], a[148:151], v[180:183], v[116:119]
    v_mfma_f32_16x16x32_bf16 v[120:123], a[152:155], v[180:183], v[120:123]
    v_mfma_f32_16x16x32_bf16 v[124:127], a[156:159], v[180:183], v[124:127]
    s_waitcnt vmcnt(10)
    v_mfma_f32_16x16x32_bf16 v[128:131], a[144:147], v[184:187], v[128:131]
    buffer_load_dwordx4 v[180:183], v11, s[36:39], s68 offen offset:1024 sc1
    v_mfma_f32_16x16x32_bf16 v[132:135], a[148:151], v[184:187], v[132:135]
    v_mfma_f32_16x16x32_bf16 v[136:139], a[152:155], v[184:187], v[136:139]
    v_mfma_f32_16x16x32_bf16 v[140:143], a[156:159], v[184:187], v[140:143]
    s_waitcnt vmcnt(10)
    v_mfma_f32_16x16x32_bf16 v[144:147], a[144:147], v[188:191], v[144:147]
    buffer_load_dwordx4 v[184:187], v11, s[36:39], s68 offen offset:2048 sc1
    v_mfma_f32_16x16x32_bf16 v[148:151], a[148:151], v[188:191], v[148:151]
    v_mfma_f32_16x16x32_bf16 v[152:155], a[152:155], v[188:191], v[152:155]
    v_mfma_f32_16x16x32_bf16 v[156:159], a[156:159], v[188:191], v[156:159]
    s_waitcnt vmcnt(10)
    v_mfma_f32_16x16x32_bf16 v[32:35], a[160:163], v[192:195], v[32:35]
    buffer_load_dwordx4 v[188:191], v11, s[36:39], s68 offen offset:3072 sc1
    v_mfma_f32_16x16x32_bf16 v[36:39], a[164:167], v[192:195], v[36:39]
    v_mfma_f32_16x16x32_bf16 v[40:43], a[168:171], v[192:195], v[40:43]
    v_mfma_f32_16x16x32_bf16 v[44:47], a[172:175], v[192:195], v[44:47]
    s_waitcnt vmcnt(10)
    v_mfma_f32_16x16x32_bf16 v[48:51], a[160:163], v[196:199], v[48:51]
    buffer_load_dwordx4 v[192:195], v12, s[36:39], s68 offen offset:0 sc1
    v_mfma_f32_16x16x32_bf16 v[52:55], a[164:167], v[196:199], v[52:55]
    v_mfma_f32_16x16x32_bf16 v[56:59], a[168:171], v[196:199], v[56:59]
    v_mfma_f32_16x16x32_bf16 v[60:63], a[172:175], v[196:199], v[60:63]
    s_waitcnt vmcnt(10)
    v_mfma_f32_16x16x32_bf16 v[64:67], a[160:163], v[200:203], v[64:67]
    buffer_load_dwordx4 v[196:199], v12, s[36:39], s68 offen offset:1024 sc1
    v_mfma_f32_16x16x32_bf16 v[68:71], a[164:167], v[200:203], v[68:71]
    v_mfma_f32_16x16x32_bf16 v[72:75], a[168:171], v[200:203], v[72:75]
    v_mfma_f32_16x16x32_bf16 v[76:79], a[172:175], v[200:203], v[76:79]
    s_waitcnt vmcnt(10)
    v_mfma_f32_16x16x32_bf16 v[80:83], a[160:163], v[204:207], v[80:83]
    buffer_load_dwordx4 v[200:203], v12, s[36:39], s68 offen offset:2048 sc1
    v_mfma_f32_16x16x32_bf16 v[84:87], a[164:167], v[204:207], v[84:87]
    v_mfma_f32_16x16x32_bf16 v[88:91], a[168:171], v[204:207], v[88:91]
    v_mfma_f32_16x16x32_bf16 v[92:95], a[172:175], v[204:207], v[92:95]
    s_waitcnt vmcnt(10)
    v_mfma_f32_16x16x32_bf16 v[96:99], a[160:163], v[160:163], v[96:99]
    buffer_load_dwordx4 v[204:207], v12, s[36:39], s68 offen offset:3072 sc1
    v_mfma_f32_16x16x32_bf16 v[100:103], a[164:167], v[160:163], v[100:103]
    v_mfma_f32_16x16x32_bf16 v[104:107], a[168:171], v[160:163], v[104:107]
    v_mfma_f32_16x16x32_bf16 v[108:111], a[172:175], v[160:163], v[108:111]
    s_add_u32 s68, s68, 131072
    s_waitcnt vmcnt(10)
    v_mfma_f32_16x16x32_bf16 v[112:115], a[160:163], v[164:167], v[112:115]
    buffer_load_dwordx4 v[160:163], v11, s[36:39], s68 offen offset:0 sc1
    v_mfma_f32_16x16x32_bf16 v[116:119], a[164:167], v[164:167], v[116:119]
    v_mfma_f32_16x16x32_bf16 v[120:123], a[168:171], v[164:167], v[120:123]
    v_mfma_f32_16x16x32_bf16 v[124:127], a[172:175], v[164:167], v[124:127]
    s_add_u32 s90, s68, 131072
    s_waitcnt vmcnt(10)
    v_mfma_f32_16x16x32_bf16 v[128:131], a[160:163], v[168:171], v[128:131]
    buffer_load_dwordx4 v[164:167], v11, s[36:39], s90 offen offset:0 sc1
    v_mfma_f32_16x16x32_bf16 v[132:135], a[164:167], v[168:171], v[132:135]
    v_mfma_f32_16x16x32_bf16 v[136:139], a[168:171], v[168:171], v[136:139]
    v_mfma_f32_16x16x32_bf16 v[140:143], a[172:175], v[168:171], v[140:143]
    s_waitcnt vmcnt(10)
    v_mfma_f32_16x16x32_bf16 v[144:147], a[160:163], v[172:175], v[144:147]
    buffer_load_dwordx4 v[168:171], v11, s[36:39], s68 offen offset:1024 sc1
    v_mfma_f32_16x16x32_bf16 v[148:151], a[164:167], v[172:175], v[148:151]
    v_mfma_f32_16x16x32_bf16 v[152:155], a[168:171], v[172:175], v[152:155]
    v_mfma_f32_16x16x32_bf16 v[156:159], a[172:175], v[172:175], v[156:159]
    s_waitcnt vmcnt(10)
    s_waitcnt lgkmcnt(15)
    v_mfma_f32_16x16x32_bf16 v[32:35], a[176:179], v[176:179], v[32:35]
    buffer_load_dwordx4 v[172:175], v11, s[36:39], s90 offen offset:1024 sc1
    v_mfma_f32_16x16x32_bf16 v[36:39], a[180:183], v[176:179], v[36:39]
    v_mfma_f32_16x16x32_bf16 v[40:43], a[184:187], v[176:179], v[40:43]
    v_mfma_f32_16x16x32_bf16 v[44:47], a[188:191], v[176:179], v[44:47]
    s_waitcnt vmcnt(10)
    v_mfma_f32_16x16x32_bf16 v[48:51], a[176:179], v[180:183], v[48:51]
    buffer_load_dwordx4 v[176:179], v11, s[36:39], s68 offen offset:2048 sc1
    v_mfma_f32_16x16x32_bf16 v[52:55], a[180:183], v[180:183], v[52:55]
    v_mfma_f32_16x16x32_bf16 v[56:59], a[184:187], v[180:183], v[56:59]
    v_mfma_f32_16x16x32_bf16 v[60:63], a[188:191], v[180:183], v[60:63]
    s_waitcnt vmcnt(10)
    v_mfma_f32_16x16x32_bf16 v[64:67], a[176:179], v[184:187], v[64:67]
    buffer_load_dwordx4 v[180:183], v11, s[36:39], s90 offen offset:2048 sc1
    v_mfma_f32_16x16x32_bf16 v[68:71], a[180:183], v[184:187], v[68:71]
    v_mfma_f32_16x16x32_bf16 v[72:75], a[184:187], v[184:187], v[72:75]
    v_mfma_f32_16x16x32_bf16 v[76:79], a[188:191], v[184:187], v[76:79]
    s_waitcnt vmcnt(10)
    v_mfma_f32_16x16x32_bf16 v[80:83], a[176:179], v[188:191], v[80:83]
    buffer_load_dwordx4 v[184:187], v11, s[36:39], s68 offen offset:3072 sc1
    v_mfma_f32_16x16x32_bf16 v[84:87], a[180:183], v[188:191], v[84:87]
    v_mfma_f32_16x16x32_bf16 v[88:91], a[184:187], v[188:191], v[88:91]
    v_mfma_f32_16x16x32_bf16 v[92:95], a[188:191], v[188:191], v[92:95]
    s_waitcnt vmcnt(10)
    v_mfma_f32_16x16x32_bf16 v[96:99], a[176:179], v[192:195], v[96:99]
    buffer_load_dwordx4 v[188:191], v11, s[36:39], s90 offen offset:3072 sc1
    v_mfma_f32_16x16x32_bf16 v[100:103], a[180:183], v[192:195], v[100:103]
    v_mfma_f32_16x16x32_bf16 v[104:107], a[184:187], v[192:195], v[104:107]
    v_mfma_f32_16x16x32_bf16 v[108:111], a[188:191], v[192:195], v[108:111]
    s_waitcnt vmcnt(10)
    v_mfma_f32_16x16x32_bf16 v[112:115], a[176:179], v[196:199], v[112:115]
    buffer_load_dwordx4 v[192:195], v12, s[36:39], s68 offen offset:0 sc1
    v_mfma_f32_16x16x32_bf16 v[116:119], a[180:183], v[196:199], v[116:119]
    v_mfma_f32_16x16x32_bf16 v[120:123], a[184:187], v[196:199], v[120:123]
    v_mfma_f32_16x16x32_bf16 v[124:127], a[188:191], v[196:199], v[124:127]
    s_waitcnt vmcnt(10)
    v_mfma_f32_16x16x32_bf16 v[128:131], a[176:179], v[200:203], v[128:131]
    buffer_load_dword v252, v250, s[16:19], 0 offen sc1
    v_mfma_f32_16x16x32_bf16 v[132:135], a[180:183], v[200:203], v[132:135]
    buffer_load_dwordx4 v[196:199], v12, s[36:39], s90 offen offset:0 sc1
    v_mfma_f32_16x16x32_bf16 v[136:139], a[184:187], v[200:203], v[136:139]
    v_mfma_f32_16x16x32_bf16 v[140:143], a[188:191], v[200:203], v[140:143]
    s_waitcnt vmcnt(11)
    v_mfma_f32_16x16x32_bf16 v[144:147], a[176:179], v[204:207], v[144:147]
    buffer_load_dwordx4 v[200:203], v12, s[36:39], s68 offen offset:1024 sc1
    v_mfma_f32_16x16x32_bf16 v[148:151], a[180:183], v[204:207], v[148:151]
    v_mfma_f32_16x16x32_bf16 v[152:155], a[184:187], v[204:207], v[152:155]
    v_mfma_f32_16x16x32_bf16 v[156:159], a[188:191], v[204:207], v[156:159]
    s_waitcnt vmcnt(11)
    v_mfma_f32_16x16x32_bf16 v[32:35], a[192:195], v[160:163], v[32:35]
    buffer_load_dwordx4 v[204:207], v12, s[36:39], s90 offen offset:1024 sc1
    v_mfma_f32_16x16x32_bf16 v[36:39], a[196:199], v[160:163], v[36:39]
    v_mfma_f32_16x16x32_bf16 v[40:43], a[200:203], v[160:163], v[40:43]
    v_mfma_f32_16x16x32_bf16 v[44:47], a[204:207], v[160:163], v[44:47]
    s_waitcnt vmcnt(11)
    v_mfma_f32_16x16x32_bf16 v[32:35], a[208:211], v[164:167], v[32:35]
    buffer_load_dwordx4 v[160:163], v12, s[36:39], s68 offen offset:2048 sc1
    v_mfma_f32_16x16x32_bf16 v[36:39], a[212:215], v[164:167], v[36:39]
    v_mfma_f32_16x16x32_bf16 v[40:43], a[216:219], v[164:167], v[40:43]
    v_mfma_f32_16x16x32_bf16 v[44:47], a[220:223], v[164:167], v[44:47]
    s_waitcnt vmcnt(11)
    v_mfma_f32_16x16x32_bf16 v[48:51], a[192:195], v[168:171], v[48:51]
    buffer_load_dwordx4 v[164:167], v12, s[36:39], s90 offen offset:2048 sc1
    v_mfma_f32_16x16x32_bf16 v[52:55], a[196:199], v[168:171], v[52:55]
    v_mfma_f32_16x16x32_bf16 v[56:59], a[200:203], v[168:171], v[56:59]
    v_mfma_f32_16x16x32_bf16 v[60:63], a[204:207], v[168:171], v[60:63]
    s_waitcnt vmcnt(11)
    v_mfma_f32_16x16x32_bf16 v[48:51], a[208:211], v[172:175], v[48:51]
    s_waitcnt vmcnt(5)
    v_cmp_gt_u32 vcc, 1, v252
    s_nop 0
    s_cbranch_vccz F_poll3_ok
    s_mov_b32 s3, 0
F_poll3_spin:
    s_add_u32 s3, s3, 1
    s_cmp_gt_u32 s3, 0x8000
    s_cbranch_scc1 F_poll3_ok
    s_sleep 1
    buffer_load_dword v252, v250, s[16:19], 0 offen sc1
    s_waitcnt vmcnt(0)
    v_cmp_gt_u32 vcc, 1, v252
    s_nop 0
    s_cbranch_vccnz F_poll3_spin
F_poll3_ok:
    v_mfma_f32_16x16x32_bf16 v[52:55], a[212:215], v[172:175], v[52:55]
    buffer_load_dword v2, v19, s[16:19], 0 offen offset:0 sc1
    buffer_load_dword v3, v19, s[16:19], 0 offen offset:64 sc1
    buffer_load_dword v4, v19, s[16:19], 0 offen offset:128 sc1
    buffer_load_dword v5, v19, s[16:19], 0 offen offset:192 sc1
    buffer_load_dword v6, v19, s[16:19], 0 offen offset:256 sc1
    buffer_load_dword v7, v19, s[16:19], 0 offen offset:320 sc1
    buffer_load_dword v8, v19, s[16:19], 0 offen offset:384 sc1
    buffer_load_dword v9, v19, s[16:19], 0 offen offset:448 sc1
    buffer_load_dwordx4 v[168:171], v12, s[36:39], s68 offen offset:3072 sc1
    v_mfma_f32_16x16x32_bf16 v[56:59], a[216:219], v[172:175], v[56:59]
    v_mfma_f32_16x16x32_bf16 v[60:63], a[220:223], v[172:175], v[60:63]
    v_mfma_f32_16x16x32_bf16 v[64:67], a[192:195], v[176:179], v[64:67]
    buffer_load_dwordx4 v[172:175], v12, s[36:39], s90 offen offset:3072 sc1
    v_mfma_f32_16x16x32_bf16 v[68:71], a[196:199], v[176:179], v[68:71]
    v_mfma_f32_16x16x32_bf16 v[72:75], a[200:203], v[176:179], v[72:75]
    v_mfma_f32_16x16x32_bf16 v[76:79], a[204:207], v[176:179], v[76:79]
    v_mfma_f32_16x16x32_bf16 v[64:67], a[208:211], v[180:183], v[64:67]
    buffer_load_dwordx4 v[176:179], v11, s[16:19], s70 offen offset:0 sc1
    v_mfma_f32_16x16x32_bf16 v[68:71], a[212:215], v[180:183], v[68:71]
    v_mfma_f32_16x16x32_bf16 v[72:75], a[216:219], v[180:183], v[72:75]
    v_mfma_f32_16x16x32_bf16 v[76:79], a[220:223], v[180:183], v[76:79]
    v_mfma_f32_16x16x32_bf16 v[80:83], a[192:195], v[184:187], v[80:83]
    buffer_load_dwordx4 v[180:183], v11, s[16:19], s71 offen offset:0 sc1
    v_mfma_f32_16x16x32_bf16 v[84:87], a[196:199], v[184:187], v[84:87]
    v_mfma_f32_16x16x32_bf16 v[88:91], a[200:203], v[184:187], v[88:91]
    v_mfma_f32_16x16x32_bf16 v[92:95], a[204:207], v[184:187], v[92:95]
    v_mfma_f32_16x16x32_bf16 v[80:83], a[208:211], v[188:191], v[80:83]
    buffer_load_dwordx2 v[184:185], v13, s[16:19], s72 offen offset:0 sc1
    v_mfma_f32_16x16x32_bf16 v[84:87], a[212:215], v[188:191], v[84:87]
    buffer_load_dwordx2 v[186:187], v13, s[16:19], s72 offen offset:512 sc1
    v_mfma_f32_16x16x32_bf16 v[88:91], a[216:219], v[188:191], v[88:91]
    v_mfma_f32_16x16x32_bf16 v[92:95], a[220:223], v[188:191], v[92:95]
    v_mfma_f32_16x16x32_bf16 v[96:99], a[192:195], v[192:195], v[96:99]
    buffer_load_dwordx4 v[188:191], v11, s[16:19], s73 offen offset:0 sc1
    v_mfma_f32_16x16x32_bf16 v[100:103], a[196:199], v[192:195], v[100:103]
    v_mfma_f32_16x16x32_bf16 v[104:107], a[200:203], v[192:195], v[104:107]
    v_mfma_f32_16x16x32_bf16 v[108:111], a[204:207], v[192:195], v[108:111]
    s_waitcnt vmcnt(19)
    v_mfma_f32_16x16x32_bf16 v[96:99], a[208:211], v[196:199], v[96:99]
    buffer_load_dwordx4 v[192:195], v11, s[16:19], s74 offen offset:0 sc1
    v_mfma_f32_16x16x32_bf16 v[100:103], a[212:215], v[196:199], v[100:103]
    v_mfma_f32_16x16x32_bf16 v[104:107], a[216:219], v[196:199], v[104:107]
    v_mfma_f32_16x16x32_bf16 v[108:111], a[220:223], v[196:199], v[108:111]
    s_waitcnt vmcnt(19)
    v_mfma_f32_16x16x32_bf16 v[112:115], a[192:195], v[200:203], v[112:115]
    buffer_load_dwordx4 v[196:199], v11, s[16:19], s70 offen offset:1024 sc1
    v_mfma_f32_16x16x32_bf16 v[116:119], a[196:199], v[200:203], v[116:119]
    v_mfma_f32_16x16x32_bf16 v[120:123], a[200:203], v[200:203], v[120:123]
    v_mfma_f32_16x16x32_bf16 v[124:127], a[204:207], v[200:203], v[124:127]
    s_waitcnt vmcnt(19)
    v_mfma_f32_16x16x32_bf16 v[112:115], a[208:211], v[204:207], v[112:115]
    buffer_load_dwordx4 v[200:203], v11, s[16:19], s71 offen offset:1024 sc1
    v_mfma_f32_16x16x32_bf16 v[116:119], a[212:215], v[204:207], v[116:119]
    s_waitcnt vmcnt(17)
    v_mul_f32 v32, v2, v32
    v_mul_f32 v33, v2, v33
    v_mfma_f32_16x16x32_bf16 v[120:123], a[216:219], v[204:207], v[120:123]
    v_mul_f32 v34, v2, v34
    v_mul_f32 v35, v2, v35
    v_mfma_f32_16x16x32_bf16 v[124:127], a[220:223], v[204:207], v[124:127]
    v_mul_f32 v36, v2, v36
    v_mul_f32 v37, v2, v37
    v_mfma_f32_16x16x32_bf16 v[128:131], a[192:195], v[160:163], v[128:131]
    buffer_load_dwordx2 v[204:205], v13, s[16:19], s72 offen offset:1024 sc1
    v_mfma_f32_16x16x32_bf16 v[132:135], a[196:199], v[160:163], v[132:135]
    buffer_load_dwordx2 v[206:207], v13, s[16:19], s72 offen offset:1536 sc1
    v_mfma_f32_16x16x32_bf16 v[136:139], a[200:203], v[160:163], v[136:139]
    v_mul_f32 v38, v2, v38
    v_mul_f32 v39, v2, v39
    v_mfma_f32_16x16x32_bf16 v[140:143], a[204:207], v[160:163], v[140:143]
    v_mul_f32 v40, v2, v40
    v_mul_f32 v41, v2, v41
    v_mul_f32 v42, v2, v42
    v_mul_f32 v43, v2, v43
    v_mfma_f32_16x16x32_bf16 v[128:131], a[208:211], v[164:167], v[128:131]
    buffer_load_dwordx4 v[160:163], v11, s[16:19], s73 offen offset:1024 sc1
    v_mfma_f32_16x16x32_bf16 v[132:135], a[212:215], v[164:167], v[132:135]
    v_mul_f32 v44, v2, v44
    v_mul_f32 v45, v2, v45
    v_mfma_f32_16x16x32_bf16 v[136:139], a[216:219], v[164:167], v[136:139]
    v_mul_f32 v46, v2, v46
    v_mul_f32 v47, v2, v47
    v_mfma_f32_16x16x32_bf16 v[140:143], a[220:223], v[164:167], v[140:143]
    s_waitcnt vmcnt(12)
    v_mul_f32 v48, v3, v48
    v_mul_f32 v49, v3, v49
    v_mfma_f32_16x16x32_bf16 v[144:147], a[192:195], v[168:171], v[144:147]
    buffer_load_dwordx4 v[164:167], v11, s[16:19], s74 offen offset:1024 sc1
    v_mfma_f32_16x16x32_bf16 v[148:151], a[196:199], v[168:171], v[148:151]
    v_mul_f32 v50, v3, v50
    v_mul_f32 v51, v3, v51
    v_mfma_f32_16x16x32_bf16 v[152:155], a[200:203], v[168:171], v[152:155]
    v_mul_f32 v52, v3, v52
    v_mul_f32 v53, v3, v53
    v_mfma_f32_16x16x32_bf16 v[156:159], a[204:207], v[168:171], v[156:159]
    s_waitcnt vmcnt(12)
    v_mul_f32 v54, v3, v54
    v_mul_f32 v55, v3, v55
    v_mfma_f32_16x16x32_bf16 v[144:147], a[208:211], v[172:175], v[144:147]
    buffer_load_dwordx4 v[168:171], v11, s[16:19], s70 offen offset:2048 sc1
    v_mfma_f32_16x16x32_bf16 v[148:151], a[212:215], v[172:175], v[148:151]
    v_mul_f32 v56, v3, v56
    v_mul_f32 v57, v3, v57
    v_mfma_f32_16x16x32_bf16 v[152:155], a[216:219], v[172:175], v[152:155]
    v_mul_f32 v58, v3, v58
    v_mul_f32 v59, v3, v59
    v_mfma_f32_16x16x32_bf16 v[156:159], a[220:223], v[172:175], v[156:159]
    s_waitcnt vmcnt(12)
    v_mul_f32 v60, v3, v60
    v_mul_f32 v61, v3, v61
    v_mul_f32 v62, v3, v62
    v_mul_f32 v63, v3, v63
    v_mfma_f32_16x16x32_bf16 v[32:35], a[224:227], v[176:179], v[32:35]
    buffer_load_dwordx4 v[172:175], v11, s[16:19], s71 offen offset:2048 sc1
    v_mfma_f32_16x16x32_bf16 v[36:39], a[228:231], v[176:179], v[36:39]
    v_mul_f32 v64, v4, v64
    v_mul_f32 v65, v4, v65
    v_mfma_f32_16x16x32_bf16 v[40:43], a[232:235], v[176:179], v[40:43]
    v_mul_f32 v66, v4, v66
    v_mul_f32 v67, v4, v67
    v_mfma_f32_16x16x32_bf16 v[44:47], a[236:239], v[176:179], v[44:47]
    s_waitcnt vmcnt(12)
    v_mul_f32 v68, v4, v68
    v_mul_f32 v69, v4, v69
    v_mfma_f32_16x16x32_bf16 v[32:35], a[240:243], v[180:183], v[32:35]
    buffer_load_dwordx2 v[176:177], v13, s[16:19], s72 offen offset:2048 sc1
    v_mfma_f32_16x16x32_bf16 v[36:39], a[244:247], v[180:183], v[36:39]
    buffer_load_dwordx2 v[178:179], v13, s[16:19], s72 offen offset:2560 sc1
    v_mfma_f32_16x16x32_bf16 v[40:43], a[248:251], v[180:183], v[40:43]
    v_mul_f32 v70, v4, v70
    v_mul_f32 v71, v4, v71
    v_mfma_f32_16x16x32_bf16 v[44:47], a[252:255], v[180:183], v[44:47]
    s_waitcnt vmcnt(12)
    v_mul_f32 v72, v4, v72
    v_mul_f32 v73, v4, v73
    v_mul_f32 v74, v4, v74
    v_mul_f32 v75, v4, v75
    v_mfma_f32_16x16x32_bf16 v[32:35], a[0:3], v[184:187], v[32:35]
    buffer_load_dwordx4 v[180:183], v11, s[16:19], s73 offen offset:2048 sc1
    v_mfma_f32_16x16x32_bf16 v[36:39], a[4:7], v[184:187], v[36:39]
    v_mul_f32 v76, v4, v76
    v_mul_f32 v77, v4, v77
    v_mfma_f32_16x16x32_bf16 v[40:43], a[8:11], v[184:187], v[40:43]
    v_mul_f32 v78, v4, v78
    v_mul_f32 v79, v4, v79
    v_mfma_f32_16x16x32_bf16 v[44:47], a[12:15], v[184:187], v[44:47]
    s_waitcnt vmcnt(12)
    v_mul_f32 v80, v5, v80
    v_mul_f32 v81, v5, v81
    s_waitcnt lgkmcnt(14)
    v_mfma_f32_16x16x32_bf16 v[32:35], a[16:19], v[188:191], v[32:35]
    buffer_load_dwordx4 v[184:187], v11, s[16:19], s74 offen offset:2048 sc1
    s_waitcnt lgkmcnt(12)
    v_mfma_f32_16x16x32_bf16 v[36:39], a[20:23], v[188:191], v[36:39]
    v_mul_f32 v82, v5, v82
    v_mul_f32 v83, v5, v83
    s_waitcnt lgkmcnt(10)
    v_mfma_f32_16x16x32_bf16 v[40:43], a[24:27], v[188:191], v[40:43]
    v_mul_f32 v84, v5, v84
    v_mul_f32 v85, v5, v85
    s_waitcnt lgkmcnt(8)
    v_mfma_f32_16x16x32_bf16 v[44:47], a[28:31], v[188:191], v[44:47]
    s_waitcnt vmcnt(12)
    v_mul_f32 v86, v5, v86
    v_mul_f32 v87, v5, v87
    s_waitcnt lgkmcnt(6)
    v_mfma_f32_16x16x32_bf16 v[32:35], a[32:35], v[192:195], v[32:35]
    buffer_load_dwordx4 v[188:191], v11, s[16:19], s70 offen offset:3072 sc1
    s_waitcnt lgkmcnt(4)
    v_mfma_f32_16x16x32_bf16 v[36:39], a[36:39], v[192:195], v[36:39]
    v_mul_f32 v88, v5, v88
    v_mul_f32 v89, v5, v89
    s_waitcnt lgkmcnt(2)
    v_mfma_f32_16x16x32_bf16 v[40:43], a[40:43], v[192:195], v[40:43]
    v_mul_f32 v90, v5, v90
    v_mul_f32 v91, v5, v91
    s_waitcnt lgkmcnt(0)
    v_mfma_f32_16x16x32_bf16 v[44:47], a[44:47], v[192:195], v[44:47]
    s_waitcnt vmcnt(12)
    v_mul_f32 v92, v5, v92
    v_mul_f32 v93, v5, v93
    v_mul_f32 v94, v5, v94
    v_mul_f32 v95, v5, v95
    v_mfma_f32_16x16x32_bf16 v[48:51], a[224:227], v[196:199], v[48:51]
    buffer_load_dwordx4 v[192:195], v11, s[16:19], s71 offen offset:3072 sc1
    v_mfma_f32_16x16x32_bf16 v[52:55], a[228:231], v[196:199], v[52:55]
    v_mul_f32 v96, v6, v96
    v_mul_f32 v97, v6, v97
    v_mfma_f32_16x16x32_bf16 v[56:59], a[232:235], v[196:199], v[56:59]
    v_mul_f32 v98, v6, v98
    v_mul_f32 v99, v6, v99
    v_mfma_f32_16x16x32_bf16 v[60:63], a[236:239], v[196:199], v[60:63]
    s_waitcnt vmcnt(12)
    v_mul_f32 v100, v6, v100
    v_mul_f32 v101, v6, v101
    v_mfma_f32_16x16x32_bf16 v[48:51], a[240:243], v[200:203], v[48:51]
    ds_write_b128 v15, v[32:35] offset:0
    v_mfma_f32_16x16x32_bf16 v[52:55], a[244:247], v[200:203], v[52:55]
    buffer_load_dwordx2 v[196:197], v13, s[16:19], s72 offen offset:3072 sc1
    buffer_load_dwordx2 v[198:199], v13, s[16:19], s72 offen offset:3584 sc1
    v_mfma_f32_16x16x32_bf16 v[56:59], a[248:251], v[200:203], v[56:59]
    v_mul_f32 v102, v6, v102
    v_mul_f32 v103, v6, v103
    v_mfma_f32_16x16x32_bf16 v[60:63], a[252:255], v[200:203], v[60:63]
    s_waitcnt vmcnt(12)
    v_mul_f32 v104, v6, v104
    v_mul_f32 v105, v6, v105
    v_mul_f32 v106, v6, v106
    v_mul_f32 v107, v6, v107
    v_mul_f32 v108, v6, v108
    v_mul_f32 v109, v6, v109
    v_mfma_f32_16x16x32_bf16 v[48:51], a[0:3], v[204:207], v[48:51]
    ds_write_b128 v16, v[36:39] offset:0
    v_mfma_f32_16x16x32_bf16 v[52:55], a[4:7], v[204:207], v[52:55]
    buffer_load_dwordx4 v[200:203], v11, s[16:19], s73 offen offset:3072 sc1
    v_mfma_f32_16x16x32_bf16 v[56:59], a[8:11], v[204:207], v[56:59]
    v_mul_f32 v110, v6, v110
    v_mul_f32 v111, v6, v111
    v_mfma_f32_16x16x32_bf16 v[60:63], a[12:15], v[204:207], v[60:63]
    s_waitcnt vmcnt(12)
    v_mul_f32 v112, v7, v112
    v_mul_f32 v113, v7, v113
    v_mfma_f32_16x16x32_bf16 v[48:51], a[16:19], v[160:163], v[48:51]
    ds_write_b128 v15, v[40:43] offset:128
    v_mfma_f32_16x16x32_bf16 v[52:55], a[20:23], v[160:163], v[52:55]
    buffer_load_dwordx4 v[204:207], v11, s[16:19], s74 offen offset:3072 sc1
    v_mfma_f32_16x16x32_bf16 v[56:59], a[24:27], v[160:163], v[56:59]
    v_mul_f32 v114, v7, v114
    v_mul_f32 v115, v7, v115
    v_mfma_f32_16x16x32_bf16 v[60:63], a[28:31], v[160:163], v[60:63]
    s_waitcnt vmcnt(12)
    v_mul_f32 v116, v7, v116
    v_mul_f32 v117, v7, v117
    v_mul_f32 v118, v7, v118
    v_mul_f32 v119, v7, v119
    v_mul_f32 v120, v7, v120
    v_mul_f32 v121, v7, v121
    v_mfma_f32_16x16x32_bf16 v[48:51], a[32:35], v[164:167], v[48:51]
    ds_write_b128 v16, v[44:47] offset:128
    v_mfma_f32_16x16x32_bf16 v[52:55], a[36:39], v[164:167], v[52:55]
    buffer_load_dwordx4 v[160:163], v12, s[16:19], s70 offen offset:0 sc1
    v_mfma_f32_16x16x32_bf16 v[56:59], a[40:43], v[164:167], v[56:59]
    v_mul_f32 v122, v7, v122
    v_mul_f32 v123, v7, v123
    v_mfma_f32_16x16x32_bf16 v[60:63], a[44:47], v[164:167], v[60:63]
    s_waitcnt vmcnt(12)
    v_mul_f32 v124, v7, v124
    v_mul_f32 v125, v7, v125
    v_mul_f32 v126, v7, v126
    v_mul_f32 v127, v7, v127
    v_mfma_f32_16x16x32_bf16 v[64:67], a[224:227], v[168:171], v[64:67]
    buffer_load_dwordx4 v[164:167], v12, s[16:19], s71 offen offset:0 sc1
    v_mfma_f32_16x16x32_bf16 v[68:71], a[228:231], v[168:171], v[68:71]
    v_mul_f32 v128, v8, v128
    v_mul_f32 v129, v8, v129
    v_mfma_f32_16x16x32_bf16 v[72:75], a[232:235], v[168:171], v[72:75]
    v_mul_f32 v130, v8, v130
    v_mul_f32 v131, v8, v131
    v_mfma_f32_16x16x32_bf16 v[76:79], a[236:239], v[168:171], v[76:79]
    s_waitcnt vmcnt(12)
    v_mul_f32 v132, v8, v132
    v_mul_f32 v133, v8, v133
    v_mfma_f32_16x16x32_bf16 v[64:67], a[240:243], v[172:175], v[64:67]
    ds_write_b128 v15, v[48:51] offset:16896
    v_mfma_f32_16x16x32_bf16 v[68:71], a[244:247], v[172:175], v[68:71]
    buffer_load_dwordx2 v[168:169], v14, s[16:19], s72 offen offset:0 sc1
    buffer_load_dwordx2 v[170:171], v14, s[16:19], s72 offen offset:512 sc1
    v_mfma_f32_16x16x32_bf16 v[72:75], a[248:251], v[172:175], v[72:75]
    v_mul_f32 v134, v8, v134
    v_mul_f32 v135, v8, v135
    v_mfma_f32_16x16x32_bf16 v[76:79], a[252:255], v[172:175], v[76:79]
    s_waitcnt vmcnt(12)
    v_mul_f32 v136, v8, v136
    v_mul_f32 v137, v8, v137
    v_mul_f32 v138, v8, v138
    v_mul_f32 v139, v8, v139
    v_mul_f32 v140, v8, v140
    v_mul_f32 v141, v8, v141
    v_mfma_f32_16x16x32_bf16 v[64:67], a[0:3], v[176:179], v[64:67]
    ds_write_b128 v16, v[52:55] offset:16896
    v_mfma_f32_16x16x32_bf16 v[68:71], a[4:7], v[176:179], v[68:71]
    buffer_load_dwordx4 v[172:175], v12, s[16:19], s73 offen offset:0 sc1
    v_mfma_f32_16x16x32_bf16 v[72:75], a[8:11], v[176:179], v[72:75]
    v_mul_f32 v142, v8, v142
    v_mul_f32 v143, v8, v143
    v_mfma_f32_16x16x32_bf16 v[76:79], a[12:15], v[176:179], v[76:79]
    s_waitcnt vmcnt(12)
    v_mul_f32 v144, v9, v144
    v_mul_f32 v145, v9, v145
    v_mfma_f32_16x16x32_bf16 v[64:67], a[16:19], v[180:183], v[64:67]
    ds_write_b128 v15, v[56:59] offset:17024
    v_mfma_f32_16x16x32_bf16 v[68:71], a[20:23], v[180:183], v[68:71]
    buffer_load_dwordx4 v[176:179], v12, s[16:19], s74 offen offset:0 sc1
    v_mfma_f32_16x16x32_bf16 v[72:75], a[24:27], v[180:183], v[72:75]
    v_mul_f32 v146, v9, v146
    v_mul_f32 v147, v9, v147
    v_mfma_f32_16x16x32_bf16 v[76:79], a[28:31], v[180:183], v[76:79]
    s_waitcnt vmcnt(12)
    v_mul_f32 v148, v9, v148
    v_mul_f32 v149, v9, v149
    v_mul_f32 v150, v9, v150
    v_mul_f32 v151, v9, v151
    v_mul_f32 v152, v9, v152
    v_mul_f32 v153, v9, v153
    v_mfma_f32_16x16x32_bf16 v[64:67], a[32:35], v[184:187], v[64:67]
    ds_write_b128 v16, v[60:63] offset:17024
    v_mfma_f32_16x16x32_bf16 v[68:71], a[36:39], v[184:187], v[68:71]
    buffer_load_dwordx4 v[180:183], v12, s[16:19], s70 offen offset:1024 sc1
    v_mfma_f32_16x16x32_bf16 v[72:75], a[40:43], v[184:187], v[72:75]
    v_mul_f32 v154, v9, v154
    v_mul_f32 v155, v9, v155
    v_mfma_f32_16x16x32_bf16 v[76:79], a[44:47], v[184:187], v[76:79]
    s_waitcnt vmcnt(12)
    v_mul_f32 v156, v9, v156
    v_mul_f32 v157, v9, v157
    v_mul_f32 v158, v9, v158
    v_mul_f32 v159, v9, v159
    v_mfma_f32_16x16x32_bf16 v[80:83], a[224:227], v[188:191], v[80:83]
    buffer_load_dwordx4 v[184:187], v12, s[16:19], s71 offen offset:1024 sc1
    v_mfma_f32_16x16x32_bf16 v[84:87], a[228:231], v[188:191], v[84:87]
    v_mfma_f32_16x16x32_bf16 v[88:91], a[232:235], v[188:191], v[88:91]
    v_mfma_f32_16x16x32_bf16 v[92:95], a[236:239], v[188:191], v[92:95]
    s_waitcnt vmcnt(12)
    v_mfma_f32_16x16x32_bf16 v[80:83], a[240:243], v[192:195], v[80:83]
    ds_write_b128 v15, v[64:67] offset:33792
    v_mfma_f32_16x16x32_bf16 v[84:87], a[244:247], v[192:195], v[84:87]
    buffer_load_dwordx2 v[188:189], v14, s[16:19], s72 offen offset:1024 sc1
    buffer_load_dwordx2 v[190:191], v14, s[16:19], s72 offen offset:1536 sc1
    v_mfma_f32_16x16x32_bf16 v[88:91], a[248:251], v[192:195], v[88:91]
    v_mfma_f32_16x16x32_bf16 v[92:95], a[252:255], v[192:195], v[92:95]
    s_waitcnt vmcnt(12)
    v_mfma_f32_16x16x32_bf16 v[80:83], a[0:3], v[196:199], v[80:83]
    ds_write_b128 v16, v[68:71] offset:33792
    v_mfma_f32_16x16x32_bf16 v[84:87], a[4:7], v[196:199], v[84:87]
    buffer_load_dwordx4 v[192:195], v12, s[16:19], s73 offen offset:1024 sc1
    v_mfma_f32_16x16x32_bf16 v[88:91], a[8:11], v[196:199], v[88:91]
    v_mfma_f32_16x16x32_bf16 v[92:95], a[12:15], v[196:199], v[92:95]
    s_waitcnt vmcnt(12)
    v_mfma_f32_16x16x32_bf16 v[80:83], a[16:19], v[200:203], v[80:83]
    ds_write_b128 v15, v[72:75] offset:33920
    v_mfma_f32_16x16x32_bf16 v[84:87], a[20:23], v[200:203], v[84:87]
    buffer_load_dwordx4 v[196:199], v12, s[16:19], s74 offen offset:1024 sc1
    v_mfma_f32_16x16x32_bf16 v[88:91], a[24:27], v[200:203], v[88:91]
    v_mfma_f32_16x16x32_bf16 v[92:95], a[28:31], v[200:203], v[92:95]
    s_waitcnt vmcnt(12)
    v_mfma_f32_16x16x32_bf16 v[80:83], a[32:35], v[204:207], v[80:83]
    ds_write_b128 v16, v[76:79] offset:33920
    v_mfma_f32_16x16x32_bf16 v[84:87], a[36:39], v[204:207], v[84:87]
    buffer_load_dwordx4 v[200:203], v12, s[16:19], s70 offen offset:2048 sc1
    v_mfma_f32_16x16x32_bf16 v[88:91], a[40:43], v[204:207], v[88:91]
    s_waitcnt lgkmcnt(0)
    s_barrier
    v_mfma_f32_16x16x32_bf16 v[92:95], a[44:47], v[204:207], v[92:95]
    ds_read_b128 v[32:35], v17 offset:0
    s_waitcnt vmcnt(12)
    v_mfma_f32_16x16x32_bf16 v[96:99], a[224:227], v[160:163], v[96:99]
    buffer_load_dwordx4 v[204:207], v12, s[16:19], s71 offen offset:2048 sc1
    v_mfma_f32_16x16x32_bf16 v[100:103], a[228:231], v[160:163], v[100:103]
    ds_read_b128 v[36:39], v17 offset:4224
    v_mfma_f32_16x16x32_bf16 v[104:107], a[232:235], v[160:163], v[104:107]
    ds_read_b128 v[40:43], v17 offset:8448
    v_mfma_f32_16x16x32_bf16 v[108:111], a[236:239], v[160:163], v[108:111]
    ds_read_b128 v[44:47], v17 offset:12672
    s_waitcnt vmcnt(12)
    v_mfma_f32_16x16x32_bf16 v[96:99], a[240:243], v[164:167], v[96:99]
    ds_write_b128 v15, v[80:83] offset:50688
    ds_read_b128 v[48:51], v17 offset:16896
    v_mfma_f32_16x16x32_bf16 v[100:103], a[244:247], v[164:167], v[100:103]
    ds_read_b128 v[52:55], v17 offset:21120
    buffer_load_dwordx2 v[160:161], v14, s[16:19], s72 offen offset:2048 sc1
    buffer_load_dwordx2 v[162:163], v14, s[16:19], s72 offen offset:2560 sc1
    v_mfma_f32_16x16x32_bf16 v[104:107], a[248:251], v[164:167], v[104:107]
    ds_read_b128 v[56:59], v17 offset:25344
    v_mfma_f32_16x16x32_bf16 v[108:111], a[252:255], v[164:167], v[108:111]
    ds_read_b128 v[60:63], v17 offset:29568
    s_waitcnt vmcnt(12)
    s_waitcnt lgkmcnt(7)
    v_add_f32 v32, v32, v36
    v_add_f32 v33, v33, v37
    v_mfma_f32_16x16x32_bf16 v[96:99], a[0:3], v[168:171], v[96:99]
    ds_write_b128 v16, v[84:87] offset:50688
    v_mfma_f32_16x16x32_bf16 v[100:103], a[4:7], v[168:171], v[100:103]
    buffer_load_dwordx4 v[164:167], v12, s[16:19], s73 offen offset:2048 sc1
    v_mfma_f32_16x16x32_bf16 v[104:107], a[8:11], v[168:171], v[104:107]
    v_add_f32 v34, v34, v38
    v_add_f32 v35, v35, v39
    v_mfma_f32_16x16x32_bf16 v[108:111], a[12:15], v[168:171], v[108:111]
    s_waitcnt vmcnt(12)
    s_waitcnt lgkmcnt(6)
    v_add_f32 v40, v40, v44
    v_add_f32 v41, v41, v45
    v_mfma_f32_16x16x32_bf16 v[96:99], a[16:19], v[172:175], v[96:99]
    ds_write_b128 v15, v[88:91] offset:50816
    v_mfma_f32_16x16x32_bf16 v[100:103], a[20:23], v[172:175], v[100:103]
    buffer_load_dwordx4 v[168:171], v12, s[16:19], s74 offen offset:2048 sc1
    v_mfma_f32_16x16x32_bf16 v[104:107], a[24:27], v[172:175], v[104:107]
    v_add_f32 v42, v42, v46
    v_add_f32 v43, v43, v47
    v_mfma_f32_16x16x32_bf16 v[108:111], a[28:31], v[172:175], v[108:111]
    s_waitcnt vmcnt(12)
    v_add_f32 v32, v32, v40
    v_add_f32 v33, v33, v41
    v_mfma_f32_16x16x32_bf16 v[96:99], a[32:35], v[176:179], v[96:99]
    ds_write_b128 v16, v[92:95] offset:50816
    v_mfma_f32_16x16x32_bf16 v[100:103], a[36:39], v[176:179], v[100:103]
    buffer_load_dwordx4 v[172:175], v12, s[16:19], s70 offen offset:3072 sc1
    v_mfma_f32_16x16x32_bf16 v[104:107], a[40:43], v[176:179], v[104:107]
    v_add_f32 v34, v34, v42
    v_add_f32 v35, v35, v43
    v_mfma_f32_16x16x32_bf16 v[108:111], a[44:47], v[176:179], v[108:111]
    s_waitcnt vmcnt(12)
    v_cvt_pk_bf16_f32 v32, v32, v33
    v_cvt_pk_bf16_f32 v33, v34, v35
    v_mfma_f32_16x16x32_bf16 v[112:115], a[224:227], v[180:183], v[112:115]
    buffer_load_dwordx4 v[176:179], v12, s[16:19], s71 offen offset:3072 sc1
    v_mfma_f32_16x16x32_bf16 v[116:119], a[228:231], v[180:183], v[116:119]
    buffer_store_dwordx2 v[32:33], v18, s[28:31], 0 offen sc1
    v_mfma_f32_16x16x32_bf16 v[120:123], a[232:235], v[180:183], v[120:123]
    ds_read_b128 v[64:67], v17 offset:33792
    v_mfma_f32_16x16x32_bf16 v[124:127], a[236:239], v[180:183], v[124:127]
    ds_read_b128 v[68:71], v17 offset:38016
    s_waitcnt vmcnt(13)
    v_mfma_f32_16x16x32_bf16 v[112:115], a[240:243], v[184:187], v[112:115]
    ds_read_b128 v[72:75], v17 offset:42240
    v_add_u32 v15, 67584, v15
    v_add_u32 v16, 67584, v16
    ds_write_b128 v15, v[96:99] offset:0
    v_mfma_f32_16x16x32_bf16 v[116:119], a[244:247], v[184:187], v[116:119]
    buffer_load_dwordx2 v[180:181], v14, s[16:19], s72 offen offset:3072 sc1
    buffer_load_dwordx2 v[182:183], v14, s[16:19], s72 offen offset:3584 sc1
    v_mfma_f32_16x16x32_bf16 v[120:123], a[248:251], v[184:187], v[120:123]
    ds_read_b128 v[76:79], v17 offset:46464
    s_waitcnt lgkmcnt(10)
    v_add_f32 v48, v48, v52
    v_mfma_f32_16x16x32_bf16 v[124:127], a[252:255], v[184:187], v[124:127]
    s_waitcnt vmcnt(13)
    v_add_f32 v49, v49, v53
    v_add_f32 v50, v50, v54
    v_mfma_f32_16x16x32_bf16 v[112:115], a[0:3], v[188:191], v[112:115]
    ds_write_b128 v16, v[100:103] offset:0
    v_mfma_f32_16x16x32_bf16 v[116:119], a[4:7], v[188:191], v[116:119]
    buffer_load_dwordx4 v[184:187], v12, s[16:19], s73 offen offset:3072 sc1
    v_mfma_f32_16x16x32_bf16 v[120:123], a[8:11], v[188:191], v[120:123]
    v_add_f32 v51, v51, v55
    s_waitcnt lgkmcnt(9)
    v_add_f32 v56, v56, v60
    v_mfma_f32_16x16x32_bf16 v[124:127], a[12:15], v[188:191], v[124:127]
    s_waitcnt vmcnt(13)
    v_add_f32 v57, v57, v61
    v_add_f32 v58, v58, v62
    v_mfma_f32_16x16x32_bf16 v[112:115], a[16:19], v[192:195], v[112:115]
    ds_write_b128 v15, v[104:107] offset:128
    v_mfma_f32_16x16x32_bf16 v[116:119], a[20:23], v[192:195], v[116:119]
    buffer_load_dwordx4 v[188:191], v12, s[16:19], s74 offen offset:3072 sc1
    v_mfma_f32_16x16x32_bf16 v[120:123], a[24:27], v[192:195], v[120:123]
    v_add_f32 v59, v59, v63
    v_add_f32 v48, v48, v56
    v_mfma_f32_16x16x32_bf16 v[124:127], a[28:31], v[192:195], v[124:127]
    s_waitcnt vmcnt(13)
    v_add_f32 v49, v49, v57
    v_add_f32 v50, v50, v58
    v_mfma_f32_16x16x32_bf16 v[112:115], a[32:35], v[196:199], v[112:115]
    ds_write_b128 v16, v[108:111] offset:128
    v_mfma_f32_16x16x32_bf16 v[116:119], a[36:39], v[196:199], v[116:119]
    v_add_f32 v51, v51, v59
    v_cvt_pk_bf16_f32 v48, v48, v49
    v_mfma_f32_16x16x32_bf16 v[120:123], a[40:43], v[196:199], v[120:123]
    v_cvt_pk_bf16_f32 v49, v50, v51
    v_mfma_f32_16x16x32_bf16 v[124:127], a[44:47], v[196:199], v[124:127]
    s_waitcnt vmcnt(12)
    v_add_u32 v18, 20480, v18
    v_mfma_f32_16x16x32_bf16 v[128:131], a[224:227], v[200:203], v[128:131]
    buffer_store_dwordx2 v[48:49], v18, s[28:31], 0 offen sc1
    v_mfma_f32_16x16x32_bf16 v[132:135], a[228:231], v[200:203], v[132:135]
    s_waitcnt lgkmcnt(6)
    v_add_f32 v64, v64, v68
    v_mfma_f32_16x16x32_bf16 v[136:139], a[232:235], v[200:203], v[136:139]
    v_add_f32 v65, v65, v69
    v_mfma_f32_16x16x32_bf16 v[140:143], a[236:239], v[200:203], v[140:143]
    s_waitcnt vmcnt(12)
    v_add_f32 v66, v66, v70
    v_mfma_f32_16x16x32_bf16 v[128:131], a[240:243], v[204:207], v[128:131]
    ds_write_b128 v15, v[112:115] offset:16896
    v_mfma_f32_16x16x32_bf16 v[132:135], a[244:247], v[204:207], v[132:135]
    v_add_f32 v67, v67, v71
    s_waitcnt lgkmcnt(4)
    v_add_f32 v72, v72, v76
    v_mfma_f32_16x16x32_bf16 v[136:139], a[248:251], v[204:207], v[136:139]
    v_add_f32 v73, v73, v77
    v_mfma_f32_16x16x32_bf16 v[140:143], a[252:255], v[204:207], v[140:143]
    s_waitcnt vmcnt(10)
    v_add_f32 v74, v74, v78
    v_mfma_f32_16x16x32_bf16 v[128:131], a[0:3], v[160:163], v[128:131]
    ds_write_b128 v16, v[116:119] offset:16896
    v_mfma_f32_16x16x32_bf16 v[132:135], a[4:7], v[160:163], v[132:135]
    v_add_f32 v75, v75, v79
    v_add_f32 v64, v64, v72
    v_mfma_f32_16x16x32_bf16 v[136:139], a[8:11], v[160:163], v[136:139]
    v_add_f32 v65, v65, v73
    v_mfma_f32_16x16x32_bf16 v[140:143], a[12:15], v[160:163], v[140:143]
    s_waitcnt vmcnt(9)
    v_add_f32 v66, v66, v74
    v_mfma_f32_16x16x32_bf16 v[128:131], a[16:19], v[164:167], v[128:131]
    ds_write_b128 v15, v[120:123] offset:17024
    v_mfma_f32_16x16x32_bf16 v[132:135], a[20:23], v[164:167], v[132:135]
    v_add_f32 v67, v67, v75
    v_cvt_pk_bf16_f32 v64, v64, v65
    v_mfma_f32_16x16x32_bf16 v[136:139], a[24:27], v[164:167], v[136:139]
    v_cvt_pk_bf16_f32 v65, v66, v67
    v_mfma_f32_16x16x32_bf16 v[140:143], a[28:31], v[164:167], v[140:143]
    s_waitcnt vmcnt(8)
    v_add_u32 v18, 20480, v18
    v_mfma_f32_16x16x32_bf16 v[128:131], a[32:35], v[168:171], v[128:131]
    ds_write_b128 v16, v[124:127] offset:17024
    v_mfma_f32_16x16x32_bf16 v[132:135], a[36:39], v[168:171], v[132:135]
    buffer_store_dwordx2 v[64:65], v18, s[28:31], 0 offen sc1
    v_mfma_f32_16x16x32_bf16 v[136:139], a[40:43], v[168:171], v[136:139]
    s_waitcnt lgkmcnt(0)
    s_barrier
    v_mfma_f32_16x16x32_bf16 v[140:143], a[44:47], v[168:171], v[140:143]
    ds_read_b128 v[80:83], v17 offset:50688
    s_waitcnt vmcnt(8)
    v_mfma_f32_16x16x32_bf16 v[144:147], a[224:227], v[172:175], v[144:147]
    ds_read_b128 v[84:87], v17 offset:54912
    v_mfma_f32_16x16x32_bf16 v[148:151], a[228:231], v[172:175], v[148:151]
    ds_read_b128 v[88:91], v17 offset:59136
    ds_read_b128 v[92:95], v17 offset:63360
    v_mfma_f32_16x16x32_bf16 v[152:155], a[232:235], v[172:175], v[152:155]
    v_add_u32 v17, 67584, v17
    ds_read_b128 v[96:99], v17 offset:0
    ds_read_b128 v[100:103], v17 offset:4224
    v_mfma_f32_16x16x32_bf16 v[156:159], a[236:239], v[172:175], v[156:159]
    ds_read_b128 v[104:107], v17 offset:8448
    ds_read_b128 v[108:111], v17 offset:12672
    s_waitcnt vmcnt(7)
    s_waitcnt lgkmcnt(6)
    v_add_f32 v80, v80, v84
    v_add_f32 v81, v81, v85
    v_add_f32 v82, v82, v86
    v_add_f32 v83, v83, v87
    v_mfma_f32_16x16x32_bf16 v[144:147], a[240:243], v[176:179], v[144:147]
    ds_write_b128 v15, v[128:131] offset:33792
    v_mfma_f32_16x16x32_bf16 v[148:151], a[244:247], v[176:179], v[148:151]
    s_waitcnt lgkmcnt(5)
    v_add_f32 v88, v88, v92
    v_add_f32 v89, v89, v93
    v_add_f32 v90, v90, v94
    v_mfma_f32_16x16x32_bf16 v[152:155], a[248:251], v[176:179], v[152:155]
    v_add_f32 v91, v91, v95
    v_add_f32 v80, v80, v88
    v_add_f32 v81, v81, v89
    v_mfma_f32_16x16x32_bf16 v[156:159], a[252:255], v[176:179], v[156:159]
    s_waitcnt vmcnt(4)
    v_add_f32 v82, v82, v90
    v_add_f32 v83, v83, v91
    v_cvt_pk_bf16_f32 v80, v80, v81
    v_cvt_pk_bf16_f32 v81, v82, v83
    v_add_u32 v18, 20480, v18
    buffer_store_dwordx2 v[80:81], v18, s[28:31], 0 offen sc1
    v_mfma_f32_16x16x32_bf16 v[144:147], a[0:3], v[180:183], v[144:147]
    ds_write_b128 v16, v[132:135] offset:33792
    v_mfma_f32_16x16x32_bf16 v[148:151], a[4:7], v[180:183], v[148:151]
    ds_read_b128 v[112:115], v17 offset:16896
    ds_read_b128 v[116:119], v17 offset:21120
    ds_read_b128 v[120:123], v17 offset:25344
    v_mfma_f32_16x16x32_bf16 v[152:155], a[8:11], v[180:183], v[152:155]
    ds_read_b128 v[124:127], v17 offset:29568
    s_waitcnt lgkmcnt(8)
    v_add_f32 v96, v96, v100
    v_add_f32 v97, v97, v101
    v_mfma_f32_16x16x32_bf16 v[156:159], a[12:15], v[180:183], v[156:159]
    s_waitcnt vmcnt(4)
    v_add_f32 v98, v98, v102
    v_add_f32 v99, v99, v103
    s_waitcnt lgkmcnt(6)
    v_add_f32 v104, v104, v108
    v_add_f32 v105, v105, v109
    v_add_f32 v106, v106, v110
    v_add_f32 v107, v107, v111
    v_mfma_f32_16x16x32_bf16 v[144:147], a[16:19], v[184:187], v[144:147]
    ds_write_b128 v15, v[136:139] offset:33920
    v_mfma_f32_16x16x32_bf16 v[148:151], a[20:23], v[184:187], v[148:151]
    v_add_f32 v96, v96, v104
    v_add_f32 v97, v97, v105
    v_add_f32 v98, v98, v106
    v_mfma_f32_16x16x32_bf16 v[152:155], a[24:27], v[184:187], v[152:155]
    v_add_f32 v99, v99, v107
    v_cvt_pk_bf16_f32 v96, v96, v97
    v_cvt_pk_bf16_f32 v97, v98, v99
    v_mfma_f32_16x16x32_bf16 v[156:159], a[28:31], v[184:187], v[156:159]
    s_waitcnt vmcnt(3)
    v_add_u32 v18, 20480, v18
    buffer_store_dwordx2 v[96:97], v18, s[28:31], 0 offen sc1
    s_waitcnt lgkmcnt(3)
    v_add_f32 v112, v112, v116
    v_add_f32 v113, v113, v117
    v_add_f32 v114, v114, v118
    v_add_f32 v115, v115, v119
    v_mfma_f32_16x16x32_bf16 v[144:147], a[32:35], v[188:191], v[144:147]
    ds_write_b128 v16, v[140:143] offset:33920
    v_mfma_f32_16x16x32_bf16 v[148:151], a[36:39], v[188:191], v[148:151]
    s_waitcnt lgkmcnt(2)
    v_add_f32 v120, v120, v124
    v_add_f32 v121, v121, v125
    v_add_f32 v122, v122, v126
    v_mfma_f32_16x16x32_bf16 v[152:155], a[40:43], v[188:191], v[152:155]
    v_add_f32 v123, v123, v127
    v_add_f32 v112, v112, v120
    v_add_f32 v113, v113, v121
    v_mfma_f32_16x16x32_bf16 v[156:159], a[44:47], v[188:191], v[156:159]
    v_add_f32 v114, v114, v122
    v_add_f32 v115, v115, v123
    v_cvt_pk_bf16_f32 v112, v112, v113
    v_cvt_pk_bf16_f32 v113, v114, v115
    v_add_u32 v18, 20480, v18
    buffer_store_dwordx2 v[112:113], v18, s[28:31], 0 offen sc1
    ds_write_b128 v15, v[144:147] offset:50688
    ds_write_b128 v16, v[148:151] offset:50688
    ds_write_b128 v15, v[152:155] offset:50816
    ds_write_b128 v16, v[156:159] offset:50816
    s_waitcnt lgkmcnt(0)
    s_barrier
    ds_read_b128 v[128:131], v17 offset:33792
    ds_read_b128 v[132:135], v17 offset:38016
    ds_read_b128 v[136:139], v17 offset:42240
    ds_read_b128 v[140:143], v17 offset:46464
    ds_read_b128 v[144:147], v17 offset:50688
    ds_read_b128 v[148:151], v17 offset:54912
    ds_read_b128 v[152:155], v17 offset:59136
    ds_read_b128 v[156:159], v17 offset:63360
    s_waitcnt lgkmcnt(6)
    v_add_f32 v128, v128, v132
    v_add_f32 v129, v129, v133
    v_add_f32 v130, v130, v134
    v_add_f32 v131, v131, v135
    s_waitcnt lgkmcnt(4)
    v_add_f32 v136, v136, v140
    v_add_f32 v137, v137, v141
    v_add_f32 v138, v138, v142
    v_add_f32 v139, v139, v143
    v_add_f32 v128, v128, v136
    v_add_f32 v129, v129, v137
    v_add_f32 v130, v130, v138
    v_add_f32 v131, v131, v139
    v_cvt_pk_bf16_f32 v128, v128, v129
    v_cvt_pk_bf16_f32 v129, v130, v131
    v_add_u32 v18, 20480, v18
    buffer_store_dwordx2 v[128:129], v18, s[28:31], 0 offen sc1
    s_waitcnt lgkmcnt(2)
    v_add_f32 v144, v144, v148
    v_add_f32 v145, v145, v149
    v_add_f32 v146, v146, v150
    v_add_f32 v147, v147, v151
    s_waitcnt lgkmcnt(0)
    v_add_f32 v152, v152, v156
    v_add_f32 v153, v153, v157
    v_add_f32 v154, v154, v158
    v_add_f32 v155, v155, v159
    v_add_f32 v144, v144, v152
    v_add_f32 v145, v145, v153
    v_add_f32 v146, v146, v154
    v_add_f32 v147, v147, v155
    v_cvt_pk_bf16_f32 v144, v144, v145
    v_cvt_pk_bf16_f32 v145, v146, v147
    v_add_u32 v18, 20480, v18
    buffer_store_dwordx2 v[144:145], v18, s[28:31], 0 offen sc1
    s_endpgm
L_A:
    s_lshr_b32 s49, s60, 2
    s_mul_i32 s49, s49, 6
    s_and_b32 s50, s60, 3
    s_lshl_b32 s50, s50, 1
    s_add_u32 s49, s49, s51
    s_cmp_ge_u32 s51, 6
    s_cselect_b32 s61, 6, 0
    s_cselect_b32 s62, 1, 0
    s_sub_u32 s49, s49, s61
    s_add_u32 s50, s50, s62
    s_mul_i32 s56, s60, 12
    s_mov_b32 s14, 2457600
    s_mov_b32 s15, 0x20000
    v_mul_u32_u24 v24, 205, v1
    s_mul_i32 s60, s48, 30720
    v_lshrrev_b32 v24, 11, v24
    s_mul_i32 s61, s50, 160
    v_mad_i32_i24 v25, v24, -10, v1
    s_add_u32 s60, s60, s61
    v_mul_u32_u24 v26, 1280, v24
    v_cmp_le_u32 vcc, 3, v24
    v_lshl_add_u32 v26, v25, 4, v26
    v_mov_b32 v27, 11520
    v_cndmask_b32 v27, 0, v27, vcc
    v_add3_u32 v26, v26, v27, s60
    v_mov_b32 v27, 2146435072
    v_cmp_gt_u32 vcc, 60, v1
    s_mul_i32 s66, s48, 4224
    s_add_u32 s52, s66, 0
    v_cndmask_b32 v2, v27, v26, vcc
    v_add_u32 v3, 2784, v2
    v_add_u32 v4, 5568, v2
    v_add_u32 v5, 8352, v2
    s_add_u32 m0, s52, 0
    s_mov_b32 s54, 0
    s_waitcnt lgkmcnt(0)
    buffer_load_dwordx4 v2, s[12:15], s54 offen offset:0  lds
    buffer_load_dwordx4 v3, s[12:15], s54 offen offset:1056  lds
    buffer_load_dwordx4 v4, s[12:15], s54 offen offset:2112  lds
    buffer_load_dwordx4 v5, s[12:15], s54 offen offset:3168  lds
    v_lshrrev_b32 v24, 3, v1
    s_mul_i32 s60, s49, 176
    v_and_b32 v26, 7, v1
    s_mul_i32 s61, s48, 48
    v_lshrrev_b32 v27, 4, v1
    s_add_u32 s60, s60, s61
    v_xor_b32 v28, v26, v27
    s_sub_u32 s60, s60, 16
    v_xor_b32 v29, 4, v28
    s_mul_i32 s53, s48, 6144
    v_add_u32 v24, s60, v24
    s_add_u32 s53, s53, 84480
    v_lshlrev_b32 v28, 4, v28
    v_lshlrev_b32 v29, 4, v29
    s_movk_i32 s61, 1280
    v_add_u32 v25, 0, v24
    v_max_i32 v25, 0, v25
    v_mad_u32_u24 v6, v25, s61, v28
    v_add_u32 v25, 8, v24
    v_max_i32 v25, 1, v25
    v_mad_u32_u24 v7, v25, s61, v29
    v_subrev_u32 v7, 1024, v7
    v_add_u32 v25, 16, v24
    v_mad_u32_u24 v8, v25, s61, v28
    v_subrev_u32 v8, 2048, v8
    v_add_u32 v25, 24, v24
    v_mad_u32_u24 v9, v25, s61, v29
    v_subrev_u32 v9, 3072, v9
    v_add_u32 v25, 32, v24
    v_mad_u32_u24 v10, v25, s61, v28
    v_add_u32 v25, 40, v24
    v_mad_u32_u24 v11, v25, s61, v29
    v_subrev_u32 v11, 1024, v11
    s_add_u32 m0, s53, 0
    s_mov_b32 s55, 0
    buffer_load_dwordx4 v6, s[8:11], s55 offen offset:0  lds
    buffer_load_dwordx4 v7, s[8:11], s55 offen offset:1024  lds
    buffer_load_dwordx4 v8, s[8:11], s55 offen offset:2048  lds
    buffer_load_dwordx4 v9, s[8:11], s55 offen offset:3072  lds
    s_mov_b32 s18, 268435456
    s_mov_b32 s19, 0x20000
    s_mov_b32 s42, 256
    s_mov_b32 s43, 0x20000
    s_mov_b32 s34, 1280
    s_mov_b32 s35, 0x20000
    s_mov_b32 s46, 2211840
    s_mov_b32 s47, 0x20000
    s_mov_b32 s22, 2211840
    s_mov_b32 s23, 0x20000
    s_mov_b32 s26, 819200
    s_mov_b32 s27, 0x20000
    s_add_u32 m0, s53, 4096
    s_nop 0
    buffer_load_dwordx4 v10, s[8:11], s55 offen offset:0  lds
    buffer_load_dwordx4 v11, s[8:11], s55 offen offset:1024  lds
    s_mul_i32 s60, s48, 320
    s_add_u32 m0, s60, 158208
    v_lshl_add_u32 v24, v1, 4, s60
    s_mov_b64 exec, 0xfffff
    buffer_load_dwordx4 v24, s[32:35], 0 offen lds
    s_mov_b64 exec, -1
    s_mul_i32 s60, s49, 8
    s_add_u32 s60, s60, s50
    s_lshl_b32 s60, s60, 5
    s_add_u32 s60, s60, s48
    s_lshl_b32 s60, s60, 2
    s_add_u32 s60, s60, 9961472
    v_mov_b32 v21, 2146435072
    v_mov_b32 v22, 0
    v_writelane_b32 v21, s60, 0
    buffer_store_dword v22, v21, s[16:19], 0 offen sc1
    s_add_u32 s56, s56, s51
    s_lshl_b32 s56, s56, 2
    s_add_u32 s90, s56, s48
    s_lshl_b32 s60, s90, 11
    v_min_u32 v19, 15, v1
    v_lshl_add_u32 v19, v19, 7, s60
    v_min_u32 v24, 23, v1
    v_lshrrev_b32 v25, 2, v24
    v_and_b32 v24, 3, v24
    v_mul_u32_u24 v25, 1280, v25
    s_mul_i32 s60, s90, 7680
    v_lshl_add_u32 v24, v24, 7, s60
    v_add_u32 v20, v24, v25
    s_mov_b32 s56, 256
    buffer_load_dword v23, v20, s[8:11], s56 offen
    s_mov_b32 s56, 635904
    buffer_load_dword v23, v19, s[44:47], s56 offen
    v_and_b32 v24, 15, v1
    v_lshrrev_b32 v25, 4, v1
    v_lshrrev_b32 v26, 1, v24
    v_xor_b32 v26, v26, v25
    v_lshlrev_b32 v26, 4, v26
    v_lshl_add_u32 v26, v24, 7, v26
    v_xor_b32 v27, 64, v26
    v_add_u32 v12, s53, v26
    v_add_u32 v13, s53, v27
    v_lshrrev_b32 v28, 2, v1
    v_mul_u32_u24 v28, 1056, v28
    v_and_b32 v29, 3, v1
    v_lshl_add_u32 v17, v29, 3, v28
    v_lshlrev_b32 v14, 4, v25
    v_add_u32 v14, 158208, v14
    v_mad_u32_u24 v15, v29, 40, v28
    v_add_u32 v16, 50688, v15
    v_add_u32 v18, 50688, v17
    v_and_b32 v24, 15, v1
    v_lshrrev_b32 v25, 4, v1
    v_and_b32 v26, 1, v1
    v_cmp_eq_u32 s[76:77], 1, v26
    v_lshl_add_u32 v27, v25, 2, v26
    v_cmp_le_u32 s[78:79], v27, v24
    v_add_u32 v27, 2, v27
    v_cmp_le_u32 s[80:81], v27, v24
    v_cmp_eq_u32 s[82:83], 1, v25
    v_cmp_eq_u32 s[84:85], 2, v25
    v_cmp_eq_u32 s[86:87], 3, v25
    v_mov_b32 v24, 0x0c0c0100
    v_mov_b32 v25, 0x01000c0c
    v_cndmask_b32 v24, v24, v25, s[76:77]
    v_mov_b32 v25, 0x0c0c0302
    v_mov_b32 v26, 0x03020c0c
    v_cndmask_b32 v25, v25, v26, s[76:77]
    v_mov_b32 v26, 0x0c0c0c0c
    v_cndmask_b32 v28, v24, v26, s[78:79]
    v_cndmask_b32 v29, v25, v26, s[80:81]
    v_cndmask_b32 v30, v26, v24, s[78:79]
    v_cndmask_b32 v31, v26, v25, s[80:81]
    s_lshr_b32 s60, s50, 1
    s_lshl_b32 s63, s60, 13
    s_add_u32 s73, s63, 9699328
    s_mul_i32 s60, s60, 5
    s_add_u32 s60, s60, 54
    s_and_b32 s61, s50, 1
    s_mul_i32 s62, s61, 3
    s_add_u32 s62, s62, s60
    s_lshl_b32 s92, s62, 17
    s_add_u32 s93, s92, 131072
    s_add_u32 s60, s60, 2
    s_lshl_b32 s60, s60, 17
    s_lshl_b32 s62, s61, 9
    s_add_u32 s91, s60, s62
    s_or_b32 s61, s49, s48
    s_cmp_eq_u32 s61, 0
    s_cselect_b32 s94, 0xff800000, 0
    s_mov_b32 s95, 0x3ea52b5c
    s_mul_i32 s60, s49, 11
    s_mul_i32 s61, s48, 3
    s_add_u32 s60, s60, s61
    s_sub_u32 s60, s60, 1
    s_add_u32 s61, s60, 0
    s_lshl_b32 s62, s61, 10
    s_lshl_b32 s63, s61, 6
    s_cmp_lt_u32 s61, 128
    s_cselect_b32 s96, s62, 2146435072
    s_cselect_b32 s70, s63, 2146435072
    s_add_u32 s61, s60, 1
    s_lshl_b32 s62, s61, 10
    s_lshl_b32 s63, s61, 6
    s_cmp_lt_u32 s61, 128
    s_cselect_b32 s97, s62, 2146435072
    s_cselect_b32 s71, s63, 2146435072
    s_add_u32 s61, s60, 2
    s_lshl_b32 s62, s61, 10
    s_lshl_b32 s63, s61, 6
    s_cmp_lt_u32 s61, 128
    s_cselect_b32 s98, s62, 2146435072
    s_cselect_b32 s72, s63, 2146435072
    s_cmp_eq_u32 s48, 0
    s_cselect_b32 s96, 2146435072, s96
    s_cselect_b32 s70, 2146435072, s70
    s_bitcmp1_b32 s50, 0
    s_cselect_b32 s70, 2146435072, s70
    s_cselect_b32 s71, 2146435072, s71
    s_cselect_b32 s72, 2146435072, s72
    s_add_u32 m0, s52, 16896
    s_add_u32 s54, s54, 122880
    buffer_load_dwordx4 v2, s[12:15], s54 offen offset:0  lds
    buffer_load_dwordx4 v3, s[12:15], s54 offen offset:1056  lds
    buffer_load_dwordx4 v4, s[12:15], s54 offen offset:2112  lds
    buffer_load_dwordx4 v5, s[12:15], s54 offen offset:3168  lds
    s_add_u32 m0, s53, 24576
    s_add_u32 s55, s55, 128
    buffer_load_dwordx4 v6, s[8:11], s55 offen offset:0  lds
    buffer_load_dwordx4 v7, s[8:11], s55 offen offset:1024  lds
    buffer_load_dwordx4 v8, s[8:11], s55 offen offset:2048  lds
    buffer_load_dwordx4 v9, s[8:11], s55 offen offset:3072  lds
    s_add_u32 m0, s53, 28672
    s_nop 0
    buffer_load_dwordx4 v10, s[8:11], s55 offen offset:0  lds
    buffer_load_dwordx4 v11, s[8:11], s55 offen offset:1024  lds
    s_waitcnt vmcnt(13)
    s_barrier
    ds_read_b128 a[32:35], v12 offset:0
    ds_read_b64_tr_b16 a[0:1], v15 offset:0
    ds_read_b128 a[36:39], v12 offset:2048
    ds_read_b64_tr_b16 a[2:3], v15 offset:480
    ds_read_b128 a[40:43], v12 offset:4096
    ds_read_b64_tr_b16 a[4:5], v15 offset:8
    ds_read_b64_tr_b16 a[6:7], v15 offset:488
    ds_read_b64_tr_b16 a[8:9], v15 offset:16
    ds_read_b64_tr_b16 a[10:11], v15 offset:496
    s_waitcnt lgkmcnt(5)
    v_mfma_f32_16x16x32_bf16 v[144:147], a[0:3], a[32:35], 0
    ds_read_b64_tr_b16 a[12:13], v15 offset:24
    s_add_u32 m0, s52, 33792
    s_add_u32 s54, s54, 122880
    v_mfma_f32_16x16x32_bf16 v[104:107], a[0:3], a[36:39], 0
    ds_read_b64_tr_b16 a[14:15], v15 offset:504
    buffer_load_dwordx4 v2, s[12:15], s54 offen offset:0  lds
    s_waitcnt lgkmcnt(6)
    v_mfma_f32_16x16x32_bf16 v[64:67], a[0:3], a[40:43], 0
    s_waitcnt lgkmcnt(4)
    s_and_b32 s3, s2, 15
    v_mfma_f32_16x16x32_bf16 v[148:151], a[4:7], a[32:35], 0
    ds_read_b64_tr_b16 a[16:17], v15 offset:32
    buffer_load_dwordx4 v3, s[12:15], s54 offen offset:1056  lds
    v_mfma_f32_16x16x32_bf16 v[108:111], a[4:7], a[36:39], 0
    ds_read_b64_tr_b16 a[18:19], v15 offset:512
    s_waitcnt lgkmcnt(4)
    v_mfma_f32_16x16x32_bf16 v[68:71], a[4:7], a[40:43], 0
    ds_read_b64_tr_b16 a[20:21], v15 offset:160
    s_lshl_b32 s3, s3, 4
    v_mfma_f32_16x16x32_bf16 v[152:155], a[8:11], a[32:35], 0
    buffer_load_dwordx4 v4, s[12:15], s54 offen offset:2112  lds
    v_mfma_f32_16x16x32_bf16 v[112:115], a[8:11], a[36:39], 0
    ds_read_b64_tr_b16 a[22:23], v15 offset:640
    s_waitcnt lgkmcnt(4)
    v_mfma_f32_16x16x32_bf16 v[72:75], a[8:11], a[40:43], 0
    ds_read_b64_tr_b16 a[0:1], v15 offset:168
    buffer_load_dwordx4 v5, s[12:15], s54 offen offset:3168  lds
    v_mfma_f32_16x16x32_bf16 v[156:159], a[12:15], a[32:35], 0
    s_add_u32 m0, s52, 50688
    s_add_u32 s54, s54, 122880
    v_mfma_f32_16x16x32_bf16 v[116:119], a[12:15], a[36:39], 0
    ds_read_b64_tr_b16 a[2:3], v15 offset:648
    s_waitcnt lgkmcnt(4)
    v_mfma_f32_16x16x32_bf16 v[76:79], a[12:15], a[40:43], 0
    ds_read_b128 a[44:47], v14 offset:0
    buffer_load_dwordx4 v2, s[12:15], s54 offen offset:0  lds
    v_mfma_f32_16x16x32_bf16 v[160:163], a[16:19], a[32:35], 0
    ds_read_b64_tr_b16 a[4:5], v15 offset:176
    v_mfma_f32_16x16x32_bf16 v[120:123], a[16:19], a[36:39], 0
    buffer_load_dwordx4 v3, s[12:15], s54 offen offset:1056  lds
    v_mfma_f32_16x16x32_bf16 v[80:83], a[16:19], a[40:43], 0
    ds_read_b64_tr_b16 a[6:7], v15 offset:656
    s_waitcnt lgkmcnt(5)
    v_mfma_f32_16x16x32_bf16 v[164:167], a[20:23], a[32:35], 0
    ds_read_b64_tr_b16 a[8:9], v15 offset:184
    v_mfma_f32_16x16x32_bf16 v[124:127], a[20:23], a[36:39], 0
    buffer_load_dwordx4 v4, s[12:15], s54 offen offset:2112  lds
    v_mfma_f32_16x16x32_bf16 v[84:87], a[20:23], a[40:43], 0
    ds_read_b64_tr_b16 a[10:11], v15 offset:664
    s_waitcnt lgkmcnt(5)
    v_mfma_f32_16x16x32_bf16 v[168:171], a[0:3], a[32:35], 0
    ds_read_b64_tr_b16 a[12:13], v15 offset:192
    buffer_load_dwordx4 v5, s[12:15], s54 offen offset:3168  lds
    v_mfma_f32_16x16x32_bf16 v[128:131], a[0:3], a[36:39], 0
    ds_read_b64_tr_b16 a[14:15], v15 offset:672
    s_add_u32 m0, s53, 49152
    v_mfma_f32_16x16x32_bf16 v[88:91], a[0:3], a[40:43], 0
    s_add_u32 s55, s55, 128
    s_waitcnt lgkmcnt(4)
    v_mfma_f32_16x16x32_bf16 v[172:175], a[4:7], a[32:35], 0
    ds_read_b64_tr_b16 a[16:17], v17 offset:320
    buffer_load_dwordx4 v6, s[8:11], s55 offen offset:0  lds
    v_mfma_f32_16x16x32_bf16 v[132:135], a[4:7], a[36:39], 0
    ds_read_b64_tr_b16 a[18:19], v17 offset:800
    s_waitcnt lgkmcnt(4)
    v_mfma_f32_16x16x32_bf16 v[92:95], a[4:7], a[40:43], 0
    ds_read_b64_tr_b16 a[20:21], v17 offset:360
    buffer_load_dwordx4 v7, s[8:11], s55 offen offset:1024  lds
    v_mfma_f32_16x16x32_bf16 v[176:179], a[8:11], a[32:35], 0
    s_cmp_eq_u32 s48, 0
    s_cselect_b32 s3, s3, 2146435072
    v_mov_b32 v32, 2146435072
    v_mfma_f32_16x16x32_bf16 v[136:139], a[8:11], a[36:39], 0
    ds_read_b64_tr_b16 a[22:23], v17 offset:840
    s_waitcnt lgkmcnt(4)
    v_mfma_f32_16x16x32_bf16 v[96:99], a[8:11], a[40:43], 0
    ds_read_b64_tr_b16 a[0:1], v17 offset:400
    buffer_load_dwordx4 v8, s[8:11], s55 offen offset:2048  lds
    v_mfma_f32_16x16x32_bf16 v[180:183], a[12:15], a[32:35], 0
    v_mov_b32 v33, 1
    v_writelane_b32 v32, s3, 0
    v_mfma_f32_16x16x32_bf16 v[140:143], a[12:15], a[36:39], 0
    ds_read_b64_tr_b16 a[2:3], v17 offset:880
    buffer_load_dwordx4 v9, s[8:11], s55 offen offset:3072  lds
    s_waitcnt lgkmcnt(4)
    v_mfma_f32_16x16x32_bf16 v[100:103], a[12:15], a[40:43], 0
    ds_read_b64_tr_b16 a[4:5], v17 offset:440
    s_add_u32 m0, s53, 53248
    v_mfma_f32_16x16x32_bf16 v[184:187], a[32:35], a[16:19], 0
    ds_read_b64_tr_b16 a[6:7], v17 offset:920
    v_mfma_f32_16x16x32_bf16 v[188:191], a[36:39], a[16:19], 0
    buffer_load_dwordx4 v10, s[8:11], s55 offen offset:0  lds
    v_mfma_f32_16x16x32_bf16 v[192:195], a[40:43], a[16:19], 0
    ds_read_b64_tr_b16 a[8:9], v15 offset:352
    s_waitcnt lgkmcnt(5)
    v_mfma_f32_16x16x32_bf16 v[196:199], a[32:35], a[20:23], 0
    ds_read_b64_tr_b16 a[10:11], v15 offset:832
    buffer_load_dwordx4 v11, s[8:11], s55 offen offset:1024  lds
    v_mfma_f32_16x16x32_bf16 v[200:203], a[36:39], a[20:23], 0
    s_waitcnt lgkmcnt(4)
    v_mfma_f32_16x16x32_bf16 v[204:207], a[40:43], a[20:23], 0
    s_waitcnt vmcnt(20)
    s_barrier
    v_mfma_f32_16x16x32_bf16 v[208:211], a[32:35], a[0:3], 0
    ds_read_b128 a[48:51], v13 offset:0
    s_add_u32 m0, s52, 67584
    v_mfma_f32_16x16x32_bf16 v[212:215], a[36:39], a[0:3], 0
    ds_read_b64_tr_b16 a[12:13], v15 offset:16896
    s_add_u32 s54, s54, 122880
    v_mfma_f32_16x16x32_bf16 v[216:219], a[40:43], a[0:3], 0
    ds_read_b128 a[52:55], v13 offset:2048
    s_waitcnt lgkmcnt(5)
    v_mfma_f32_16x16x32_bf16 v[244:247], a[44:47], a[32:35], 0
    ds_read_b64_tr_b16 a[14:15], v15 offset:17376
    v_mfma_f32_16x16x32_bf16 v[220:223], a[32:35], a[4:7], 0
    buffer_atomic_add v33, v32, s[40:43], 0 offen sc1
    v_mfma_f32_16x16x32_bf16 v[224:227], a[36:39], a[4:7], 0
    ds_read_b128 a[56:59], v13 offset:4096
    v_mfma_f32_16x16x32_bf16 v[228:231], a[40:43], a[4:7], 0
    buffer_load_dwordx4 v2, s[12:15], s54 offen offset:0  lds
    v_mfma_f32_16x16x32_bf16 v[248:251], a[44:47], a[36:39], 0
    ds_read_b64_tr_b16 a[16:17], v15 offset:16904
    s_waitcnt lgkmcnt(6)
    v_mfma_f32_16x16x32_bf16 v[232:235], a[32:35], a[8:11], 0
    ds_read_b64_tr_b16 a[18:19], v15 offset:17384
    v_mfma_f32_16x16x32_bf16 v[236:239], a[36:39], a[8:11], 0
    ds_read_b64_tr_b16 a[20:21], v15 offset:16912
    v_mfma_f32_16x16x32_bf16 v[240:243], a[40:43], a[8:11], 0
    s_waitcnt lgkmcnt(3)
    v_mfma_f32_16x16x32_bf16 v[252:255], a[44:47], a[40:43], 0
    ds_read_b64_tr_b16 a[22:23], v15 offset:17392
    v_mfma_f32_16x16x32_bf16 v[144:147], a[12:15], a[48:51], v[144:147]
    ds_read_b64_tr_b16 a[0:1], v15 offset:16920
    v_mfma_f32_16x16x32_bf16 v[104:107], a[12:15], a[52:55], v[104:107]
    ds_read_b64_tr_b16 a[2:3], v15 offset:17400
    s_waitcnt lgkmcnt(4)
    v_mfma_f32_16x16x32_bf16 v[64:67], a[12:15], a[56:59], v[64:67]
    ds_read_b64_tr_b16 a[4:5], v15 offset:16928
    s_mov_b32 s56, 768
    v_mfma_f32_16x16x32_bf16 v[148:151], a[16:19], a[48:51], v[148:151]
    buffer_load_dword v23, v20, s[8:11], s56 offen
    v_mfma_f32_16x16x32_bf16 v[108:111], a[16:19], a[52:55], v[108:111]
    ds_read_b64_tr_b16 a[6:7], v15 offset:17408
    s_waitcnt lgkmcnt(4)
    v_mfma_f32_16x16x32_bf16 v[68:71], a[16:19], a[56:59], v[68:71]
    ds_read_b64_tr_b16 a[8:9], v15 offset:17056
    s_mov_b32 s56, 1423872
    v_mfma_f32_16x16x32_bf16 v[152:155], a[20:23], a[48:51], v[152:155]
    buffer_load_dwordx4 v3, s[12:15], s54 offen offset:1056  lds
    v_mfma_f32_16x16x32_bf16 v[112:115], a[20:23], a[52:55], v[112:115]
    ds_read_b64_tr_b16 a[10:11], v15 offset:17536
    s_waitcnt lgkmcnt(4)
    v_mfma_f32_16x16x32_bf16 v[72:75], a[20:23], a[56:59], v[72:75]
    ds_read_b64_tr_b16 a[12:13], v15 offset:17064
    v_mfma_f32_16x16x32_bf16 v[156:159], a[0:3], a[48:51], v[156:159]
    buffer_load_dword v23, v19, s[44:47], s56 offen
    v_mfma_f32_16x16x32_bf16 v[116:119], a[0:3], a[52:55], v[116:119]
    ds_read_b64_tr_b16 a[14:15], v15 offset:17544
    s_waitcnt lgkmcnt(4)
    v_mfma_f32_16x16x32_bf16 v[76:79], a[0:3], a[56:59], v[76:79]
    ds_read_b128 a[60:63], v14 offset:64
    v_mfma_f32_16x16x32_bf16 v[160:163], a[4:7], a[48:51], v[160:163]
    ds_read_b64_tr_b16 a[16:17], v15 offset:17072
    v_mfma_f32_16x16x32_bf16 v[120:123], a[4:7], a[52:55], v[120:123]
    s_waitcnt lgkmcnt(4)
    v_mfma_f32_16x16x32_bf16 v[80:83], a[4:7], a[56:59], v[80:83]
    ds_read_b64_tr_b16 a[18:19], v15 offset:17552
    v_mfma_f32_16x16x32_bf16 v[164:167], a[8:11], a[48:51], v[164:167]
    ds_read_b64_tr_b16 a[20:21], v15 offset:17080
    v_mfma_f32_16x16x32_bf16 v[124:127], a[8:11], a[52:55], v[124:127]
    ds_read_b64_tr_b16 a[22:23], v15 offset:17560
    s_waitcnt lgkmcnt(5)
    v_mfma_f32_16x16x32_bf16 v[84:87], a[8:11], a[56:59], v[84:87]
    buffer_load_dwordx4 v4, s[12:15], s54 offen offset:2112  lds
    v_mfma_f32_16x16x32_bf16 v[168:171], a[12:15], a[48:51], v[168:171]
    ds_read_b64_tr_b16 a[0:1], v15 offset:17088
    v_mfma_f32_16x16x32_bf16 v[128:131], a[12:15], a[52:55], v[128:131]
    s_waitcnt lgkmcnt(3)
    v_mfma_f32_16x16x32_bf16 v[88:91], a[12:15], a[56:59], v[88:91]
    ds_read_b64_tr_b16 a[2:3], v15 offset:17568
    v_mfma_f32_16x16x32_bf16 v[172:175], a[16:19], a[48:51], v[172:175]
    ds_read_b64_tr_b16 a[4:5], v17 offset:17216
    v_mfma_f32_16x16x32_bf16 v[132:135], a[16:19], a[52:55], v[132:135]
    ds_read_b64_tr_b16 a[6:7], v17 offset:17696
    s_waitcnt lgkmcnt(4)
    v_mfma_f32_16x16x32_bf16 v[92:95], a[16:19], a[56:59], v[92:95]
    ds_read_b64_tr_b16 a[8:9], v17 offset:17256
    v_mfma_f32_16x16x32_bf16 v[176:179], a[20:23], a[48:51], v[176:179]
    v_mfma_f32_16x16x32_bf16 v[136:139], a[20:23], a[52:55], v[136:139]
    ds_read_b64_tr_b16 a[10:11], v17 offset:17736
    s_waitcnt lgkmcnt(4)
    v_mfma_f32_16x16x32_bf16 v[96:99], a[20:23], a[56:59], v[96:99]
    ds_read_b64_tr_b16 a[12:13], v17 offset:17296
    v_mfma_f32_16x16x32_bf16 v[180:183], a[0:3], a[48:51], v[180:183]
    ds_read_b64_tr_b16 a[14:15], v17 offset:17776
    v_mfma_f32_16x16x32_bf16 v[140:143], a[0:3], a[52:55], v[140:143]
    ds_read_b64_tr_b16 a[16:17], v17 offset:17336
    s_waitcnt lgkmcnt(5)
    v_mfma_f32_16x16x32_bf16 v[100:103], a[0:3], a[56:59], v[100:103]
    buffer_load_dwordx4 v5, s[12:15], s54 offen offset:3168  lds
    v_mfma_f32_16x16x32_bf16 v[184:187], a[48:51], a[4:7], v[184:187]
    v_mfma_f32_16x16x32_bf16 v[188:191], a[52:55], a[4:7], v[188:191]
    ds_read_b64_tr_b16 a[18:19], v17 offset:17816
    s_waitcnt lgkmcnt(4)
    v_mfma_f32_16x16x32_bf16 v[192:195], a[56:59], a[4:7], v[192:195]
    ds_read_b64_tr_b16 a[20:21], v15 offset:17248
    v_mfma_f32_16x16x32_bf16 v[196:199], a[48:51], a[8:11], v[196:199]
    ds_read_b64_tr_b16 a[22:23], v15 offset:17728
    v_mfma_f32_16x16x32_bf16 v[200:203], a[52:55], a[8:11], v[200:203]
    s_waitcnt lgkmcnt(4)
    v_mfma_f32_16x16x32_bf16 v[204:207], a[56:59], a[8:11], v[204:207]
    s_waitcnt vmcnt(17)
    s_barrier
    v_mfma_f32_16x16x32_bf16 v[208:211], a[48:51], a[12:15], v[208:211]
    ds_read_b128 a[32:35], v12 offset:24576
    s_add_u32 m0, s52, 0
    v_mfma_f32_16x16x32_bf16 v[212:215], a[52:55], a[12:15], v[212:215]
    ds_read_b64_tr_b16 a[0:1], v15 offset:33792
    s_add_u32 s54, s54, 122880
    v_mfma_f32_16x16x32_bf16 v[216:219], a[56:59], a[12:15], v[216:219]
    ds_read_b128 a[36:39], v12 offset:26624
    s_waitcnt lgkmcnt(5)
    v_mfma_f32_16x16x32_bf16 v[244:247], a[60:63], a[48:51], v[244:247]
    buffer_load_dwordx4 v2, s[12:15], s54 offen offset:0  lds
    v_mfma_f32_16x16x32_bf16 v[220:223], a[48:51], a[16:19], v[220:223]
    ds_read_b64_tr_b16 a[2:3], v15 offset:34272
    v_mfma_f32_16x16x32_bf16 v[224:227], a[52:55], a[16:19], v[224:227]
    ds_read_b128 a[40:43], v12 offset:28672
    v_mfma_f32_16x16x32_bf16 v[228:231], a[56:59], a[16:19], v[228:231]
    ds_read_b64_tr_b16 a[4:5], v15 offset:33800
    s_waitcnt lgkmcnt(6)
    v_mfma_f32_16x16x32_bf16 v[248:251], a[60:63], a[52:55], v[248:251]
    ds_read_b64_tr_b16 a[6:7], v15 offset:34280
    v_mfma_f32_16x16x32_bf16 v[232:235], a[48:51], a[20:23], v[232:235]
    v_mfma_f32_16x16x32_bf16 v[236:239], a[52:55], a[20:23], v[236:239]
    buffer_load_dwordx4 v3, s[12:15], s54 offen offset:1056  lds
    v_mfma_f32_16x16x32_bf16 v[240:243], a[56:59], a[20:23], v[240:243]
    ds_read_b64_tr_b16 a[8:9], v15 offset:33808
    s_waitcnt lgkmcnt(3)
    v_mfma_f32_16x16x32_bf16 v[252:255], a[60:63], a[56:59], v[252:255]
    ds_read_b64_tr_b16 a[10:11], v15 offset:34288
    v_mfma_f32_16x16x32_bf16 v[144:147], a[0:3], a[32:35], v[144:147]
    ds_read_b64_tr_b16 a[12:13], v15 offset:33816
    v_mfma_f32_16x16x32_bf16 v[104:107], a[0:3], a[36:39], v[104:107]
    ds_read_b64_tr_b16 a[14:15], v15 offset:34296
    s_waitcnt lgkmcnt(4)
    v_mfma_f32_16x16x32_bf16 v[64:67], a[0:3], a[40:43], v[64:67]
    buffer_load_dwordx4 v4, s[12:15], s54 offen offset:2112  lds
    v_mfma_f32_16x16x32_bf16 v[148:151], a[4:7], a[32:35], v[148:151]
    ds_read_b64_tr_b16 a[16:17], v15 offset:33824
    v_mfma_f32_16x16x32_bf16 v[108:111], a[4:7], a[36:39], v[108:111]
    ds_read_b64_tr_b16 a[18:19], v15 offset:34304
    s_waitcnt lgkmcnt(4)
    v_mfma_f32_16x16x32_bf16 v[68:71], a[4:7], a[40:43], v[68:71]
    ds_read_b64_tr_b16 a[20:21], v15 offset:33952
    v_mfma_f32_16x16x32_bf16 v[152:155], a[8:11], a[32:35], v[152:155]
    v_mfma_f32_16x16x32_bf16 v[112:115], a[8:11], a[36:39], v[112:115]
    ds_read_b64_tr_b16 a[22:23], v15 offset:34432
    s_waitcnt lgkmcnt(4)
    v_mfma_f32_16x16x32_bf16 v[72:75], a[8:11], a[40:43], v[72:75]
    buffer_load_dwordx4 v5, s[12:15], s54 offen offset:3168  lds
    v_mfma_f32_16x16x32_bf16 v[156:159], a[12:15], a[32:35], v[156:159]
    ds_read_b64_tr_b16 a[0:1], v15 offset:33960
    s_add_u32 m0, s53, 0
    v_mfma_f32_16x16x32_bf16 v[116:119], a[12:15], a[36:39], v[116:119]
    ds_read_b64_tr_b16 a[2:3], v15 offset:34440
    s_add_u32 s55, s55, 128
    v_mfma_f32_16x16x32_bf16 v[76:79], a[12:15], a[40:43], v[76:79]
    ds_read_b128 a[44:47], v14 offset:128
    s_waitcnt lgkmcnt(5)
    v_mfma_f32_16x16x32_bf16 v[160:163], a[16:19], a[32:35], v[160:163]
    ds_read_b64_tr_b16 a[4:5], v15 offset:33968
    v_mfma_f32_16x16x32_bf16 v[120:123], a[16:19], a[36:39], v[120:123]
    ds_read_b64_tr_b16 a[6:7], v15 offset:34448
    s_waitcnt lgkmcnt(5)
    v_mfma_f32_16x16x32_bf16 v[80:83], a[16:19], a[40:43], v[80:83]
    buffer_load_dwordx4 v6, s[8:11], s55 offen offset:0  lds
    v_mfma_f32_16x16x32_bf16 v[164:167], a[20:23], a[32:35], v[164:167]
    ds_read_b64_tr_b16 a[8:9], v15 offset:33976
    v_mfma_f32_16x16x32_bf16 v[124:127], a[20:23], a[36:39], v[124:127]
    s_waitcnt lgkmcnt(4)
    v_mfma_f32_16x16x32_bf16 v[84:87], a[20:23], a[40:43], v[84:87]
    ds_read_b64_tr_b16 a[10:11], v15 offset:34456
    v_mfma_f32_16x16x32_bf16 v[168:171], a[0:3], a[32:35], v[168:171]
    ds_read_b64_tr_b16 a[12:13], v15 offset:33984
    v_mfma_f32_16x16x32_bf16 v[128:131], a[0:3], a[36:39], v[128:131]
    ds_read_b64_tr_b16 a[14:15], v15 offset:34464
    s_waitcnt lgkmcnt(4)
    v_mfma_f32_16x16x32_bf16 v[88:91], a[0:3], a[40:43], v[88:91]
    buffer_load_dwordx4 v7, s[8:11], s55 offen offset:1024  lds
    v_mfma_f32_16x16x32_bf16 v[172:175], a[4:7], a[32:35], v[172:175]
    ds_read_b64_tr_b16 a[16:17], v17 offset:34112
    v_mfma_f32_16x16x32_bf16 v[132:135], a[4:7], a[36:39], v[132:135]
    ds_read_b64_tr_b16 a[18:19], v17 offset:34592
    s_waitcnt lgkmcnt(4)
    v_mfma_f32_16x16x32_bf16 v[92:95], a[4:7], a[40:43], v[92:95]
    ds_read_b64_tr_b16 a[20:21], v17 offset:34152
    v_mfma_f32_16x16x32_bf16 v[176:179], a[8:11], a[32:35], v[176:179]
    ds_read_b64_tr_b16 a[22:23], v17 offset:34632
    v_mfma_f32_16x16x32_bf16 v[136:139], a[8:11], a[36:39], v[136:139]
    s_waitcnt lgkmcnt(4)
    v_mfma_f32_16x16x32_bf16 v[96:99], a[8:11], a[40:43], v[96:99]
    buffer_load_dwordx4 v8, s[8:11], s55 offen offset:2048  lds
    v_mfma_f32_16x16x32_bf16 v[180:183], a[12:15], a[32:35], v[180:183]
    ds_read_b64_tr_b16 a[0:1], v17 offset:34192
    v_mfma_f32_16x16x32_bf16 v[140:143], a[12:15], a[36:39], v[140:143]
    ds_read_b64_tr_b16 a[2:3], v17 offset:34672
    s_waitcnt lgkmcnt(4)
    v_mfma_f32_16x16x32_bf16 v[100:103], a[12:15], a[40:43], v[100:103]
    ds_read_b64_tr_b16 a[4:5], v17 offset:34232
    v_mfma_f32_16x16x32_bf16 v[184:187], a[32:35], a[16:19], v[184:187]
    ds_read_b64_tr_b16 a[6:7], v17 offset:34712
    v_mfma_f32_16x16x32_bf16 v[188:191], a[36:39], a[16:19], v[188:191]
    ds_read_b64_tr_b16 a[8:9], v15 offset:34144
    s_waitcnt lgkmcnt(5)
    v_mfma_f32_16x16x32_bf16 v[192:195], a[40:43], a[16:19], v[192:195]
    buffer_load_dwordx4 v9, s[8:11], s55 offen offset:3072  lds
    v_mfma_f32_16x16x32_bf16 v[196:199], a[32:35], a[20:23], v[196:199]
    ds_read_b64_tr_b16 a[10:11], v15 offset:34624
    v_mfma_f32_16x16x32_bf16 v[200:203], a[36:39], a[20:23], v[200:203]
    s_waitcnt lgkmcnt(4)
    v_mfma_f32_16x16x32_bf16 v[204:207], a[40:43], a[20:23], v[204:207]
    s_waitcnt vmcnt(21)
    s_barrier
    v_mfma_f32_16x16x32_bf16 v[208:211], a[32:35], a[0:3], v[208:211]
    ds_read_b128 a[48:51], v13 offset:24576
    s_add_u32 m0, s53, 4096
    v_mfma_f32_16x16x32_bf16 v[212:215], a[36:39], a[0:3], v[212:215]
    ds_read_b64_tr_b16 a[12:13], v16 offset:0
    v_mfma_f32_16x16x32_bf16 v[216:219], a[40:43], a[0:3], v[216:219]
    ds_read_b128 a[52:55], v13 offset:26624
    s_waitcnt lgkmcnt(5)
    v_mfma_f32_16x16x32_bf16 v[244:247], a[44:47], a[32:35], v[244:247]
    ds_read_b64_tr_b16 a[14:15], v16 offset:480
    v_mfma_f32_16x16x32_bf16 v[220:223], a[32:35], a[4:7], v[220:223]
    buffer_load_dwordx4 v10, s[8:11], s55 offen offset:0  lds
    v_mfma_f32_16x16x32_bf16 v[224:227], a[36:39], a[4:7], v[224:227]
    ds_read_b128 a[56:59], v13 offset:28672
    v_mfma_f32_16x16x32_bf16 v[228:231], a[40:43], a[4:7], v[228:231]
    s_waitcnt lgkmcnt(5)
    v_mfma_f32_16x16x32_bf16 v[248:251], a[44:47], a[36:39], v[248:251]
    ds_read_b64_tr_b16 a[16:17], v16 offset:8
    v_mfma_f32_16x16x32_bf16 v[232:235], a[32:35], a[8:11], v[232:235]
    ds_read_b64_tr_b16 a[18:19], v16 offset:488
    v_mfma_f32_16x16x32_bf16 v[236:239], a[36:39], a[8:11], v[236:239]
    ds_read_b64_tr_b16 a[20:21], v16 offset:16
    v_mfma_f32_16x16x32_bf16 v[240:243], a[40:43], a[8:11], v[240:243]
    ds_read_b64_tr_b16 a[22:23], v16 offset:496
    s_waitcnt lgkmcnt(4)
    v_mfma_f32_16x16x32_bf16 v[252:255], a[44:47], a[40:43], v[252:255]
    ds_read_b64_tr_b16 a[0:1], v16 offset:24
    v_mfma_f32_16x16x32_bf16 v[144:147], a[12:15], a[48:51], v[144:147]
    buffer_load_dwordx4 v11, s[8:11], s55 offen offset:1024  lds
    v_mfma_f32_16x16x32_bf16 v[104:107], a[12:15], a[52:55], v[104:107]
    s_add_u32 m0, s52, 16896
    s_add_u32 s54, s54, 122880
    s_waitcnt lgkmcnt(3)
    v_mfma_f32_16x16x32_bf16 v[64:67], a[12:15], a[56:59], v[64:67]
    ds_read_b64_tr_b16 a[2:3], v16 offset:504
    v_mfma_f32_16x16x32_bf16 v[148:151], a[16:19], a[48:51], v[148:151]
    ds_read_b64_tr_b16 a[4:5], v16 offset:32
    v_mfma_f32_16x16x32_bf16 v[108:111], a[16:19], a[52:55], v[108:111]
    ds_read_b64_tr_b16 a[6:7], v16 offset:512
    s_waitcnt lgkmcnt(4)
    v_mfma_f32_16x16x32_bf16 v[68:71], a[16:19], a[56:59], v[68:71]
    ds_read_b64_tr_b16 a[8:9], v16 offset:160
    v_mfma_f32_16x16x32_bf16 v[152:155], a[20:23], a[48:51], v[152:155]
    ds_read_b64_tr_b16 a[10:11], v16 offset:640
    v_mfma_f32_16x16x32_bf16 v[112:115], a[20:23], a[52:55], v[112:115]
    buffer_load_dwordx4 v2, s[12:15], s54 offen offset:0  lds
    v_mfma_f32_16x16x32_bf16 v[72:75], a[20:23], a[56:59], v[72:75]
    s_waitcnt lgkmcnt(4)
    v_mfma_f32_16x16x32_bf16 v[156:159], a[0:3], a[48:51], v[156:159]
    ds_read_b64_tr_b16 a[12:13], v16 offset:168
    v_mfma_f32_16x16x32_bf16 v[116:119], a[0:3], a[52:55], v[116:119]
    ds_read_b64_tr_b16 a[14:15], v16 offset:648
    s_waitcnt lgkmcnt(4)
    v_mfma_f32_16x16x32_bf16 v[76:79], a[0:3], a[56:59], v[76:79]
    ds_read_b128 a[60:63], v14 offset:192
    v_mfma_f32_16x16x32_bf16 v[160:163], a[4:7], a[48:51], v[160:163]
    ds_read_b64_tr_b16 a[16:17], v16 offset:176
    v_mfma_f32_16x16x32_bf16 v[120:123], a[4:7], a[52:55], v[120:123]
    ds_read_b64_tr_b16 a[18:19], v16 offset:656
    s_waitcnt lgkmcnt(5)
    v_mfma_f32_16x16x32_bf16 v[80:83], a[4:7], a[56:59], v[80:83]
    v_mfma_f32_16x16x32_bf16 v[164:167], a[8:11], a[48:51], v[164:167]
    buffer_load_dwordx4 v3, s[12:15], s54 offen offset:1056  lds
    v_mfma_f32_16x16x32_bf16 v[124:127], a[8:11], a[52:55], v[124:127]
    ds_read_b64_tr_b16 a[20:21], v16 offset:184
    s_waitcnt lgkmcnt(4)
    v_mfma_f32_16x16x32_bf16 v[84:87], a[8:11], a[56:59], v[84:87]
    ds_read_b64_tr_b16 a[22:23], v16 offset:664
    v_mfma_f32_16x16x32_bf16 v[168:171], a[12:15], a[48:51], v[168:171]
    ds_read_b64_tr_b16 a[0:1], v16 offset:192
    v_mfma_f32_16x16x32_bf16 v[128:131], a[12:15], a[52:55], v[128:131]
    ds_read_b64_tr_b16 a[2:3], v16 offset:672
    s_waitcnt lgkmcnt(4)
    v_mfma_f32_16x16x32_bf16 v[88:91], a[12:15], a[56:59], v[88:91]
    ds_read_b64_tr_b16 a[4:5], v18 offset:320
    v_mfma_f32_16x16x32_bf16 v[172:175], a[16:19], a[48:51], v[172:175]
    v_mfma_f32_16x16x32_bf16 v[132:135], a[16:19], a[52:55], v[132:135]
    ds_read_b64_tr_b16 a[6:7], v18 offset:800
    s_waitcnt lgkmcnt(4)
    v_mfma_f32_16x16x32_bf16 v[92:95], a[16:19], a[56:59], v[92:95]
    buffer_load_dwordx4 v4, s[12:15], s54 offen offset:2112  lds
    v_mfma_f32_16x16x32_bf16 v[176:179], a[20:23], a[48:51], v[176:179]
    ds_read_b64_tr_b16 a[8:9], v18 offset:360
    v_mfma_f32_16x16x32_bf16 v[136:139], a[20:23], a[52:55], v[136:139]
    ds_read_b64_tr_b16 a[10:11], v18 offset:840
    s_waitcnt lgkmcnt(4)
    v_mfma_f32_16x16x32_bf16 v[96:99], a[20:23], a[56:59], v[96:99]
    ds_read_b64_tr_b16 a[12:13], v18 offset:400
    v_mfma_f32_16x16x32_bf16 v[180:183], a[0:3], a[48:51], v[180:183]
    ds_read_b64_tr_b16 a[14:15], v18 offset:880
    v_mfma_f32_16x16x32_bf16 v[140:143], a[0:3], a[52:55], v[140:143]
    s_waitcnt lgkmcnt(4)
    v_mfma_f32_16x16x32_bf16 v[100:103], a[0:3], a[56:59], v[100:103]
    ds_read_b64_tr_b16 a[16:17], v18 offset:440
    v_mfma_f32_16x16x32_bf16 v[184:187], a[48:51], a[4:7], v[184:187]
    ds_read_b64_tr_b16 a[18:19], v18 offset:920
    v_mfma_f32_16x16x32_bf16 v[188:191], a[52:55], a[4:7], v[188:191]
    buffer_load_dwordx4 v5, s[12:15], s54 offen offset:3168  lds
    v_mfma_f32_16x16x32_bf16 v[192:195], a[56:59], a[4:7], v[192:195]
    ds_read_b64_tr_b16 a[20:21], v16 offset:352
    s_waitcnt lgkmcnt(5)
    v_mfma_f32_16x16x32_bf16 v[196:199], a[48:51], a[8:11], v[196:199]
    ds_read_b64_tr_b16 a[22:23], v16 offset:832
    v_mfma_f32_16x16x32_bf16 v[200:203], a[52:55], a[8:11], v[200:203]
    s_waitcnt lgkmcnt(4)
    v_mfma_f32_16x16x32_bf16 v[204:207], a[56:59], a[8:11], v[204:207]
    s_waitcnt vmcnt(14)
    s_barrier
    v_mfma_f32_16x16x32_bf16 v[208:211], a[48:51], a[12:15], v[208:211]
    ds_read_b128 a[32:35], v12 offset:49152
    s_add_u32 m0, s52, 33792
    v_mfma_f32_16x16x32_bf16 v[212:215], a[52:55], a[12:15], v[212:215]
    ds_read_b64_tr_b16 a[0:1], v16 offset:16896
    s_add_u32 s54, s54, 122880
    v_mfma_f32_16x16x32_bf16 v[216:219], a[56:59], a[12:15], v[216:219]
    ds_read_b128 a[36:39], v12 offset:51200
    s_waitcnt lgkmcnt(5)
    v_mfma_f32_16x16x32_bf16 v[244:247], a[60:63], a[48:51], v[244:247]
    buffer_load_dwordx4 v2, s[12:15], s54 offen offset:0  lds
    v_mfma_f32_16x16x32_bf16 v[220:223], a[48:51], a[16:19], v[220:223]
    ds_read_b64_tr_b16 a[2:3], v16 offset:17376
    v_mfma_f32_16x16x32_bf16 v[224:227], a[52:55], a[16:19], v[224:227]
    ds_read_b128 a[40:43], v12 offset:53248
    v_mfma_f32_16x16x32_bf16 v[228:231], a[56:59], a[16:19], v[228:231]
    ds_read_b64_tr_b16 a[4:5], v16 offset:16904
    s_waitcnt lgkmcnt(6)
    v_mfma_f32_16x16x32_bf16 v[248:251], a[60:63], a[52:55], v[248:251]
    ds_read_b64_tr_b16 a[6:7], v16 offset:17384
    v_mfma_f32_16x16x32_bf16 v[232:235], a[48:51], a[20:23], v[232:235]
    v_mfma_f32_16x16x32_bf16 v[236:239], a[52:55], a[20:23], v[236:239]
    buffer_load_dwordx4 v3, s[12:15], s54 offen offset:1056  lds
    v_mfma_f32_16x16x32_bf16 v[240:243], a[56:59], a[20:23], v[240:243]
    ds_read_b64_tr_b16 a[8:9], v16 offset:16912
    s_waitcnt lgkmcnt(3)
    v_mfma_f32_16x16x32_bf16 v[252:255], a[60:63], a[56:59], v[252:255]
    ds_read_b64_tr_b16 a[10:11], v16 offset:17392
    v_mfma_f32_16x16x32_bf16 v[144:147], a[0:3], a[32:35], v[144:147]
    ds_read_b64_tr_b16 a[12:13], v16 offset:16920
    v_mfma_f32_16x16x32_bf16 v[104:107], a[0:3], a[36:39], v[104:107]
    ds_read_b64_tr_b16 a[14:15], v16 offset:17400
    s_waitcnt lgkmcnt(4)
    v_mfma_f32_16x16x32_bf16 v[64:67], a[0:3], a[40:43], v[64:67]
    buffer_load_dwordx4 v4, s[12:15], s54 offen offset:2112  lds
    v_mfma_f32_16x16x32_bf16 v[148:151], a[4:7], a[32:35], v[148:151]
    ds_read_b64_tr_b16 a[16:17], v16 offset:16928
    v_mfma_f32_16x16x32_bf16 v[108:111], a[4:7], a[36:39], v[108:111]
    ds_read_b64_tr_b16 a[18:19], v16 offset:17408
    s_waitcnt lgkmcnt(4)
    v_mfma_f32_16x16x32_bf16 v[68:71], a[4:7], a[40:43], v[68:71]
    ds_read_b64_tr_b16 a[20:21], v16 offset:17056
    v_mfma_f32_16x16x32_bf16 v[152:155], a[8:11], a[32:35], v[152:155]
    v_mfma_f32_16x16x32_bf16 v[112:115], a[8:11], a[36:39], v[112:115]
    ds_read_b64_tr_b16 a[22:23], v16 offset:17536
    s_waitcnt lgkmcnt(4)
    v_mfma_f32_16x16x32_bf16 v[72:75], a[8:11], a[40:43], v[72:75]
    buffer_load_dwordx4 v5, s[12:15], s54 offen offset:3168  lds
    v_mfma_f32_16x16x32_bf16 v[156:159], a[12:15], a[32:35], v[156:159]
    ds_read_b64_tr_b16 a[0:1], v16 offset:17064
    s_add_u32 m0, s53, 24576
    v_mfma_f32_16x16x32_bf16 v[116:119], a[12:15], a[36:39], v[116:119]
    ds_read_b64_tr_b16 a[2:3], v16 offset:17544
    s_add_u32 s55, s55, 128
    v_mfma_f32_16x16x32_bf16 v[76:79], a[12:15], a[40:43], v[76:79]
    ds_read_b128 a[44:47], v14 offset:256
    s_waitcnt lgkmcnt(5)
    v_mfma_f32_16x16x32_bf16 v[160:163], a[16:19], a[32:35], v[160:163]
    ds_read_b64_tr_b16 a[4:5], v16 offset:17072
    v_mfma_f32_16x16x32_bf16 v[120:123], a[16:19], a[36:39], v[120:123]
    ds_read_b64_tr_b16 a[6:7], v16 offset:17552
    s_waitcnt lgkmcnt(5)
    v_mfma_f32_16x16x32_bf16 v[80:83], a[16:19], a[40:43], v[80:83]
    buffer_load_dwordx4 v6, s[8:11], s55 offen offset:0  lds
    v_mfma_f32_16x16x32_bf16 v[164:167], a[20:23], a[32:35], v[164:167]
    ds_read_b64_tr_b16 a[8:9], v16 offset:17080
    v_mfma_f32_16x16x32_bf16 v[124:127], a[20:23], a[36:39], v[124:127]
    s_waitcnt lgkmcnt(4)
    v_mfma_f32_16x16x32_bf16 v[84:87], a[20:23], a[40:43], v[84:87]
    ds_read_b64_tr_b16 a[10:11], v16 offset:17560
    v_mfma_f32_16x16x32_bf16 v[168:171], a[0:3], a[32:35], v[168:171]
    ds_read_b64_tr_b16 a[12:13], v16 offset:17088
    v_mfma_f32_16x16x32_bf16 v[128:131], a[0:3], a[36:39], v[128:131]
    ds_read_b64_tr_b16 a[14:15], v16 offset:17568
    s_waitcnt lgkmcnt(4)
    v_mfma_f32_16x16x32_bf16 v[88:91], a[0:3], a[40:43], v[88:91]
    buffer_load_dwordx4 v7, s[8:11], s55 offen offset:1024  lds
    v_mfma_f32_16x16x32_bf16 v[172:175], a[4:7], a[32:35], v[172:175]
    ds_read_b64_tr_b16 a[16:17], v18 offset:17216
    v_mfma_f32_16x16x32_bf16 v[132:135], a[4:7], a[36:39], v[132:135]
    ds_read_b64_tr_b16 a[18:19], v18 offset:17696
    s_waitcnt lgkmcnt(4)
    v_mfma_f32_16x16x32_bf16 v[92:95], a[4:7], a[40:43], v[92:95]
    ds_read_b64_tr_b16 a[20:21], v18 offset:17256
    v_mfma_f32_16x16x32_bf16 v[176:179], a[8:11], a[32:35], v[176:179]
    ds_read_b64_tr_b16 a[22:23], v18 offset:17736
    v_mfma_f32_16x16x32_bf16 v[136:139], a[8:11], a[36:39], v[136:139]
    s_waitcnt lgkmcnt(4)
    v_mfma_f32_16x16x32_bf16 v[96:99], a[8:11], a[40:43], v[96:99]
    buffer_load_dwordx4 v8, s[8:11], s55 offen offset:2048  lds
    v_mfma_f32_16x16x32_bf16 v[180:183], a[12:15], a[32:35], v[180:183]
    ds_read_b64_tr_b16 a[0:1], v18 offset:17296
    v_mfma_f32_16x16x32_bf16 v[140:143], a[12:15], a[36:39], v[140:143]
    ds_read_b64_tr_b16 a[2:3], v18 offset:17776
    s_waitcnt lgkmcnt(4)
    v_mfma_f32_16x16x32_bf16 v[100:103], a[12:15], a[40:43], v[100:103]
    ds_read_b64_tr_b16 a[4:5], v18 offset:17336
    v_mfma_f32_16x16x32_bf16 v[184:187], a[32:35], a[16:19], v[184:187]
    ds_read_b64_tr_b16 a[6:7], v18 offset:17816
    v_mfma_f32_16x16x32_bf16 v[188:191], a[36:39], a[16:19], v[188:191]
    ds_read_b64_tr_b16 a[8:9], v16 offset:17248
    s_waitcnt lgkmcnt(5)
    v_mfma_f32_16x16x32_bf16 v[192:195], a[40:43], a[16:19], v[192:195]
    buffer_load_dwordx4 v9, s[8:11], s55 offen offset:3072  lds
    v_mfma_f32_16x16x32_bf16 v[196:199], a[32:35], a[20:23], v[196:199]
    ds_read_b64_tr_b16 a[10:11], v16 offset:17728
    v_mfma_f32_16x16x32_bf16 v[200:203], a[36:39], a[20:23], v[200:203]
    s_waitcnt lgkmcnt(4)
    v_mfma_f32_16x16x32_bf16 v[204:207], a[40:43], a[20:23], v[204:207]
    s_waitcnt vmcnt(18)
    s_barrier
    v_mfma_f32_16x16x32_bf16 v[208:211], a[32:35], a[0:3], v[208:211]
    ds_read_b128 a[48:51], v13 offset:49152
    s_add_u32 m0, s53, 28672
    v_mfma_f32_16x16x32_bf16 v[212:215], a[36:39], a[0:3], v[212:215]
    ds_read_b64_tr_b16 a[12:13], v15 offset:0
    v_mfma_f32_16x16x32_bf16 v[216:219], a[40:43], a[0:3], v[216:219]
    ds_read_b128 a[52:55], v13 offset:51200
    s_waitcnt lgkmcnt(5)
    v_mfma_f32_16x16x32_bf16 v[244:247], a[44:47], a[32:35], v[244:247]
    ds_read_b64_tr_b16 a[14:15], v15 offset:480
    v_mfma_f32_16x16x32_bf16 v[220:223], a[32:35], a[4:7], v[220:223]
    buffer_load_dwordx4 v10, s[8:11], s55 offen offset:0  lds
    v_mfma_f32_16x16x32_bf16 v[224:227], a[36:39], a[4:7], v[224:227]
    ds_read_b128 a[56:59], v13 offset:53248
    v_mfma_f32_16x16x32_bf16 v[228:231], a[40:43], a[4:7], v[228:231]
    s_waitcnt lgkmcnt(5)
    v_mfma_f32_16x16x32_bf16 v[248:251], a[44:47], a[36:39], v[248:251]
    ds_read_b64_tr_b16 a[16:17], v15 offset:8
    v_mfma_f32_16x16x32_bf16 v[232:235], a[32:35], a[8:11], v[232:235]
    ds_read_b64_tr_b16 a[18:19], v15 offset:488
    v_mfma_f32_16x16x32_bf16 v[236:239], a[36:39], a[8:11], v[236:239]
    ds_read_b64_tr_b16 a[20:21], v15 offset:16
    v_mfma_f32_16x16x32_bf16 v[240:243], a[40:43], a[8:11], v[240:243]
    ds_read_b64_tr_b16 a[22:23], v15 offset:496
    s_waitcnt lgkmcnt(4)
    v_mfma_f32_16x16x32_bf16 v[252:255], a[44:47], a[40:43], v[252:255]
    ds_read_b64_tr_b16 a[0:1], v15 offset:24
    v_mfma_f32_16x16x32_bf16 v[144:147], a[12:15], a[48:51], v[144:147]
    buffer_load_dwordx4 v11, s[8:11], s55 offen offset:1024  lds
    v_mfma_f32_16x16x32_bf16 v[104:107], a[12:15], a[52:55], v[104:107]
    s_add_u32 m0, s52, 50688
    s_add_u32 s54, s54, 122880
    s_waitcnt lgkmcnt(3)
    v_mfma_f32_16x16x32_bf16 v[64:67], a[12:15], a[56:59], v[64:67]
    ds_read_b64_tr_b16 a[2:3], v15 offset:504
    v_mfma_f32_16x16x32_bf16 v[148:151], a[16:19], a[48:51], v[148:151]
    ds_read_b64_tr_b16 a[4:5], v15 offset:32
    v_mfma_f32_16x16x32_bf16 v[108:111], a[16:19], a[52:55], v[108:111]
    ds_read_b64_tr_b16 a[6:7], v15 offset:512
    s_waitcnt lgkmcnt(4)
    v_mfma_f32_16x16x32_bf16 v[68:71], a[16:19], a[56:59], v[68:71]
    ds_read_b64_tr_b16 a[8:9], v15 offset:160
    v_mfma_f32_16x16x32_bf16 v[152:155], a[20:23], a[48:51], v[152:155]
    ds_read_b64_tr_b16 a[10:11], v15 offset:640
    v_mfma_f32_16x16x32_bf16 v[112:115], a[20:23], a[52:55], v[112:115]
    buffer_load_dwordx4 v2, s[12:15], s54 offen offset:0  lds
    v_mfma_f32_16x16x32_bf16 v[72:75], a[20:23], a[56:59], v[72:75]
    s_waitcnt lgkmcnt(4)
    v_mfma_f32_16x16x32_bf16 v[156:159], a[0:3], a[48:51], v[156:159]
    ds_read_b64_tr_b16 a[12:13], v15 offset:168
    v_mfma_f32_16x16x32_bf16 v[116:119], a[0:3], a[52:55], v[116:119]
    ds_read_b64_tr_b16 a[14:15], v15 offset:648
    s_waitcnt lgkmcnt(4)
    v_mfma_f32_16x16x32_bf16 v[76:79], a[0:3], a[56:59], v[76:79]
    ds_read_b128 a[60:63], v14 offset:320
    v_mfma_f32_16x16x32_bf16 v[160:163], a[4:7], a[48:51], v[160:163]
    ds_read_b64_tr_b16 a[16:17], v15 offset:176
    v_mfma_f32_16x16x32_bf16 v[120:123], a[4:7], a[52:55], v[120:123]
    ds_read_b64_tr_b16 a[18:19], v15 offset:656
    s_waitcnt lgkmcnt(5)
    v_mfma_f32_16x16x32_bf16 v[80:83], a[4:7], a[56:59], v[80:83]
    v_mfma_f32_16x16x32_bf16 v[164:167], a[8:11], a[48:51], v[164:167]
    buffer_load_dwordx4 v3, s[12:15], s54 offen offset:1056  lds
    v_mfma_f32_16x16x32_bf16 v[124:127], a[8:11], a[52:55], v[124:127]
    ds_read_b64_tr_b16 a[20:21], v15 offset:184
    s_waitcnt lgkmcnt(4)
    v_mfma_f32_16x16x32_bf16 v[84:87], a[8:11], a[56:59], v[84:87]
    ds_read_b64_tr_b16 a[22:23], v15 offset:664
    v_mfma_f32_16x16x32_bf16 v[168:171], a[12:15], a[48:51], v[168:171]
    ds_read_b64_tr_b16 a[0:1], v15 offset:192
    v_mfma_f32_16x16x32_bf16 v[128:131], a[12:15], a[52:55], v[128:131]
    ds_read_b64_tr_b16 a[2:3], v15 offset:672
    s_waitcnt lgkmcnt(4)
    v_mfma_f32_16x16x32_bf16 v[88:91], a[12:15], a[56:59], v[88:91]
    ds_read_b64_tr_b16 a[4:5], v17 offset:320
    v_mfma_f32_16x16x32_bf16 v[172:175], a[16:19], a[48:51], v[172:175]
    v_mfma_f32_16x16x32_bf16 v[132:135], a[16:19], a[52:55], v[132:135]
    ds_read_b64_tr_b16 a[6:7], v17 offset:800
    s_waitcnt lgkmcnt(4)
    v_mfma_f32_16x16x32_bf16 v[92:95], a[16:19], a[56:59], v[92:95]
    buffer_load_dwordx4 v4, s[12:15], s54 offen offset:2112  lds
    v_mfma_f32_16x16x32_bf16 v[176:179], a[20:23], a[48:51], v[176:179]
    ds_read_b64_tr_b16 a[8:9], v17 offset:360
    v_mfma_f32_16x16x32_bf16 v[136:139], a[20:23], a[52:55], v[136:139]
    ds_read_b64_tr_b16 a[10:11], v17 offset:840
    s_waitcnt lgkmcnt(4)
    v_mfma_f32_16x16x32_bf16 v[96:99], a[20:23], a[56:59], v[96:99]
    ds_read_b64_tr_b16 a[12:13], v17 offset:400
    v_mfma_f32_16x16x32_bf16 v[180:183], a[0:3], a[48:51], v[180:183]
    ds_read_b64_tr_b16 a[14:15], v17 offset:880
    v_mfma_f32_16x16x32_bf16 v[140:143], a[0:3], a[52:55], v[140:143]
    s_waitcnt lgkmcnt(4)
    v_mfma_f32_16x16x32_bf16 v[100:103], a[0:3], a[56:59], v[100:103]
    ds_read_b64_tr_b16 a[16:17], v17 offset:440
    v_mfma_f32_16x16x32_bf16 v[184:187], a[48:51], a[4:7], v[184:187]
    ds_read_b64_tr_b16 a[18:19], v17 offset:920
    v_mfma_f32_16x16x32_bf16 v[188:191], a[52:55], a[4:7], v[188:191]
    buffer_load_dwordx4 v5, s[12:15], s54 offen offset:3168  lds
    v_mfma_f32_16x16x32_bf16 v[192:195], a[56:59], a[4:7], v[192:195]
    ds_read_b64_tr_b16 a[20:21], v15 offset:352
    s_waitcnt lgkmcnt(5)
    v_mfma_f32_16x16x32_bf16 v[196:199], a[48:51], a[8:11], v[196:199]
    ds_read_b64_tr_b16 a[22:23], v15 offset:832
    v_mfma_f32_16x16x32_bf16 v[200:203], a[52:55], a[8:11], v[200:203]
    s_waitcnt lgkmcnt(4)
    v_mfma_f32_16x16x32_bf16 v[204:207], a[56:59], a[8:11], v[204:207]
    s_waitcnt vmcnt(14)
    s_barrier
    v_mfma_f32_16x16x32_bf16 v[208:211], a[48:51], a[12:15], v[208:211]
    ds_read_b128 a[32:35], v12 offset:0
    s_add_u32 m0, s52, 67584
    v_mfma_f32_16x16x32_bf16 v[212:215], a[52:55], a[12:15], v[212:215]
    ds_read_b64_tr_b16 a[0:1], v15 offset:16896
    s_add_u32 s54, s54, 122880
    v_mfma_f32_16x16x32_bf16 v[216:219], a[56:59], a[12:15], v[216:219]
    ds_read_b128 a[36:39], v12 offset:2048
    s_waitcnt lgkmcnt(5)
    v_mfma_f32_16x16x32_bf16 v[244:247], a[60:63], a[48:51], v[244:247]
    buffer_load_dwordx4 v2, s[12:15], s54 offen offset:0  lds
    v_mfma_f32_16x16x32_bf16 v[220:223], a[48:51], a[16:19], v[220:223]
    ds_read_b64_tr_b16 a[2:3], v15 offset:17376
    v_mfma_f32_16x16x32_bf16 v[224:227], a[52:55], a[16:19], v[224:227]
    ds_read_b128 a[40:43], v12 offset:4096
    v_mfma_f32_16x16x32_bf16 v[228:231], a[56:59], a[16:19], v[228:231]
    ds_read_b64_tr_b16 a[4:5], v15 offset:16904
    s_waitcnt lgkmcnt(6)
    v_mfma_f32_16x16x32_bf16 v[248:251], a[60:63], a[52:55], v[248:251]
    ds_read_b64_tr_b16 a[6:7], v15 offset:17384
    v_mfma_f32_16x16x32_bf16 v[232:235], a[48:51], a[20:23], v[232:235]
    v_mfma_f32_16x16x32_bf16 v[236:239], a[52:55], a[20:23], v[236:239]
    buffer_load_dwordx4 v3, s[12:15], s54 offen offset:1056  lds
    v_mfma_f32_16x16x32_bf16 v[240:243], a[56:59], a[20:23], v[240:243]
    ds_read_b64_tr_b16 a[8:9], v15 offset:16912
    s_waitcnt lgkmcnt(3)
    v_mfma_f32_16x16x32_bf16 v[252:255], a[60:63], a[56:59], v[252:255]
    ds_read_b64_tr_b16 a[10:11], v15 offset:17392
    v_mfma_f32_16x16x32_bf16 v[144:147], a[0:3], a[32:35], v[144:147]
    ds_read_b64_tr_b16 a[12:13], v15 offset:16920
    v_mfma_f32_16x16x32_bf16 v[104:107], a[0:3], a[36:39], v[104:107]
    ds_read_b64_tr_b16 a[14:15], v15 offset:17400
    s_waitcnt lgkmcnt(4)
    v_mfma_f32_16x16x32_bf16 v[64:67], a[0:3], a[40:43], v[64:67]
    buffer_load_dwordx4 v4, s[12:15], s54 offen offset:2112  lds
    v_mfma_f32_16x16x32_bf16 v[148:151], a[4:7], a[32:35], v[148:151]
    ds_read_b64_tr_b16 a[16:17], v15 offset:16928
    v_mfma_f32_16x16x32_bf16 v[108:111], a[4:7], a[36:39], v[108:111]
    ds_read_b64_tr_b16 a[18:19], v15 offset:17408
    s_waitcnt lgkmcnt(4)
    v_mfma_f32_16x16x32_bf16 v[68:71], a[4:7], a[40:43], v[68:71]
    ds_read_b64_tr_b16 a[20:21], v15 offset:17056
    v_mfma_f32_16x16x32_bf16 v[152:155], a[8:11], a[32:35], v[152:155]
    v_mfma_f32_16x16x32_bf16 v[112:115], a[8:11], a[36:39], v[112:115]
    ds_read_b64_tr_b16 a[22:23], v15 offset:17536
    s_waitcnt lgkmcnt(4)
    v_mfma_f32_16x16x32_bf16 v[72:75], a[8:11], a[40:43], v[72:75]
    buffer_load_dwordx4 v5, s[12:15], s54 offen offset:3168  lds
    v_mfma_f32_16x16x32_bf16 v[156:159], a[12:15], a[32:35], v[156:159]
    ds_read_b64_tr_b16 a[0:1], v15 offset:17064
    s_add_u32 m0, s53, 49152
    v_mfma_f32_16x16x32_bf16 v[116:119], a[12:15], a[36:39], v[116:119]
    ds_read_b64_tr_b16 a[2:3], v15 offset:17544
    s_add_u32 s55, s55, 128
    v_mfma_f32_16x16x32_bf16 v[76:79], a[12:15], a[40:43], v[76:79]
    ds_read_b128 a[44:47], v14 offset:384
    s_waitcnt lgkmcnt(5)
    v_mfma_f32_16x16x32_bf16 v[160:163], a[16:19], a[32:35], v[160:163]
    ds_read_b64_tr_b16 a[4:5], v15 offset:17072
    v_mfma_f32_16x16x32_bf16 v[120:123], a[16:19], a[36:39], v[120:123]
    ds_read_b64_tr_b16 a[6:7], v15 offset:17552
    s_waitcnt lgkmcnt(5)
    v_mfma_f32_16x16x32_bf16 v[80:83], a[16:19], a[40:43], v[80:83]
    buffer_load_dwordx4 v6, s[8:11], s55 offen offset:0  lds
    v_mfma_f32_16x16x32_bf16 v[164:167], a[20:23], a[32:35], v[164:167]
    ds_read_b64_tr_b16 a[8:9], v15 offset:17080
    v_mfma_f32_16x16x32_bf16 v[124:127], a[20:23], a[36:39], v[124:127]
    s_waitcnt lgkmcnt(4)
    v_mfma_f32_16x16x32_bf16 v[84:87], a[20:23], a[40:43], v[84:87]
    ds_read_b64_tr_b16 a[10:11], v15 offset:17560
    v_mfma_f32_16x16x32_bf16 v[168:171], a[0:3], a[32:35], v[168:171]
    ds_read_b64_tr_b16 a[12:13], v15 offset:17088
    v_mfma_f32_16x16x32_bf16 v[128:131], a[0:3], a[36:39], v[128:131]
    ds_read_b64_tr_b16 a[14:15], v15 offset:17568
    s_waitcnt lgkmcnt(4)
    v_mfma_f32_16x16x32_bf16 v[88:91], a[0:3], a[40:43], v[88:91]
    buffer_load_dwordx4 v7, s[8:11], s55 offen offset:1024  lds
    v_mfma_f32_16x16x32_bf16 v[172:175], a[4:7], a[32:35], v[172:175]
    ds_read_b64_tr_b16 a[16:17], v17 offset:17216
    v_mfma_f32_16x16x32_bf16 v[132:135], a[4:7], a[36:39], v[132:135]
    ds_read_b64_tr_b16 a[18:19], v17 offset:17696
    s_waitcnt lgkmcnt(4)
    v_mfma_f32_16x16x32_bf16 v[92:95], a[4:7], a[40:43], v[92:95]
    ds_read_b64_tr_b16 a[20:21], v17 offset:17256
    v_mfma_f32_16x16x32_bf16 v[176:179], a[8:11], a[32:35], v[176:179]
    ds_read_b64_tr_b16 a[22:23], v17 offset:17736
    v_mfma_f32_16x16x32_bf16 v[136:139], a[8:11], a[36:39], v[136:139]
    s_waitcnt lgkmcnt(4)
    v_mfma_f32_16x16x32_bf16 v[96:99], a[8:11], a[40:43], v[96:99]
    buffer_load_dwordx4 v8, s[8:11], s55 offen offset:2048  lds
    v_mfma_f32_16x16x32_bf16 v[180:183], a[12:15], a[32:35], v[180:183]
    ds_read_b64_tr_b16 a[0:1], v17 offset:17296
    v_mfma_f32_16x16x32_bf16 v[140:143], a[12:15], a[36:39], v[140:143]
    ds_read_b64_tr_b16 a[2:3], v17 offset:17776
    s_waitcnt lgkmcnt(4)
    v_mfma_f32_16x16x32_bf16 v[100:103], a[12:15], a[40:43], v[100:103]
    ds_read_b64_tr_b16 a[4:5], v17 offset:17336
    v_mfma_f32_16x16x32_bf16 v[184:187], a[32:35], a[16:19], v[184:187]
    ds_read_b64_tr_b16 a[6:7], v17 offset:17816
    v_mfma_f32_16x16x32_bf16 v[188:191], a[36:39], a[16:19], v[188:191]
    ds_read_b64_tr_b16 a[8:9], v15 offset:17248
    s_waitcnt lgkmcnt(5)
    v_mfma_f32_16x16x32_bf16 v[192:195], a[40:43], a[16:19], v[192:195]
    buffer_load_dwordx4 v9, s[8:11], s55 offen offset:3072  lds
    v_mfma_f32_16x16x32_bf16 v[196:199], a[32:35], a[20:23], v[196:199]
    ds_read_b64_tr_b16 a[10:11], v15 offset:17728
    v_mfma_f32_16x16x32_bf16 v[200:203], a[36:39], a[20:23], v[200:203]
    s_waitcnt lgkmcnt(4)
    v_mfma_f32_16x16x32_bf16 v[204:207], a[40:43], a[20:23], v[204:207]
    s_waitcnt vmcnt(18)
    s_barrier
    v_mfma_f32_16x16x32_bf16 v[208:211], a[32:35], a[0:3], v[208:211]
    ds_read_b128 a[48:51], v13 offset:0
    s_add_u32 m0, s53, 53248
    v_mfma_f32_16x16x32_bf16 v[212:215], a[36:39], a[0:3], v[212:215]
    ds_read_b64_tr_b16 a[12:13], v15 offset:33792
    v_mfma_f32_16x16x32_bf16 v[216:219], a[40:43], a[0:3], v[216:219]
    ds_read_b128 a[52:55], v13 offset:2048
    s_waitcnt lgkmcnt(5)
    v_mfma_f32_16x16x32_bf16 v[244:247], a[44:47], a[32:35], v[244:247]
    ds_read_b64_tr_b16 a[14:15], v15 offset:34272
    v_mfma_f32_16x16x32_bf16 v[220:223], a[32:35], a[4:7], v[220:223]
    buffer_load_dwordx4 v10, s[8:11], s55 offen offset:0  lds
    v_mfma_f32_16x16x32_bf16 v[224:227], a[36:39], a[4:7], v[224:227]
    ds_read_b128 a[56:59], v13 offset:4096
    v_mfma_f32_16x16x32_bf16 v[228:231], a[40:43], a[4:7], v[228:231]
    s_waitcnt lgkmcnt(5)
    v_mfma_f32_16x16x32_bf16 v[248:251], a[44:47], a[36:39], v[248:251]
    ds_read_b64_tr_b16 a[16:17], v15 offset:33800
    v_mfma_f32_16x16x32_bf16 v[232:235], a[32:35], a[8:11], v[232:235]
    ds_read_b64_tr_b16 a[18:19], v15 offset:34280
    v_mfma_f32_16x16x32_bf16 v[236:239], a[36:39], a[8:11], v[236:239]
    ds_read_b64_tr_b16 a[20:21], v15 offset:33808
    v_mfma_f32_16x16x32_bf16 v[240:243], a[40:43], a[8:11], v[240:243]
    ds_read_b64_tr_b16 a[22:23], v15 offset:34288
    s_waitcnt lgkmcnt(4)
    v_mfma_f32_16x16x32_bf16 v[252:255], a[44:47], a[40:43], v[252:255]
    ds_read_b64_tr_b16 a[0:1], v15 offset:33816
    v_mfma_f32_16x16x32_bf16 v[144:147], a[12:15], a[48:51], v[144:147]
    buffer_load_dwordx4 v11, s[8:11], s55 offen offset:1024  lds
    v_mfma_f32_16x16x32_bf16 v[104:107], a[12:15], a[52:55], v[104:107]
    s_add_u32 m0, s52, 0
    s_add_u32 s54, s54, 122880
    s_waitcnt lgkmcnt(3)
    v_mfma_f32_16x16x32_bf16 v[64:67], a[12:15], a[56:59], v[64:67]
    ds_read_b64_tr_b16 a[2:3], v15 offset:34296
    v_mfma_f32_16x16x32_bf16 v[148:151], a[16:19], a[48:51], v[148:151]
    ds_read_b64_tr_b16 a[4:5], v15 offset:33824
    v_mfma_f32_16x16x32_bf16 v[108:111], a[16:19], a[52:55], v[108:111]
    ds_read_b64_tr_b16 a[6:7], v15 offset:34304
    s_waitcnt lgkmcnt(4)
    v_mfma_f32_16x16x32_bf16 v[68:71], a[16:19], a[56:59], v[68:71]
    ds_read_b64_tr_b16 a[8:9], v15 offset:33952
    v_mfma_f32_16x16x32_bf16 v[152:155], a[20:23], a[48:51], v[152:155]
    ds_read_b64_tr_b16 a[10:11], v15 offset:34432
    v_mfma_f32_16x16x32_bf16 v[112:115], a[20:23], a[52:55], v[112:115]
    buffer_load_dwordx4 v2, s[12:15], s54 offen offset:0  lds
    v_mfma_f32_16x16x32_bf16 v[72:75], a[20:23], a[56:59], v[72:75]
    s_waitcnt lgkmcnt(4)
    v_mfma_f32_16x16x32_bf16 v[156:159], a[0:3], a[48:51], v[156:159]
    ds_read_b64_tr_b16 a[12:13], v15 offset:33960
    v_mfma_f32_16x16x32_bf16 v[116:119], a[0:3], a[52:55], v[116:119]
    ds_read_b64_tr_b16 a[14:15], v15 offset:34440
    s_waitcnt lgkmcnt(4)
    v_mfma_f32_16x16x32_bf16 v[76:79], a[0:3], a[56:59], v[76:79]
    ds_read_b128 a[60:63], v14 offset:448
    v_mfma_f32_16x16x32_bf16 v[160:163], a[4:7], a[48:51], v[160:163]
    ds_read_b64_tr_b16 a[16:17], v15 offset:33968
    v_mfma_f32_16x16x32_bf16 v[120:123], a[4:7], a[52:55], v[120:123]
    ds_read_b64_tr_b16 a[18:19], v15 offset:34448
    s_waitcnt lgkmcnt(5)
    v_mfma_f32_16x16x32_bf16 v[80:83], a[4:7], a[56:59], v[80:83]
    v_mfma_f32_16x16x32_bf16 v[164:167], a[8:11], a[48:51], v[164:167]
    buffer_load_dwordx4 v3, s[12:15], s54 offen offset:1056  lds
    v_mfma_f32_16x16x32_bf16 v[124:127], a[8:11], a[52:55], v[124:127]
    ds_read_b64_tr_b16 a[20:21], v15 offset:33976
    s_waitcnt lgkmcnt(4)
    v_mfma_f32_16x16x32_bf16 v[84:87], a[8:11], a[56:59], v[84:87]
    ds_read_b64_tr_b16 a[22:23], v15 offset:34456
    v_mfma_f32_16x16x32_bf16 v[168:171], a[12:15], a[48:51], v[168:171]
    ds_read_b64_tr_b16 a[0:1], v15 offset:33984
    v_mfma_f32_16x16x32_bf16 v[128:131], a[12:15], a[52:55], v[128:131]
    ds_read_b64_tr_b16 a[2:3], v15 offset:34464
    s_waitcnt lgkmcnt(4)
    v_mfma_f32_16x16x32_bf16 v[88:91], a[12:15], a[56:59], v[88:91]
    ds_read_b64_tr_b16 a[4:5], v17 offset:34112
    v_mfma_f32_16x16x32_bf16 v[172:175], a[16:19], a[48:51], v[172:175]
    v_mfma_f32_16x16x32_bf16 v[132:135], a[16:19], a[52:55], v[132:135]
    ds_read_b64_tr_b16 a[6:7], v17 offset:34592
    s_waitcnt lgkmcnt(4)
    v_mfma_f32_16x16x32_bf16 v[92:95], a[16:19], a[56:59], v[92:95]
    buffer_load_dwordx4 v4, s[12:15], s54 offen offset:2112  lds
    v_mfma_f32_16x16x32_bf16 v[176:179], a[20:23], a[48:51], v[176:179]
    ds_read_b64_tr_b16 a[8:9], v17 offset:34152
    v_mfma_f32_16x16x32_bf16 v[136:139], a[20:23], a[52:55], v[136:139]
    ds_read_b64_tr_b16 a[10:11], v17 offset:34632
    s_waitcnt lgkmcnt(4)
    v_mfma_f32_16x16x32_bf16 v[96:99], a[20:23], a[56:59], v[96:99]
    ds_read_b64_tr_b16 a[12:13], v17 offset:34192
    v_mfma_f32_16x16x32_bf16 v[180:183], a[0:3], a[48:51], v[180:183]
    ds_read_b64_tr_b16 a[14:15], v17 offset:34672
    v_mfma_f32_16x16x32_bf16 v[140:143], a[0:3], a[52:55], v[140:143]
    s_waitcnt lgkmcnt(4)
    v_mfma_f32_16x16x32_bf16 v[100:103], a[0:3], a[56:59], v[100:103]
    ds_read_b64_tr_b16 a[16:17], v17 offset:34232
    v_mfma_f32_16x16x32_bf16 v[184:187], a[48:51], a[4:7], v[184:187]
    ds_read_b64_tr_b16 a[18:19], v17 offset:34712
    v_mfma_f32_16x16x32_bf16 v[188:191], a[52:55], a[4:7], v[188:191]
    buffer_load_dwordx4 v5, s[12:15], s54 offen offset:3168  lds
    v_mfma_f32_16x16x32_bf16 v[192:195], a[56:59], a[4:7], v[192:195]
    ds_read_b64_tr_b16 a[20:21], v15 offset:34144
    s_waitcnt lgkmcnt(5)
    v_mfma_f32_16x16x32_bf16 v[196:199], a[48:51], a[8:11], v[196:199]
    ds_read_b64_tr_b16 a[22:23], v15 offset:34624
    v_mfma_f32_16x16x32_bf16 v[200:203], a[52:55], a[8:11], v[200:203]
    s_waitcnt lgkmcnt(4)
    v_mfma_f32_16x16x32_bf16 v[204:207], a[56:59], a[8:11], v[204:207]
    s_waitcnt vmcnt(14)
    s_barrier
    v_mfma_f32_16x16x32_bf16 v[208:211], a[48:51], a[12:15], v[208:211]
    ds_read_b128 a[32:35], v12 offset:24576
    s_add_u32 m0, s52, 16896
    v_mfma_f32_16x16x32_bf16 v[212:215], a[52:55], a[12:15], v[212:215]
    ds_read_b64_tr_b16 a[0:1], v16 offset:0
    s_add_u32 s54, s54, 122880
    v_mfma_f32_16x16x32_bf16 v[216:219], a[56:59], a[12:15], v[216:219]
    ds_read_b128 a[36:39], v12 offset:26624
    s_waitcnt lgkmcnt(5)
    v_mfma_f32_16x16x32_bf16 v[244:247], a[60:63], a[48:51], v[244:247]
    buffer_load_dwordx4 v2, s[12:15], s54 offen offset:0  lds
    v_mfma_f32_16x16x32_bf16 v[220:223], a[48:51], a[16:19], v[220:223]
    ds_read_b64_tr_b16 a[2:3], v16 offset:480
    v_mfma_f32_16x16x32_bf16 v[224:227], a[52:55], a[16:19], v[224:227]
    ds_read_b128 a[40:43], v12 offset:28672
    v_mfma_f32_16x16x32_bf16 v[228:231], a[56:59], a[16:19], v[228:231]
    ds_read_b64_tr_b16 a[4:5], v16 offset:8
    s_waitcnt lgkmcnt(6)
    v_mfma_f32_16x16x32_bf16 v[248:251], a[60:63], a[52:55], v[248:251]
    ds_read_b64_tr_b16 a[6:7], v16 offset:488
    v_mfma_f32_16x16x32_bf16 v[232:235], a[48:51], a[20:23], v[232:235]
    v_mfma_f32_16x16x32_bf16 v[236:239], a[52:55], a[20:23], v[236:239]
    buffer_load_dwordx4 v3, s[12:15], s54 offen offset:1056  lds
    v_mfma_f32_16x16x32_bf16 v[240:243], a[56:59], a[20:23], v[240:243]
    ds_read_b64_tr_b16 a[8:9], v16 offset:16
    s_waitcnt lgkmcnt(3)
    v_mfma_f32_16x16x32_bf16 v[252:255], a[60:63], a[56:59], v[252:255]
    ds_read_b64_tr_b16 a[10:11], v16 offset:496
    v_mfma_f32_16x16x32_bf16 v[144:147], a[0:3], a[32:35], v[144:147]
    ds_read_b64_tr_b16 a[12:13], v16 offset:24
    v_mfma_f32_16x16x32_bf16 v[104:107], a[0:3], a[36:39], v[104:107]
    ds_read_b64_tr_b16 a[14:15], v16 offset:504
    s_waitcnt lgkmcnt(4)
    v_mfma_f32_16x16x32_bf16 v[64:67], a[0:3], a[40:43], v[64:67]
    buffer_load_dwordx4 v4, s[12:15], s54 offen offset:2112  lds
    v_mfma_f32_16x16x32_bf16 v[148:151], a[4:7], a[32:35], v[148:151]
    ds_read_b64_tr_b16 a[16:17], v16 offset:32
    v_mfma_f32_16x16x32_bf16 v[108:111], a[4:7], a[36:39], v[108:111]
    ds_read_b64_tr_b16 a[18:19], v16 offset:512
    s_waitcnt lgkmcnt(4)
    v_mfma_f32_16x16x32_bf16 v[68:71], a[4:7], a[40:43], v[68:71]
    ds_read_b64_tr_b16 a[20:21], v16 offset:160
    v_mfma_f32_16x16x32_bf16 v[152:155], a[8:11], a[32:35], v[152:155]
    v_mfma_f32_16x16x32_bf16 v[112:115], a[8:11], a[36:39], v[112:115]
    ds_read_b64_tr_b16 a[22:23], v16 offset:640
    s_waitcnt lgkmcnt(4)
    v_mfma_f32_16x16x32_bf16 v[72:75], a[8:11], a[40:43], v[72:75]
    buffer_load_dwordx4 v5, s[12:15], s54 offen offset:3168  lds
    v_mfma_f32_16x16x32_bf16 v[156:159], a[12:15], a[32:35], v[156:159]
    ds_read_b64_tr_b16 a[0:1], v16 offset:168
    s_add_u32 m0, s53, 0
    v_mfma_f32_16x16x32_bf16 v[116:119], a[12:15], a[36:39], v[116:119]
    ds_read_b64_tr_b16 a[2:3], v16 offset:648
    s_add_u32 s55, s55, 128
    v_mfma_f32_16x16x32_bf16 v[76:79], a[12:15], a[40:43], v[76:79]
    ds_read_b128 a[44:47], v14 offset:512
    s_waitcnt lgkmcnt(5)
    v_mfma_f32_16x16x32_bf16 v[160:163], a[16:19], a[32:35], v[160:163]
    ds_read_b64_tr_b16 a[4:5], v16 offset:176
    v_mfma_f32_16x16x32_bf16 v[120:123], a[16:19], a[36:39], v[120:123]
    ds_read_b64_tr_b16 a[6:7], v16 offset:656
    s_waitcnt lgkmcnt(5)
    v_mfma_f32_16x16x32_bf16 v[80:83], a[16:19], a[40:43], v[80:83]
    buffer_load_dwordx4 v6, s[8:11], s55 offen offset:0  lds
    v_mfma_f32_16x16x32_bf16 v[164:167], a[20:23], a[32:35], v[164:167]
    ds_read_b64_tr_b16 a[8:9], v16 offset:184
    v_mfma_f32_16x16x32_bf16 v[124:127], a[20:23], a[36:39], v[124:127]
    s_waitcnt lgkmcnt(4)
    v_mfma_f32_16x16x32_bf16 v[84:87], a[20:23], a[40:43], v[84:87]
    ds_read_b64_tr_b16 a[10:11], v16 offset:664
    v_mfma_f32_16x16x32_bf16 v[168:171], a[0:3], a[32:35], v[168:171]
    ds_read_b64_tr_b16 a[12:13], v16 offset:192
    v_mfma_f32_16x16x32_bf16 v[128:131], a[0:3], a[36:39], v[128:131]
    ds_read_b64_tr_b16 a[14:15], v16 offset:672
    s_waitcnt lgkmcnt(4)
    v_mfma_f32_16x16x32_bf16 v[88:91], a[0:3], a[40:43], v[88:91]
    buffer_load_dwordx4 v7, s[8:11], s55 offen offset:1024  lds
    v_mfma_f32_16x16x32_bf16 v[172:175], a[4:7], a[32:35], v[172:175]
    ds_read_b64_tr_b16 a[16:17], v18 offset:320
    v_mfma_f32_16x16x32_bf16 v[132:135], a[4:7], a[36:39], v[132:135]
    ds_read_b64_tr_b16 a[18:19], v18 offset:800
    s_waitcnt lgkmcnt(4)
    v_mfma_f32_16x16x32_bf16 v[92:95], a[4:7], a[40:43], v[92:95]
    ds_read_b64_tr_b16 a[20:21], v18 offset:360
    v_mfma_f32_16x16x32_bf16 v[176:179], a[8:11], a[32:35], v[176:179]
    ds_read_b64_tr_b16 a[22:23], v18 offset:840
    v_mfma_f32_16x16x32_bf16 v[136:139], a[8:11], a[36:39], v[136:139]
    s_waitcnt lgkmcnt(4)
    v_mfma_f32_16x16x32_bf16 v[96:99], a[8:11], a[40:43], v[96:99]
    buffer_load_dwordx4 v8, s[8:11], s55 offen offset:2048  lds
    v_mfma_f32_16x16x32_bf16 v[180:183], a[12:15], a[32:35], v[180:183]
    ds_read_b64_tr_b16 a[0:1], v18 offset:400
    v_mfma_f32_16x16x32_bf16 v[140:143], a[12:15], a[36:39], v[140:143]
    ds_read_b64_tr_b16 a[2:3], v18 offset:880
    s_waitcnt lgkmcnt(4)
    v_mfma_f32_16x16x32_bf16 v[100:103], a[12:15], a[40:43], v[100:103]
    ds_read_b64_tr_b16 a[4:5], v18 offset:440
    v_mfma_f32_16x16x32_bf16 v[184:187], a[32:35], a[16:19], v[184:187]
    ds_read_b64_tr_b16 a[6:7], v18 offset:920
    v_mfma_f32_16x16x32_bf16 v[188:191], a[36:39], a[16:19], v[188:191]
    ds_read_b64_tr_b16 a[8:9], v16 offset:352
    s_waitcnt lgkmcnt(5)
    v_mfma_f32_16x16x32_bf16 v[192:195], a[40:43], a[16:19], v[192:195]
    buffer_load_dwordx4 v9, s[8:11], s55 offen offset:3072  lds
    v_mfma_f32_16x16x32_bf16 v[196:199], a[32:35], a[20:23], v[196:199]
    ds_read_b64_tr_b16 a[10:11], v16 offset:832
    v_mfma_f32_16x16x32_bf16 v[200:203], a[36:39], a[20:23], v[200:203]
    s_waitcnt lgkmcnt(4)
    v_mfma_f32_16x16x32_bf16 v[204:207], a[40:43], a[20:23], v[204:207]
    s_waitcnt vmcnt(18)
    s_barrier
    v_mfma_f32_16x16x32_bf16 v[208:211], a[32:35], a[0:3], v[208:211]
    ds_read_b128 a[48:51], v13 offset:24576
    s_add_u32 m0, s53, 4096
    v_mfma_f32_16x16x32_bf16 v[212:215], a[36:39], a[0:3], v[212:215]
    ds_read_b64_tr_b16 a[12:13], v16 offset:16896
    v_mfma_f32_16x16x32_bf16 v[216:219], a[40:43], a[0:3], v[216:219]
    ds_read_b128 a[52:55], v13 offset:26624
    s_waitcnt lgkmcnt(5)
    v_mfma_f32_16x16x32_bf16 v[244:247], a[44:47], a[32:35], v[244:247]
    ds_read_b64_tr_b16 a[14:15], v16 offset:17376
    v_mfma_f32_16x16x32_bf16 v[220:223], a[32:35], a[4:7], v[220:223]
    buffer_load_dwordx4 v10, s[8:11], s55 offen offset:0  lds
    v_mfma_f32_16x16x32_bf16 v[224:227], a[36:39], a[4:7], v[224:227]
    ds_read_b128 a[56:59], v13 offset:28672
    v_mfma_f32_16x16x32_bf16 v[228:231], a[40:43], a[4:7], v[228:231]
    s_waitcnt lgkmcnt(5)
    v_mfma_f32_16x16x32_bf16 v[248:251], a[44:47], a[36:39], v[248:251]
    ds_read_b64_tr_b16 a[16:17], v16 offset:16904
    v_mfma_f32_16x16x32_bf16 v[232:235], a[32:35], a[8:11], v[232:235]
    ds_read_b64_tr_b16 a[18:19], v16 offset:17384
    v_mfma_f32_16x16x32_bf16 v[236:239], a[36:39], a[8:11], v[236:239]
    ds_read_b64_tr_b16 a[20:21], v16 offset:16912
    v_mfma_f32_16x16x32_bf16 v[240:243], a[40:43], a[8:11], v[240:243]
    ds_read_b64_tr_b16 a[22:23], v16 offset:17392
    s_waitcnt lgkmcnt(4)
    v_mfma_f32_16x16x32_bf16 v[252:255], a[44:47], a[40:43], v[252:255]
    ds_read_b64_tr_b16 a[0:1], v16 offset:16920
    v_mfma_f32_16x16x32_bf16 v[144:147], a[12:15], a[48:51], v[144:147]
    buffer_load_dwordx4 v11, s[8:11], s55 offen offset:1024  lds
    v_mfma_f32_16x16x32_bf16 v[104:107], a[12:15], a[52:55], v[104:107]
    s_add_u32 m0, s52, 33792
    s_add_u32 s54, s54, 122880
    s_waitcnt lgkmcnt(3)
    v_mfma_f32_16x16x32_bf16 v[64:67], a[12:15], a[56:59], v[64:67]
    ds_read_b64_tr_b16 a[2:3], v16 offset:17400
    v_mfma_f32_16x16x32_bf16 v[148:151], a[16:19], a[48:51], v[148:151]
    ds_read_b64_tr_b16 a[4:5], v16 offset:16928
    v_mfma_f32_16x16x32_bf16 v[108:111], a[16:19], a[52:55], v[108:111]
    ds_read_b64_tr_b16 a[6:7], v16 offset:17408
    s_waitcnt lgkmcnt(4)
    v_mfma_f32_16x16x32_bf16 v[68:71], a[16:19], a[56:59], v[68:71]
    ds_read_b64_tr_b16 a[8:9], v16 offset:17056
    v_mfma_f32_16x16x32_bf16 v[152:155], a[20:23], a[48:51], v[152:155]
    ds_read_b64_tr_b16 a[10:11], v16 offset:17536
    v_mfma_f32_16x16x32_bf16 v[112:115], a[20:23], a[52:55], v[112:115]
    buffer_load_dwordx4 v2, s[12:15], s54 offen offset:0  lds
    v_mfma_f32_16x16x32_bf16 v[72:75], a[20:23], a[56:59], v[72:75]
    s_waitcnt lgkmcnt(4)
    v_mfma_f32_16x16x32_bf16 v[156:159], a[0:3], a[48:51], v[156:159]
    ds_read_b64_tr_b16 a[12:13], v16 offset:17064
    v_mfma_f32_16x16x32_bf16 v[116:119], a[0:3], a[52:55], v[116:119]
    ds_read_b64_tr_b16 a[14:15], v16 offset:17544
    s_waitcnt lgkmcnt(4)
    v_mfma_f32_16x16x32_bf16 v[76:79], a[0:3], a[56:59], v[76:79]
    ds_read_b128 a[60:63], v14 offset:576
    v_mfma_f32_16x16x32_bf16 v[160:163], a[4:7], a[48:51], v[160:163]
    ds_read_b64_tr_b16 a[16:17], v16 offset:17072
    v_mfma_f32_16x16x32_bf16 v[120:123], a[4:7], a[52:55], v[120:123]
    ds_read_b64_tr_b16 a[18:19], v16 offset:17552
    s_waitcnt lgkmcnt(5)
    v_mfma_f32_16x16x32_bf16 v[80:83], a[4:7], a[56:59], v[80:83]
    v_mfma_f32_16x16x32_bf16 v[164:167], a[8:11], a[48:51], v[164:167]
    buffer_load_dwordx4 v3, s[12:15], s54 offen offset:1056  lds
    v_mfma_f32_16x16x32_bf16 v[124:127], a[8:11], a[52:55], v[124:127]
    ds_read_b64_tr_b16 a[20:21], v16 offset:17080
    s_waitcnt lgkmcnt(4)
    v_mfma_f32_16x16x32_bf16 v[84:87], a[8:11], a[56:59], v[84:87]
    ds_read_b64_tr_b16 a[22:23], v16 offset:17560
    v_mfma_f32_16x16x32_bf16 v[168:171], a[12:15], a[48:51], v[168:171]
    ds_read_b64_tr_b16 a[0:1], v16 offset:17088
    v_mfma_f32_16x16x32_bf16 v[128:131], a[12:15], a[52:55], v[128:131]
    ds_read_b64_tr_b16 a[2:3], v16 offset:17568
    s_waitcnt lgkmcnt(4)
    v_mfma_f32_16x16x32_bf16 v[88:91], a[12:15], a[56:59], v[88:91]
    ds_read_b64_tr_b16 a[4:5], v18 offset:17216
    v_mfma_f32_16x16x32_bf16 v[172:175], a[16:19], a[48:51], v[172:175]
    v_mfma_f32_16x16x32_bf16 v[132:135], a[16:19], a[52:55], v[132:135]
    ds_read_b64_tr_b16 a[6:7], v18 offset:17696
    s_waitcnt lgkmcnt(4)
    v_mfma_f32_16x16x32_bf16 v[92:95], a[16:19], a[56:59], v[92:95]
    buffer_load_dwordx4 v4, s[12:15], s54 offen offset:2112  lds
    v_mfma_f32_16x16x32_bf16 v[176:179], a[20:23], a[48:51], v[176:179]
    ds_read_b64_tr_b16 a[8:9], v18 offset:17256
    v_mfma_f32_16x16x32_bf16 v[136:139], a[20:23], a[52:55], v[136:139]
    ds_read_b64_tr_b16 a[10:11], v18 offset:17736
    s_waitcnt lgkmcnt(4)
    v_mfma_f32_16x16x32_bf16 v[96:99], a[20:23], a[56:59], v[96:99]
    ds_read_b64_tr_b16 a[12:13], v18 offset:17296
    v_mfma_f32_16x16x32_bf16 v[180:183], a[0:3], a[48:51], v[180:183]
    ds_read_b64_tr_b16 a[14:15], v18 offset:17776
    v_mfma_f32_16x16x32_bf16 v[140:143], a[0:3], a[52:55], v[140:143]
    s_waitcnt lgkmcnt(4)
    v_mfma_f32_16x16x32_bf16 v[100:103], a[0:3], a[56:59], v[100:103]
    ds_read_b64_tr_b16 a[16:17], v18 offset:17336
    v_mfma_f32_16x16x32_bf16 v[184:187], a[48:51], a[4:7], v[184:187]
    ds_read_b64_tr_b16 a[18:19], v18 offset:17816
    v_mfma_f32_16x16x32_bf16 v[188:191], a[52:55], a[4:7], v[188:191]
    buffer_load_dwordx4 v5, s[12:15], s54 offen offset:3168  lds
    v_mfma_f32_16x16x32_bf16 v[192:195], a[56:59], a[4:7], v[192:195]
    ds_read_b64_tr_b16 a[20:21], v16 offset:17248
    s_waitcnt lgkmcnt(5)
    v_mfma_f32_16x16x32_bf16 v[196:199], a[48:51], a[8:11], v[196:199]
    ds_read_b64_tr_b16 a[22:23], v16 offset:17728
    v_mfma_f32_16x16x32_bf16 v[200:203], a[52:55], a[8:11], v[200:203]
    s_waitcnt lgkmcnt(4)
    v_mfma_f32_16x16x32_bf16 v[204:207], a[56:59], a[8:11], v[204:207]
    s_waitcnt vmcnt(14)
    s_barrier
    v_mfma_f32_16x16x32_bf16 v[208:211], a[48:51], a[12:15], v[208:211]
    ds_read_b128 a[32:35], v12 offset:49152
    s_add_u32 m0, s52, 50688
    v_mfma_f32_16x16x32_bf16 v[212:215], a[52:55], a[12:15], v[212:215]
    ds_read_b64_tr_b16 a[0:1], v15 offset:0
    s_add_u32 s54, s54, 122880
    v_mfma_f32_16x16x32_bf16 v[216:219], a[56:59], a[12:15], v[216:219]
    ds_read_b128 a[36:39], v12 offset:51200
    s_waitcnt lgkmcnt(5)
    v_mfma_f32_16x16x32_bf16 v[244:247], a[60:63], a[48:51], v[244:247]
    buffer_load_dwordx4 v2, s[12:15], s54 offen offset:0  lds
    v_mfma_f32_16x16x32_bf16 v[220:223], a[48:51], a[16:19], v[220:223]
    ds_read_b64_tr_b16 a[2:3], v15 offset:480
    v_mfma_f32_16x16x32_bf16 v[224:227], a[52:55], a[16:19], v[224:227]
    ds_read_b128 a[40:43], v12 offset:53248
    v_mfma_f32_16x16x32_bf16 v[228:231], a[56:59], a[16:19], v[228:231]
    ds_read_b64_tr_b16 a[4:5], v15 offset:8
    s_waitcnt lgkmcnt(6)
    v_mfma_f32_16x16x32_bf16 v[248:251], a[60:63], a[52:55], v[248:251]
    ds_read_b64_tr_b16 a[6:7], v15 offset:488
    v_mfma_f32_16x16x32_bf16 v[232:235], a[48:51], a[20:23], v[232:235]
    v_mfma_f32_16x16x32_bf16 v[236:239], a[52:55], a[20:23], v[236:239]
    buffer_load_dwordx4 v3, s[12:15], s54 offen offset:1056  lds
    v_mfma_f32_16x16x32_bf16 v[240:243], a[56:59], a[20:23], v[240:243]
    ds_read_b64_tr_b16 a[8:9], v15 offset:16
    s_waitcnt lgkmcnt(3)
    v_mfma_f32_16x16x32_bf16 v[252:255], a[60:63], a[56:59], v[252:255]
    ds_read_b64_tr_b16 a[10:11], v15 offset:496
    v_mfma_f32_16x16x32_bf16 v[144:147], a[0:3], a[32:35], v[144:147]
    ds_read_b64_tr_b16 a[12:13], v15 offset:24
    v_mfma_f32_16x16x32_bf16 v[104:107], a[0:3], a[36:39], v[104:107]
    ds_read_b64_tr_b16 a[14:15], v15 offset:504
    s_waitcnt lgkmcnt(4)
    v_mfma_f32_16x16x32_bf16 v[64:67], a[0:3], a[40:43], v[64:67]
    buffer_load_dwordx4 v4, s[12:15], s54 offen offset:2112  lds
    v_mfma_f32_16x16x32_bf16 v[148:151], a[4:7], a[32:35], v[148:151]
    ds_read_b64_tr_b16 a[16:17], v15 offset:32
    v_mfma_f32_16x16x32_bf16 v[108:111], a[4:7], a[36:39], v[108:111]
    ds_read_b64_tr_b16 a[18:19], v15 offset:512
    s_waitcnt lgkmcnt(4)
    v_mfma_f32_16x16x32_bf16 v[68:71], a[4:7], a[40:43], v[68:71]
    ds_read_b64_tr_b16 a[20:21], v15 offset:160
    v_mfma_f32_16x16x32_bf16 v[152:155], a[8:11], a[32:35], v[152:155]
    v_mfma_f32_16x16x32_bf16 v[112:115], a[8:11], a[36:39], v[112:115]
    ds_read_b64_tr_b16 a[22:23], v15 offset:640
    s_waitcnt lgkmcnt(4)
    v_mfma_f32_16x16x32_bf16 v[72:75], a[8:11], a[40:43], v[72:75]
    buffer_load_dwordx4 v5, s[12:15], s54 offen offset:3168  lds
    v_mfma_f32_16x16x32_bf16 v[156:159], a[12:15], a[32:35], v[156:159]
    ds_read_b64_tr_b16 a[0:1], v15 offset:168
    s_add_u32 m0, s53, 24576
    v_mfma_f32_16x16x32_bf16 v[116:119], a[12:15], a[36:39], v[116:119]
    ds_read_b64_tr_b16 a[2:3], v15 offset:648
    s_add_u32 s55, s55, 128
    v_mfma_f32_16x16x32_bf16 v[76:79], a[12:15], a[40:43], v[76:79]
    ds_read_b128 a[44:47], v14 offset:640
    s_waitcnt lgkmcnt(5)
    v_mfma_f32_16x16x32_bf16 v[160:163], a[16:19], a[32:35], v[160:163]
    ds_read_b64_tr_b16 a[4:5], v15 offset:176
    v_mfma_f32_16x16x32_bf16 v[120:123], a[16:19], a[36:39], v[120:123]
    ds_read_b64_tr_b16 a[6:7], v15 offset:656
    s_waitcnt lgkmcnt(5)
    v_mfma_f32_16x16x32_bf16 v[80:83], a[16:19], a[40:43], v[80:83]
    buffer_load_dwordx4 v6, s[8:11], s55 offen offset:0  lds
    v_mfma_f32_16x16x32_bf16 v[164:167], a[20:23], a[32:35], v[164:167]
    ds_read_b64_tr_b16 a[8:9], v15 offset:184
    v_mfma_f32_16x16x32_bf16 v[124:127], a[20:23], a[36:39], v[124:127]
    s_waitcnt lgkmcnt(4)
    v_mfma_f32_16x16x32_bf16 v[84:87], a[20:23], a[40:43], v[84:87]
    ds_read_b64_tr_b16 a[10:11], v15 offset:664
    v_mfma_f32_16x16x32_bf16 v[168:171], a[0:3], a[32:35], v[168:171]
    ds_read_b64_tr_b16 a[12:13], v15 offset:192
    v_mfma_f32_16x16x32_bf16 v[128:131], a[0:3], a[36:39], v[128:131]
    ds_read_b64_tr_b16 a[14:15], v15 offset:672
    s_waitcnt lgkmcnt(4)
    v_mfma_f32_16x16x32_bf16 v[88:91], a[0:3], a[40:43], v[88:91]
    buffer_load_dwordx4 v7, s[8:11], s55 offen offset:1024  lds
    v_mfma_f32_16x16x32_bf16 v[172:175], a[4:7], a[32:35], v[172:175]
    ds_read_b64_tr_b16 a[16:17], v17 offset:320
    v_mfma_f32_16x16x32_bf16 v[132:135], a[4:7], a[36:39], v[132:135]
    ds_read_b64_tr_b16 a[18:19], v17 offset:800
    s_waitcnt lgkmcnt(4)
    v_mfma_f32_16x16x32_bf16 v[92:95], a[4:7], a[40:43], v[92:95]
    ds_read_b64_tr_b16 a[20:21], v17 offset:360
    v_mfma_f32_16x16x32_bf16 v[176:179], a[8:11], a[32:35], v[176:179]
    ds_read_b64_tr_b16 a[22:23], v17 offset:840
    v_mfma_f32_16x16x32_bf16 v[136:139], a[8:11], a[36:39], v[136:139]
    s_waitcnt lgkmcnt(4)
    v_mfma_f32_16x16x32_bf16 v[96:99], a[8:11], a[40:43], v[96:99]
    buffer_load_dwordx4 v8, s[8:11], s55 offen offset:2048  lds
    v_mfma_f32_16x16x32_bf16 v[180:183], a[12:15], a[32:35], v[180:183]
    ds_read_b64_tr_b16 a[0:1], v17 offset:400
    v_mfma_f32_16x16x32_bf16 v[140:143], a[12:15], a[36:39], v[140:143]
    ds_read_b64_tr_b16 a[2:3], v17 offset:880
    s_waitcnt lgkmcnt(4)
    v_mfma_f32_16x16x32_bf16 v[100:103], a[12:15], a[40:43], v[100:103]
    ds_read_b64_tr_b16 a[4:5], v17 offset:440
    v_mfma_f32_16x16x32_bf16 v[184:187], a[32:35], a[16:19], v[184:187]
    ds_read_b64_tr_b16 a[6:7], v17 offset:920
    v_mfma_f32_16x16x32_bf16 v[188:191], a[36:39], a[16:19], v[188:191]
    ds_read_b64_tr_b16 a[8:9], v15 offset:352
    s_waitcnt lgkmcnt(5)
    v_mfma_f32_16x16x32_bf16 v[192:195], a[40:43], a[16:19], v[192:195]
    buffer_load_dwordx4 v9, s[8:11], s55 offen offset:3072  lds
    v_mfma_f32_16x16x32_bf16 v[196:199], a[32:35], a[20:23], v[196:199]
    ds_read_b64_tr_b16 a[10:11], v15 offset:832
    v_mfma_f32_16x16x32_bf16 v[200:203], a[36:39], a[20:23], v[200:203]
    s_waitcnt lgkmcnt(4)
    v_mfma_f32_16x16x32_bf16 v[204:207], a[40:43], a[20:23], v[204:207]
    s_waitcnt vmcnt(18)
    s_barrier
    v_mfma_f32_16x16x32_bf16 v[208:211], a[32:35], a[0:3], v[208:211]
    ds_read_b128 a[48:51], v13 offset:49152
    s_add_u32 m0, s53, 28672
    v_mfma_f32_16x16x32_bf16 v[212:215], a[36:39], a[0:3], v[212:215]
    ds_read_b64_tr_b16 a[12:13], v15 offset:16896
    v_mfma_f32_16x16x32_bf16 v[216:219], a[40:43], a[0:3], v[216:219]
    ds_read_b128 a[52:55], v13 offset:51200
    s_waitcnt lgkmcnt(5)
    v_mfma_f32_16x16x32_bf16 v[244:247], a[44:47], a[32:35], v[244:247]
    ds_read_b64_tr_b16 a[14:15], v15 offset:17376
    v_mfma_f32_16x16x32_bf16 v[220:223], a[32:35], a[4:7], v[220:223]
    buffer_load_dwordx4 v10, s[8:11], s55 offen offset:0  lds
    v_mfma_f32_16x16x32_bf16 v[224:227], a[36:39], a[4:7], v[224:227]
    ds_read_b128 a[56:59], v13 offset:53248
    v_mfma_f32_16x16x32_bf16 v[228:231], a[40:43], a[4:7], v[228:231]
    s_waitcnt lgkmcnt(5)
    v_mfma_f32_16x16x32_bf16 v[248:251], a[44:47], a[36:39], v[248:251]
    ds_read_b64_tr_b16 a[16:17], v15 offset:16904
    v_mfma_f32_16x16x32_bf16 v[232:235], a[32:35], a[8:11], v[232:235]
    ds_read_b64_tr_b16 a[18:19], v15 offset:17384
    v_mfma_f32_16x16x32_bf16 v[236:239], a[36:39], a[8:11], v[236:239]
    ds_read_b64_tr_b16 a[20:21], v15 offset:16912
    v_mfma_f32_16x16x32_bf16 v[240:243], a[40:43], a[8:11], v[240:243]
    ds_read_b64_tr_b16 a[22:23], v15 offset:17392
    s_waitcnt lgkmcnt(4)
    v_mfma_f32_16x16x32_bf16 v[252:255], a[44:47], a[40:43], v[252:255]
    ds_read_b64_tr_b16 a[0:1], v15 offset:16920
    v_mfma_f32_16x16x32_bf16 v[144:147], a[12:15], a[48:51], v[144:147]
    buffer_load_dwordx4 v11, s[8:11], s55 offen offset:1024  lds
    v_mfma_f32_16x16x32_bf16 v[104:107], a[12:15], a[52:55], v[104:107]
    s_add_u32 m0, s52, 67584
    s_add_u32 s54, s54, 122880
    s_waitcnt lgkmcnt(3)
    v_mfma_f32_16x16x32_bf16 v[64:67], a[12:15], a[56:59], v[64:67]
    ds_read_b64_tr_b16 a[2:3], v15 offset:17400
    v_mfma_f32_16x16x32_bf16 v[148:151], a[16:19], a[48:51], v[148:151]
    ds_read_b64_tr_b16 a[4:5], v15 offset:16928
    v_mfma_f32_16x16x32_bf16 v[108:111], a[16:19], a[52:55], v[108:111]
    ds_read_b64_tr_b16 a[6:7], v15 offset:17408
    s_waitcnt lgkmcnt(4)
    v_mfma_f32_16x16x32_bf16 v[68:71], a[16:19], a[56:59], v[68:71]
    ds_read_b64_tr_b16 a[8:9], v15 offset:17056
    v_mfma_f32_16x16x32_bf16 v[152:155], a[20:23], a[48:51], v[152:155]
    ds_read_b64_tr_b16 a[10:11], v15 offset:17536
    v_mfma_f32_16x16x32_bf16 v[112:115], a[20:23], a[52:55], v[112:115]
    buffer_load_dwordx4 v2, s[12:15], s54 offen offset:0  lds
    v_mfma_f32_16x16x32_bf16 v[72:75], a[20:23], a[56:59], v[72:75]
    s_waitcnt lgkmcnt(4)
    v_mfma_f32_16x16x32_bf16 v[156:159], a[0:3], a[48:51], v[156:159]
    ds_read_b64_tr_b16 a[12:13], v15 offset:17064
    v_mfma_f32_16x16x32_bf16 v[116:119], a[0:3], a[52:55], v[116:119]
    ds_read_b64_tr_b16 a[14:15], v15 offset:17544
    s_waitcnt lgkmcnt(4)
    v_mfma_f32_16x16x32_bf16 v[76:79], a[0:3], a[56:59], v[76:79]
    ds_read_b128 a[60:63], v14 offset:704
    v_mfma_f32_16x16x32_bf16 v[160:163], a[4:7], a[48:51], v[160:163]
    ds_read_b64_tr_b16 a[16:17], v15 offset:17072
    v_mfma_f32_16x16x32_bf16 v[120:123], a[4:7], a[52:55], v[120:123]
    ds_read_b64_tr_b16 a[18:19], v15 offset:17552
    s_waitcnt lgkmcnt(5)
    v_mfma_f32_16x16x32_bf16 v[80:83], a[4:7], a[56:59], v[80:83]
    v_mfma_f32_16x16x32_bf16 v[164:167], a[8:11], a[48:51], v[164:167]
    buffer_load_dwordx4 v3, s[12:15], s54 offen offset:1056  lds
    v_mfma_f32_16x16x32_bf16 v[124:127], a[8:11], a[52:55], v[124:127]
    ds_read_b64_tr_b16 a[20:21], v15 offset:17080
    s_waitcnt lgkmcnt(4)
    v_mfma_f32_16x16x32_bf16 v[84:87], a[8:11], a[56:59], v[84:87]
    ds_read_b64_tr_b16 a[22:23], v15 offset:17560
    v_mfma_f32_16x16x32_bf16 v[168:171], a[12:15], a[48:51], v[168:171]
    ds_read_b64_tr_b16 a[0:1], v15 offset:17088
    v_mfma_f32_16x16x32_bf16 v[128:131], a[12:15], a[52:55], v[128:131]
    ds_read_b64_tr_b16 a[2:3], v15 offset:17568
    s_waitcnt lgkmcnt(4)
    v_mfma_f32_16x16x32_bf16 v[88:91], a[12:15], a[56:59], v[88:91]
    ds_read_b64_tr_b16 a[4:5], v17 offset:17216
    v_mfma_f32_16x16x32_bf16 v[172:175], a[16:19], a[48:51], v[172:175]
    v_mfma_f32_16x16x32_bf16 v[132:135], a[16:19], a[52:55], v[132:135]
    ds_read_b64_tr_b16 a[6:7], v17 offset:17696
    s_waitcnt lgkmcnt(4)
    v_mfma_f32_16x16x32_bf16 v[92:95], a[16:19], a[56:59], v[92:95]
    buffer_load_dwordx4 v4, s[12:15], s54 offen offset:2112  lds
    v_mfma_f32_16x16x32_bf16 v[176:179], a[20:23], a[48:51], v[176:179]
    ds_read_b64_tr_b16 a[8:9], v17 offset:17256
    v_mfma_f32_16x16x32_bf16 v[136:139], a[20:23], a[52:55], v[136:139]
    ds_read_b64_tr_b16 a[10:11], v17 offset:17736
    s_waitcnt lgkmcnt(4)
    v_mfma_f32_16x16x32_bf16 v[96:99], a[20:23], a[56:59], v[96:99]
    ds_read_b64_tr_b16 a[12:13], v17 offset:17296
    v_mfma_f32_16x16x32_bf16 v[180:183], a[0:3], a[48:51], v[180:183]
    ds_read_b64_tr_b16 a[14:15], v17 offset:17776
    v_mfma_f32_16x16x32_bf16 v[140:143], a[0:3], a[52:55], v[140:143]
    s_waitcnt lgkmcnt(4)
    v_mfma_f32_16x16x32_bf16 v[100:103], a[0:3], a[56:59], v[100:103]
    ds_read_b64_tr_b16 a[16:17], v17 offset:17336
    v_mfma_f32_16x16x32_bf16 v[184:187], a[48:51], a[4:7], v[184:187]
    ds_read_b64_tr_b16 a[18:19], v17 offset:17816
    v_mfma_f32_16x16x32_bf16 v[188:191], a[52:55], a[4:7], v[188:191]
    buffer_load_dwordx4 v5, s[12:15], s54 offen offset:3168  lds
    v_mfma_f32_16x16x32_bf16 v[192:195], a[56:59], a[4:7], v[192:195]
    ds_read_b64_tr_b16 a[20:21], v15 offset:17248
    s_waitcnt lgkmcnt(5)
    v_mfma_f32_16x16x32_bf16 v[196:199], a[48:51], a[8:11], v[196:199]
    ds_read_b64_tr_b16 a[22:23], v15 offset:17728
    v_mfma_f32_16x16x32_bf16 v[200:203], a[52:55], a[8:11], v[200:203]
    s_waitcnt lgkmcnt(4)
    v_mfma_f32_16x16x32_bf16 v[204:207], a[56:59], a[8:11], v[204:207]
    s_waitcnt vmcnt(14)
    s_barrier
    v_mfma_f32_16x16x32_bf16 v[208:211], a[48:51], a[12:15], v[208:211]
    ds_read_b128 a[32:35], v12 offset:0
    s_add_u32 m0, s52, 0
    v_mfma_f32_16x16x32_bf16 v[212:215], a[52:55], a[12:15], v[212:215]
    ds_read_b64_tr_b16 a[0:1], v15 offset:33792
    s_add_u32 s54, s54, 122880
    v_mfma_f32_16x16x32_bf16 v[216:219], a[56:59], a[12:15], v[216:219]
    ds_read_b128 a[36:39], v12 offset:2048
    s_waitcnt lgkmcnt(5)
    v_mfma_f32_16x16x32_bf16 v[244:247], a[60:63], a[48:51], v[244:247]
    buffer_load_dwordx4 v2, s[12:15], s54 offen offset:0  lds
    v_mfma_f32_16x16x32_bf16 v[220:223], a[48:51], a[16:19], v[220:223]
    ds_read_b64_tr_b16 a[2:3], v15 offset:34272
    v_mfma_f32_16x16x32_bf16 v[224:227], a[52:55], a[16:19], v[224:227]
    ds_read_b128 a[40:43], v12 offset:4096
    v_mfma_f32_16x16x32_bf16 v[228:231], a[56:59], a[16:19], v[228:231]
    ds_read_b64_tr_b16 a[4:5], v15 offset:33800
    s_waitcnt lgkmcnt(6)
    v_mfma_f32_16x16x32_bf16 v[248:251], a[60:63], a[52:55], v[248:251]
    ds_read_b64_tr_b16 a[6:7], v15 offset:34280
    v_mfma_f32_16x16x32_bf16 v[232:235], a[48:51], a[20:23], v[232:235]
    v_mfma_f32_16x16x32_bf16 v[236:239], a[52:55], a[20:23], v[236:239]
    buffer_load_dwordx4 v3, s[12:15], s54 offen offset:1056  lds
    v_mfma_f32_16x16x32_bf16 v[240:243], a[56:59], a[20:23], v[240:243]
    ds_read_b64_tr_b16 a[8:9], v15 offset:33808
    s_waitcnt lgkmcnt(3)
    v_mfma_f32_16x16x32_bf16 v[252:255], a[60:63], a[56:59], v[252:255]
    ds_read_b64_tr_b16 a[10:11], v15 offset:34288
    v_mfma_f32_16x16x32_bf16 v[144:147], a[0:3], a[32:35], v[144:147]
    ds_read_b64_tr_b16 a[12:13], v15 offset:33816
    v_mfma_f32_16x16x32_bf16 v[104:107], a[0:3], a[36:39], v[104:107]
    ds_read_b64_tr_b16 a[14:15], v15 offset:34296
    s_waitcnt lgkmcnt(4)
    v_mfma_f32_16x16x32_bf16 v[64:67], a[0:3], a[40:43], v[64:67]
    buffer_load_dwordx4 v4, s[12:15], s54 offen offset:2112  lds
    v_mfma_f32_16x16x32_bf16 v[148:151], a[4:7], a[32:35], v[148:151]
    ds_read_b64_tr_b16 a[16:17], v15 offset:33824
    v_mfma_f32_16x16x32_bf16 v[108:111], a[4:7], a[36:39], v[108:111]
    ds_read_b64_tr_b16 a[18:19], v15 offset:34304
    s_waitcnt lgkmcnt(4)
    v_mfma_f32_16x16x32_bf16 v[68:71], a[4:7], a[40:43], v[68:71]
    ds_read_b64_tr_b16 a[20:21], v15 offset:33952
    v_mfma_f32_16x16x32_bf16 v[152:155], a[8:11], a[32:35], v[152:155]
    v_mfma_f32_16x16x32_bf16 v[112:115], a[8:11], a[36:39], v[112:115]
    ds_read_b64_tr_b16 a[22:23], v15 offset:34432
    s_waitcnt lgkmcnt(4)
    v_mfma_f32_16x16x32_bf16 v[72:75], a[8:11], a[40:43], v[72:75]
    buffer_load_dwordx4 v5, s[12:15], s54 offen offset:3168  lds
    v_mfma_f32_16x16x32_bf16 v[156:159], a[12:15], a[32:35], v[156:159]
    ds_read_b64_tr_b16 a[0:1], v15 offset:33960
    s_add_u32 m0, s53, 49152
    v_mfma_f32_16x16x32_bf16 v[116:119], a[12:15], a[36:39], v[116:119]
    ds_read_b64_tr_b16 a[2:3], v15 offset:34440
    s_add_u32 s55, s55, 128
    v_mfma_f32_16x16x32_bf16 v[76:79], a[12:15], a[40:43], v[76:79]
    ds_read_b128 a[44:47], v14 offset:768
    s_waitcnt lgkmcnt(5)
    v_mfma_f32_16x16x32_bf16 v[160:163], a[16:19], a[32:35], v[160:163]
    ds_read_b64_tr_b16 a[4:5], v15 offset:33968
    v_mfma_f32_16x16x32_bf16 v[120:123], a[16:19], a[36:39], v[120:123]
    ds_read_b64_tr_b16 a[6:7], v15 offset:34448
    s_waitcnt lgkmcnt(5)
    v_mfma_f32_16x16x32_bf16 v[80:83], a[16:19], a[40:43], v[80:83]
    buffer_load_dwordx4 v6, s[8:11], s55 offen offset:0  lds
    v_mfma_f32_16x16x32_bf16 v[164:167], a[20:23], a[32:35], v[164:167]
    ds_read_b64_tr_b16 a[8:9], v15 offset:33976
    v_mfma_f32_16x16x32_bf16 v[124:127], a[20:23], a[36:39], v[124:127]
    s_waitcnt lgkmcnt(4)
    v_mfma_f32_16x16x32_bf16 v[84:87], a[20:23], a[40:43], v[84:87]
    ds_read_b64_tr_b16 a[10:11], v15 offset:34456
    v_mfma_f32_16x16x32_bf16 v[168:171], a[0:3], a[32:35], v[168:171]
    ds_read_b64_tr_b16 a[12:13], v15 offset:33984
    v_mfma_f32_16x16x32_bf16 v[128:131], a[0:3], a[36:39], v[128:131]
    ds_read_b64_tr_b16 a[14:15], v15 offset:34464
    s_waitcnt lgkmcnt(4)
    v_mfma_f32_16x16x32_bf16 v[88:91], a[0:3], a[40:43], v[88:91]
    buffer_load_dwordx4 v7, s[8:11], s55 offen offset:1024  lds
    v_mfma_f32_16x16x32_bf16 v[172:175], a[4:7], a[32:35], v[172:175]
    ds_read_b64_tr_b16 a[16:17], v17 offset:34112
    v_mfma_f32_16x16x32_bf16 v[132:135], a[4:7], a[36:39], v[132:135]
    ds_read_b64_tr_b16 a[18:19], v17 offset:34592
    s_waitcnt lgkmcnt(4)
    v_mfma_f32_16x16x32_bf16 v[92:95], a[4:7], a[40:43], v[92:95]
    ds_read_b64_tr_b16 a[20:21], v17 offset:34152
    v_mfma_f32_16x16x32_bf16 v[176:179], a[8:11], a[32:35], v[176:179]
    ds_read_b64_tr_b16 a[22:23], v17 offset:34632
    v_mfma_f32_16x16x32_bf16 v[136:139], a[8:11], a[36:39], v[136:139]
    s_waitcnt lgkmcnt(4)
    v_mfma_f32_16x16x32_bf16 v[96:99], a[8:11], a[40:43], v[96:99]
    buffer_load_dwordx4 v8, s[8:11], s55 offen offset:2048  lds
    v_mfma_f32_16x16x32_bf16 v[180:183], a[12:15], a[32:35], v[180:183]
    ds_read_b64_tr_b16 a[0:1], v17 offset:34192
    v_mfma_f32_16x16x32_bf16 v[140:143], a[12:15], a[36:39], v[140:143]
    ds_read_b64_tr_b16 a[2:3], v17 offset:34672
    s_waitcnt lgkmcnt(4)
    v_mfma_f32_16x16x32_bf16 v[100:103], a[12:15], a[40:43], v[100:103]
    ds_read_b64_tr_b16 a[4:5], v17 offset:34232
    v_mfma_f32_16x16x32_bf16 v[184:187], a[32:35], a[16:19], v[184:187]
    ds_read_b64_tr_b16 a[6:7], v17 offset:34712
    v_mfma_f32_16x16x32_bf16 v[188:191], a[36:39], a[16:19], v[188:191]
    ds_read_b64_tr_b16 a[8:9], v15 offset:34144
    s_waitcnt lgkmcnt(5)
    v_mfma_f32_16x16x32_bf16 v[192:195], a[40:43], a[16:19], v[192:195]
    buffer_load_dwordx4 v9, s[8:11], s55 offen offset:3072  lds
    v_mfma_f32_16x16x32_bf16 v[196:199], a[32:35], a[20:23], v[196:199]
    ds_read_b64_tr_b16 a[10:11], v15 offset:34624
    v_mfma_f32_16x16x32_bf16 v[200:203], a[36:39], a[20:23], v[200:203]
    s_waitcnt lgkmcnt(4)
    v_mfma_f32_16x16x32_bf16 v[204:207], a[40:43], a[20:23], v[204:207]
    s_waitcnt vmcnt(18)
    s_barrier
    v_mfma_f32_16x16x32_bf16 v[208:211], a[32:35], a[0:3], v[208:211]
    ds_read_b128 a[48:51], v13 offset:0
    s_add_u32 m0, s53, 53248
    v_mfma_f32_16x16x32_bf16 v[212:215], a[36:39], a[0:3], v[212:215]
    ds_read_b64_tr_b16 a[12:13], v16 offset:0
    v_mfma_f32_16x16x32_bf16 v[216:219], a[40:43], a[0:3], v[216:219]
    ds_read_b128 a[52:55], v13 offset:2048
    s_waitcnt lgkmcnt(5)
    v_mfma_f32_16x16x32_bf16 v[244:247], a[44:47], a[32:35], v[244:247]
    ds_read_b64_tr_b16 a[14:15], v16 offset:480
    v_mfma_f32_16x16x32_bf16 v[220:223], a[32:35], a[4:7], v[220:223]
    buffer_load_dwordx4 v10, s[8:11], s55 offen offset:0  lds
    v_mfma_f32_16x16x32_bf16 v[224:227], a[36:39], a[4:7], v[224:227]
    ds_read_b128 a[56:59], v13 offset:4096
    v_mfma_f32_16x16x32_bf16 v[228:231], a[40:43], a[4:7], v[228:231]
    s_waitcnt lgkmcnt(5)
    v_mfma_f32_16x16x32_bf16 v[248:251], a[44:47], a[36:39], v[248:251]
    ds_read_b64_tr_b16 a[16:17], v16 offset:8
    v_mfma_f32_16x16x32_bf16 v[232:235], a[32:35], a[8:11], v[232:235]
    ds_read_b64_tr_b16 a[18:19], v16 offset:488
    v_mfma_f32_16x16x32_bf16 v[236:239], a[36:39], a[8:11], v[236:239]
    ds_read_b64_tr_b16 a[20:21], v16 offset:16
    v_mfma_f32_16x16x32_bf16 v[240:243], a[40:43], a[8:11], v[240:243]
    ds_read_b64_tr_b16 a[22:23], v16 offset:496
    s_waitcnt lgkmcnt(4)
    v_mfma_f32_16x16x32_bf16 v[252:255], a[44:47], a[40:43], v[252:255]
    ds_read_b64_tr_b16 a[0:1], v16 offset:24
    v_mfma_f32_16x16x32_bf16 v[144:147], a[12:15], a[48:51], v[144:147]
    buffer_load_dwordx4 v11, s[8:11], s55 offen offset:1024  lds
    v_mfma_f32_16x16x32_bf16 v[104:107], a[12:15], a[52:55], v[104:107]
    s_add_u32 m0, s52, 16896
    s_add_u32 s54, s54, 122880
    s_waitcnt lgkmcnt(3)
    v_mfma_f32_16x16x32_bf16 v[64:67], a[12:15], a[56:59], v[64:67]
    ds_read_b64_tr_b16 a[2:3], v16 offset:504
    v_mfma_f32_16x16x32_bf16 v[148:151], a[16:19], a[48:51], v[148:151]
    ds_read_b64_tr_b16 a[4:5], v16 offset:32
    v_mfma_f32_16x16x32_bf16 v[108:111], a[16:19], a[52:55], v[108:111]
    ds_read_b64_tr_b16 a[6:7], v16 offset:512
    s_waitcnt lgkmcnt(4)
    v_mfma_f32_16x16x32_bf16 v[68:71], a[16:19], a[56:59], v[68:71]
    ds_read_b64_tr_b16 a[8:9], v16 offset:160
    v_mfma_f32_16x16x32_bf16 v[152:155], a[20:23], a[48:51], v[152:155]
    ds_read_b64_tr_b16 a[10:11], v16 offset:640
    v_mfma_f32_16x16x32_bf16 v[112:115], a[20:23], a[52:55], v[112:115]
    buffer_load_dwordx4 v2, s[12:15], s54 offen offset:0  lds
    v_mfma_f32_16x16x32_bf16 v[72:75], a[20:23], a[56:59], v[72:75]
    s_waitcnt lgkmcnt(4)
    v_mfma_f32_16x16x32_bf16 v[156:159], a[0:3], a[48:51], v[156:159]
    ds_read_b64_tr_b16 a[12:13], v16 offset:168
    v_mfma_f32_16x16x32_bf16 v[116:119], a[0:3], a[52:55], v[116:119]
    ds_read_b64_tr_b16 a[14:15], v16 offset:648
    s_waitcnt lgkmcnt(4)
    v_mfma_f32_16x16x32_bf16 v[76:79], a[0:3], a[56:59], v[76:79]
    ds_read_b128 a[60:63], v14 offset:832
    v_mfma_f32_16x16x32_bf16 v[160:163], a[4:7], a[48:51], v[160:163]
    ds_read_b64_tr_b16 a[16:17], v16 offset:176
    v_mfma_f32_16x16x32_bf16 v[120:123], a[4:7], a[52:55], v[120:123]
    ds_read_b64_tr_b16 a[18:19], v16 offset:656
    s_waitcnt lgkmcnt(5)
    v_mfma_f32_16x16x32_bf16 v[80:83], a[4:7], a[56:59], v[80:83]
    v_mfma_f32_16x16x32_bf16 v[164:167], a[8:11], a[48:51], v[164:167]
    buffer_load_dwordx4 v3, s[12:15], s54 offen offset:1056  lds
    v_mfma_f32_16x16x32_bf16 v[124:127], a[8:11], a[52:55], v[124:127]
    ds_read_b64_tr_b16 a[20:21], v16 offset:184
    s_waitcnt lgkmcnt(4)
    v_mfma_f32_16x16x32_bf16 v[84:87], a[8:11], a[56:59], v[84:87]
    ds_read_b64_tr_b16 a[22:23], v16 offset:664
    v_mfma_f32_16x16x32_bf16 v[168:171], a[12:15], a[48:51], v[168:171]
    ds_read_b64_tr_b16 a[0:1], v16 offset:192
    v_mfma_f32_16x16x32_bf16 v[128:131], a[12:15], a[52:55], v[128:131]
    ds_read_b64_tr_b16 a[2:3], v16 offset:672
    s_waitcnt lgkmcnt(4)
    v_mfma_f32_16x16x32_bf16 v[88:91], a[12:15], a[56:59], v[88:91]
    ds_read_b64_tr_b16 a[4:5], v18 offset:320
    v_mfma_f32_16x16x32_bf16 v[172:175], a[16:19], a[48:51], v[172:175]
    v_mfma_f32_16x16x32_bf16 v[132:135], a[16:19], a[52:55], v[132:135]
    ds_read_b64_tr_b16 a[6:7], v18 offset:800
    s_waitcnt lgkmcnt(4)
    v_mfma_f32_16x16x32_bf16 v[92:95], a[16:19], a[56:59], v[92:95]
    buffer_load_dwordx4 v4, s[12:15], s54 offen offset:2112  lds
    v_mfma_f32_16x16x32_bf16 v[176:179], a[20:23], a[48:51], v[176:179]
    ds_read_b64_tr_b16 a[8:9], v18 offset:360
    v_mfma_f32_16x16x32_bf16 v[136:139], a[20:23], a[52:55], v[136:139]
    ds_read_b64_tr_b16 a[10:11], v18 offset:840
    s_waitcnt lgkmcnt(4)
    v_mfma_f32_16x16x32_bf16 v[96:99], a[20:23], a[56:59], v[96:99]
    ds_read_b64_tr_b16 a[12:13], v18 offset:400
    v_mfma_f32_16x16x32_bf16 v[180:183], a[0:3], a[48:51], v[180:183]
    ds_read_b64_tr_b16 a[14:15], v18 offset:880
    v_mfma_f32_16x16x32_bf16 v[140:143], a[0:3], a[52:55], v[140:143]
    s_waitcnt lgkmcnt(4)
    v_mfma_f32_16x16x32_bf16 v[100:103], a[0:3], a[56:59], v[100:103]
    ds_read_b64_tr_b16 a[16:17], v18 offset:440
    v_mfma_f32_16x16x32_bf16 v[184:187], a[48:51], a[4:7], v[184:187]
    ds_read_b64_tr_b16 a[18:19], v18 offset:920
    v_mfma_f32_16x16x32_bf16 v[188:191], a[52:55], a[4:7], v[188:191]
    buffer_load_dwordx4 v5, s[12:15], s54 offen offset:3168  lds
    v_mfma_f32_16x16x32_bf16 v[192:195], a[56:59], a[4:7], v[192:195]
    ds_read_b64_tr_b16 a[20:21], v16 offset:352
    s_waitcnt lgkmcnt(5)
    v_mfma_f32_16x16x32_bf16 v[196:199], a[48:51], a[8:11], v[196:199]
    ds_read_b64_tr_b16 a[22:23], v16 offset:832
    v_mfma_f32_16x16x32_bf16 v[200:203], a[52:55], a[8:11], v[200:203]
    s_waitcnt lgkmcnt(4)
    v_mfma_f32_16x16x32_bf16 v[204:207], a[56:59], a[8:11], v[204:207]
    s_waitcnt vmcnt(14)
    s_barrier
    v_mfma_f32_16x16x32_bf16 v[208:211], a[48:51], a[12:15], v[208:211]
    ds_read_b128 a[32:35], v12 offset:24576
    s_add_u32 m0, s52, 33792
    v_mfma_f32_16x16x32_bf16 v[212:215], a[52:55], a[12:15], v[212:215]
    ds_read_b64_tr_b16 a[0:1], v16 offset:16896
    s_add_u32 s54, s54, 122880
    v_mfma_f32_16x16x32_bf16 v[216:219], a[56:59], a[12:15], v[216:219]
    ds_read_b128 a[36:39], v12 offset:26624
    s_waitcnt lgkmcnt(5)
    v_mfma_f32_16x16x32_bf16 v[244:247], a[60:63], a[48:51], v[244:247]
    buffer_load_dwordx4 v2, s[12:15], s54 offen offset:0  lds
    v_mfma_f32_16x16x32_bf16 v[220:223], a[48:51], a[16:19], v[220:223]
    ds_read_b64_tr_b16 a[2:3], v16 offset:17376
    v_mfma_f32_16x16x32_bf16 v[224:227], a[52:55], a[16:19], v[224:227]
    ds_read_b128 a[40:43], v12 offset:28672
    v_mfma_f32_16x16x32_bf16 v[228:231], a[56:59], a[16:19], v[228:231]
    ds_read_b64_tr_b16 a[4:5], v16 offset:16904
    s_waitcnt lgkmcnt(6)
    v_mfma_f32_16x16x32_bf16 v[248:251], a[60:63], a[52:55], v[248:251]
    ds_read_b64_tr_b16 a[6:7], v16 offset:17384
    v_mfma_f32_16x16x32_bf16 v[232:235], a[48:51], a[20:23], v[232:235]
    v_mfma_f32_16x16x32_bf16 v[236:239], a[52:55], a[20:23], v[236:239]
    buffer_load_dwordx4 v3, s[12:15], s54 offen offset:1056  lds
    v_mfma_f32_16x16x32_bf16 v[240:243], a[56:59], a[20:23], v[240:243]
    ds_read_b64_tr_b16 a[8:9], v16 offset:16912
    s_waitcnt lgkmcnt(3)
    v_mfma_f32_16x16x32_bf16 v[252:255], a[60:63], a[56:59], v[252:255]
    ds_read_b64_tr_b16 a[10:11], v16 offset:17392
    v_mfma_f32_16x16x32_bf16 v[144:147], a[0:3], a[32:35], v[144:147]
    ds_read_b64_tr_b16 a[12:13], v16 offset:16920
    v_mfma_f32_16x16x32_bf16 v[104:107], a[0:3], a[36:39], v[104:107]
    ds_read_b64_tr_b16 a[14:15], v16 offset:17400
    s_waitcnt lgkmcnt(4)
    v_mfma_f32_16x16x32_bf16 v[64:67], a[0:3], a[40:43], v[64:67]
    buffer_load_dwordx4 v4, s[12:15], s54 offen offset:2112  lds
    v_mfma_f32_16x16x32_bf16 v[148:151], a[4:7], a[32:35], v[148:151]
    ds_read_b64_tr_b16 a[16:17], v16 offset:16928
    v_mfma_f32_16x16x32_bf16 v[108:111], a[4:7], a[36:39], v[108:111]
    ds_read_b64_tr_b16 a[18:19], v16 offset:17408
    s_waitcnt lgkmcnt(4)
    v_mfma_f32_16x16x32_bf16 v[68:71], a[4:7], a[40:43], v[68:71]
    ds_read_b64_tr_b16 a[20:21], v16 offset:17056
    v_mfma_f32_16x16x32_bf16 v[152:155], a[8:11], a[32:35], v[152:155]
    v_mfma_f32_16x16x32_bf16 v[112:115], a[8:11], a[36:39], v[112:115]
    ds_read_b64_tr_b16 a[22:23], v16 offset:17536
    s_waitcnt lgkmcnt(4)
    v_mfma_f32_16x16x32_bf16 v[72:75], a[8:11], a[40:43], v[72:75]
    buffer_load_dwordx4 v5, s[12:15], s54 offen offset:3168  lds
    v_mfma_f32_16x16x32_bf16 v[156:159], a[12:15], a[32:35], v[156:159]
    ds_read_b64_tr_b16 a[0:1], v16 offset:17064
    s_add_u32 m0, s53, 0
    v_mfma_f32_16x16x32_bf16 v[116:119], a[12:15], a[36:39], v[116:119]
    ds_read_b64_tr_b16 a[2:3], v16 offset:17544
    s_add_u32 s55, s55, 128
    v_mfma_f32_16x16x32_bf16 v[76:79], a[12:15], a[40:43], v[76:79]
    ds_read_b128 a[44:47], v14 offset:896
    s_waitcnt lgkmcnt(5)
    v_mfma_f32_16x16x32_bf16 v[160:163], a[16:19], a[32:35], v[160:163]
    ds_read_b64_tr_b16 a[4:5], v16 offset:17072
    v_mfma_f32_16x16x32_bf16 v[120:123], a[16:19], a[36:39], v[120:123]
    ds_read_b64_tr_b16 a[6:7], v16 offset:17552
    s_waitcnt lgkmcnt(5)
    v_mfma_f32_16x16x32_bf16 v[80:83], a[16:19], a[40:43], v[80:83]
    buffer_load_dwordx4 v6, s[8:11], s55 offen offset:0  lds
    v_mfma_f32_16x16x32_bf16 v[164:167], a[20:23], a[32:35], v[164:167]
    ds_read_b64_tr_b16 a[8:9], v16 offset:17080
    v_mfma_f32_16x16x32_bf16 v[124:127], a[20:23], a[36:39], v[124:127]
    s_waitcnt lgkmcnt(4)
    v_mfma_f32_16x16x32_bf16 v[84:87], a[20:23], a[40:43], v[84:87]
    ds_read_b64_tr_b16 a[10:11], v16 offset:17560
    v_mfma_f32_16x16x32_bf16 v[168:171], a[0:3], a[32:35], v[168:171]
    ds_read_b64_tr_b16 a[12:13], v16 offset:17088
    v_mfma_f32_16x16x32_bf16 v[128:131], a[0:3], a[36:39], v[128:131]
    ds_read_b64_tr_b16 a[14:15], v16 offset:17568
    s_waitcnt lgkmcnt(4)
    v_mfma_f32_16x16x32_bf16 v[88:91], a[0:3], a[40:43], v[88:91]
    buffer_load_dwordx4 v7, s[8:11], s55 offen offset:1024  lds
    v_mfma_f32_16x16x32_bf16 v[172:175], a[4:7], a[32:35], v[172:175]
    ds_read_b64_tr_b16 a[16:17], v18 offset:17216
    v_mfma_f32_16x16x32_bf16 v[132:135], a[4:7], a[36:39], v[132:135]
    ds_read_b64_tr_b16 a[18:19], v18 offset:17696
    s_waitcnt lgkmcnt(4)
    v_mfma_f32_16x16x32_bf16 v[92:95], a[4:7], a[40:43], v[92:95]
    ds_read_b64_tr_b16 a[20:21], v18 offset:17256
    v_mfma_f32_16x16x32_bf16 v[176:179], a[8:11], a[32:35], v[176:179]
    ds_read_b64_tr_b16 a[22:23], v18 offset:17736
    v_mfma_f32_16x16x32_bf16 v[136:139], a[8:11], a[36:39], v[136:139]
    s_waitcnt lgkmcnt(4)
    v_mfma_f32_16x16x32_bf16 v[96:99], a[8:11], a[40:43], v[96:99]
    buffer_load_dwordx4 v8, s[8:11], s55 offen offset:2048  lds
    v_mfma_f32_16x16x32_bf16 v[180:183], a[12:15], a[32:35], v[180:183]
    ds_read_b64_tr_b16 a[0:1], v18 offset:17296
    v_mfma_f32_16x16x32_bf16 v[140:143], a[12:15], a[36:39], v[140:143]
    ds_read_b64_tr_b16 a[2:3], v18 offset:17776
    s_waitcnt lgkmcnt(4)
    v_mfma_f32_16x16x32_bf16 v[100:103], a[12:15], a[40:43], v[100:103]
    ds_read_b64_tr_b16 a[4:5], v18 offset:17336
    v_mfma_f32_16x16x32_bf16 v[184:187], a[32:35], a[16:19], v[184:187]
    ds_read_b64_tr_b16 a[6:7], v18 offset:17816
    v_mfma_f32_16x16x32_bf16 v[188:191], a[36:39], a[16:19], v[188:191]
    ds_read_b64_tr_b16 a[8:9], v16 offset:17248
    s_waitcnt lgkmcnt(5)
    v_mfma_f32_16x16x32_bf16 v[192:195], a[40:43], a[16:19], v[192:195]
    buffer_load_dwordx4 v9, s[8:11], s55 offen offset:3072  lds
    v_mfma_f32_16x16x32_bf16 v[196:199], a[32:35], a[20:23], v[196:199]
    ds_read_b64_tr_b16 a[10:11], v16 offset:17728
    v_mfma_f32_16x16x32_bf16 v[200:203], a[36:39], a[20:23], v[200:203]
    s_waitcnt lgkmcnt(4)
    v_mfma_f32_16x16x32_bf16 v[204:207], a[40:43], a[20:23], v[204:207]
    s_waitcnt vmcnt(18)
    s_barrier
    v_mfma_f32_16x16x32_bf16 v[208:211], a[32:35], a[0:3], v[208:211]
    ds_read_b128 a[48:51], v13 offset:24576
    s_add_u32 m0, s53, 4096
    v_mfma_f32_16x16x32_bf16 v[212:215], a[36:39], a[0:3], v[212:215]
    ds_read_b64_tr_b16 a[12:13], v15 offset:0
    v_mfma_f32_16x16x32_bf16 v[216:219], a[40:43], a[0:3], v[216:219]
    ds_read_b128 a[52:55], v13 offset:26624
    s_waitcnt lgkmcnt(5)
    v_mfma_f32_16x16x32_bf16 v[244:247], a[44:47], a[32:35], v[244:247]
    ds_read_b64_tr_b16 a[14:15], v15 offset:480
    v_mfma_f32_16x16x32_bf16 v[220:223], a[32:35], a[4:7], v[220:223]
    buffer_load_dwordx4 v10, s[8:11], s55 offen offset:0  lds
    v_mfma_f32_16x16x32_bf16 v[224:227], a[36:39], a[4:7], v[224:227]
    ds_read_b128 a[56:59], v13 offset:28672
    v_mfma_f32_16x16x32_bf16 v[228:231], a[40:43], a[4:7], v[228:231]
    s_waitcnt lgkmcnt(5)
    v_mfma_f32_16x16x32_bf16 v[248:251], a[44:47], a[36:39], v[248:251]
    ds_read_b64_tr_b16 a[16:17], v15 offset:8
    v_mfma_f32_16x16x32_bf16 v[232:235], a[32:35], a[8:11], v[232:235]
    ds_read_b64_tr_b16 a[18:19], v15 offset:488
    v_mfma_f32_16x16x32_bf16 v[236:239], a[36:39], a[8:11], v[236:239]
    ds_read_b64_tr_b16 a[20:21], v15 offset:16
    v_mfma_f32_16x16x32_bf16 v[240:243], a[40:43], a[8:11], v[240:243]
    ds_read_b64_tr_b16 a[22:23], v15 offset:496
    s_waitcnt lgkmcnt(4)
    v_mfma_f32_16x16x32_bf16 v[252:255], a[44:47], a[40:43], v[252:255]
    ds_read_b64_tr_b16 a[0:1], v15 offset:24
    v_mfma_f32_16x16x32_bf16 v[144:147], a[12:15], a[48:51], v[144:147]
    buffer_load_dwordx4 v11, s[8:11], s55 offen offset:1024  lds
    v_mfma_f32_16x16x32_bf16 v[104:107], a[12:15], a[52:55], v[104:107]
    s_add_u32 m0, s52, 50688
    s_add_u32 s54, s54, 122880
    s_waitcnt lgkmcnt(3)
    v_mfma_f32_16x16x32_bf16 v[64:67], a[12:15], a[56:59], v[64:67]
    ds_read_b64_tr_b16 a[2:3], v15 offset:504
    v_mfma_f32_16x16x32_bf16 v[148:151], a[16:19], a[48:51], v[148:151]
    ds_read_b64_tr_b16 a[4:5], v15 offset:32
    v_mfma_f32_16x16x32_bf16 v[108:111], a[16:19], a[52:55], v[108:111]
    ds_read_b64_tr_b16 a[6:7], v15 offset:512
    s_waitcnt lgkmcnt(4)
    v_mfma_f32_16x16x32_bf16 v[68:71], a[16:19], a[56:59], v[68:71]
    ds_read_b64_tr_b16 a[8:9], v15 offset:160
    v_mfma_f32_16x16x32_bf16 v[152:155], a[20:23], a[48:51], v[152:155]
    ds_read_b64_tr_b16 a[10:11], v15 offset:640
    v_mfma_f32_16x16x32_bf16 v[112:115], a[20:23], a[52:55], v[112:115]
    buffer_load_dwordx4 v2, s[12:15], s54 offen offset:0  lds
    v_mfma_f32_16x16x32_bf16 v[72:75], a[20:23], a[56:59], v[72:75]
    s_waitcnt lgkmcnt(4)
    v_mfma_f32_16x16x32_bf16 v[156:159], a[0:3], a[48:51], v[156:159]
    ds_read_b64_tr_b16 a[12:13], v15 offset:168
    v_mfma_f32_16x16x32_bf16 v[116:119], a[0:3], a[52:55], v[116:119]
    ds_read_b64_tr_b16 a[14:15], v15 offset:648
    s_waitcnt lgkmcnt(4)
    v_mfma_f32_16x16x32_bf16 v[76:79], a[0:3], a[56:59], v[76:79]
    ds_read_b128 a[60:63], v14 offset:960
    v_mfma_f32_16x16x32_bf16 v[160:163], a[4:7], a[48:51], v[160:163]
    ds_read_b64_tr_b16 a[16:17], v15 offset:176
    v_mfma_f32_16x16x32_bf16 v[120:123], a[4:7], a[52:55], v[120:123]
    ds_read_b64_tr_b16 a[18:19], v15 offset:656
    s_waitcnt lgkmcnt(5)
    v_mfma_f32_16x16x32_bf16 v[80:83], a[4:7], a[56:59], v[80:83]
    v_mfma_f32_16x16x32_bf16 v[164:167], a[8:11], a[48:51], v[164:167]
    buffer_load_dwordx4 v3, s[12:15], s54 offen offset:1056  lds
    v_mfma_f32_16x16x32_bf16 v[124:127], a[8:11], a[52:55], v[124:127]
    ds_read_b64_tr_b16 a[20:21], v15 offset:184
    s_waitcnt lgkmcnt(4)
    v_mfma_f32_16x16x32_bf16 v[84:87], a[8:11], a[56:59], v[84:87]
    ds_read_b64_tr_b16 a[22:23], v15 offset:664
    v_mfma_f32_16x16x32_bf16 v[168:171], a[12:15], a[48:51], v[168:171]
    ds_read_b64_tr_b16 a[0:1], v15 offset:192
    v_mfma_f32_16x16x32_bf16 v[128:131], a[12:15], a[52:55], v[128:131]
    ds_read_b64_tr_b16 a[2:3], v15 offset:672
    s_waitcnt lgkmcnt(4)
    v_mfma_f32_16x16x32_bf16 v[88:91], a[12:15], a[56:59], v[88:91]
    ds_read_b64_tr_b16 a[4:5], v17 offset:320
    v_mfma_f32_16x16x32_bf16 v[172:175], a[16:19], a[48:51], v[172:175]
    v_mfma_f32_16x16x32_bf16 v[132:135], a[16:19], a[52:55], v[132:135]
    ds_read_b64_tr_b16 a[6:7], v17 offset:800
    s_waitcnt lgkmcnt(4)
    v_mfma_f32_16x16x32_bf16 v[92:95], a[16:19], a[56:59], v[92:95]
    buffer_load_dwordx4 v4, s[12:15], s54 offen offset:2112  lds
    v_mfma_f32_16x16x32_bf16 v[176:179], a[20:23], a[48:51], v[176:179]
    ds_read_b64_tr_b16 a[8:9], v17 offset:360
    v_mfma_f32_16x16x32_bf16 v[136:139], a[20:23], a[52:55], v[136:139]
    ds_read_b64_tr_b16 a[10:11], v17 offset:840
    s_waitcnt lgkmcnt(4)
    v_mfma_f32_16x16x32_bf16 v[96:99], a[20:23], a[56:59], v[96:99]
    ds_read_b64_tr_b16 a[12:13], v17 offset:400
    v_mfma_f32_16x16x32_bf16 v[180:183], a[0:3], a[48:51], v[180:183]
    ds_read_b64_tr_b16 a[14:15], v17 offset:880
    v_mfma_f32_16x16x32_bf16 v[140:143], a[0:3], a[52:55], v[140:143]
    s_waitcnt lgkmcnt(4)
    v_mfma_f32_16x16x32_bf16 v[100:103], a[0:3], a[56:59], v[100:103]
    ds_read_b64_tr_b16 a[16:17], v17 offset:440
    v_mfma_f32_16x16x32_bf16 v[184:187], a[48:51], a[4:7], v[184:187]
    ds_read_b64_tr_b16 a[18:19], v17 offset:920
    v_mfma_f32_16x16x32_bf16 v[188:191], a[52:55], a[4:7], v[188:191]
    buffer_load_dwordx4 v5, s[12:15], s54 offen offset:3168  lds
    v_mfma_f32_16x16x32_bf16 v[192:195], a[56:59], a[4:7], v[192:195]
    ds_read_b64_tr_b16 a[20:21], v15 offset:352
    s_waitcnt lgkmcnt(5)
    v_mfma_f32_16x16x32_bf16 v[196:199], a[48:51], a[8:11], v[196:199]
    ds_read_b64_tr_b16 a[22:23], v15 offset:832
    v_mfma_f32_16x16x32_bf16 v[200:203], a[52:55], a[8:11], v[200:203]
    s_waitcnt lgkmcnt(4)
    v_mfma_f32_16x16x32_bf16 v[204:207], a[56:59], a[8:11], v[204:207]
    s_waitcnt vmcnt(14)
    s_barrier
    v_mfma_f32_16x16x32_bf16 v[208:211], a[48:51], a[12:15], v[208:211]
    ds_read_b128 a[32:35], v12 offset:49152
    s_add_u32 m0, s52, 67584
    v_mfma_f32_16x16x32_bf16 v[212:215], a[52:55], a[12:15], v[212:215]
    ds_read_b64_tr_b16 a[0:1], v15 offset:16896
    s_add_u32 s54, s54, 122880
    v_mfma_f32_16x16x32_bf16 v[216:219], a[56:59], a[12:15], v[216:219]
    ds_read_b128 a[36:39], v12 offset:51200
    s_waitcnt lgkmcnt(5)
    v_mfma_f32_16x16x32_bf16 v[244:247], a[60:63], a[48:51], v[244:247]
    ds_read_b64_tr_b16 a[2:3], v15 offset:17376
    v_mfma_f32_16x16x32_bf16 v[220:223], a[48:51], a[16:19], v[220:223]
    v_mfma_f32_16x16x32_bf16 v[224:227], a[52:55], a[16:19], v[224:227]
    ds_read_b128 a[40:43], v12 offset:53248
    v_mfma_f32_16x16x32_bf16 v[228:231], a[56:59], a[16:19], v[228:231]
    buffer_load_dwordx4 v2, s[12:15], s54 offen offset:0  lds
    v_mfma_f32_16x16x32_bf16 v[248:251], a[60:63], a[52:55], v[248:251]
    ds_read_b64_tr_b16 a[4:5], v15 offset:16904
    s_waitcnt lgkmcnt(6)
    v_mfma_f32_16x16x32_bf16 v[232:235], a[48:51], a[20:23], v[232:235]
    ds_read_b64_tr_b16 a[6:7], v15 offset:17384
    v_mfma_f32_16x16x32_bf16 v[236:239], a[52:55], a[20:23], v[236:239]
    ds_read_b64_tr_b16 a[8:9], v15 offset:16912
    v_mfma_f32_16x16x32_bf16 v[240:243], a[56:59], a[20:23], v[240:243]
    s_waitcnt lgkmcnt(3)
    v_mfma_f32_16x16x32_bf16 v[252:255], a[60:63], a[56:59], v[252:255]
    ds_read_b64_tr_b16 a[10:11], v15 offset:17392
    v_mfma_f32_16x16x32_bf16 v[144:147], a[0:3], a[32:35], v[144:147]
    ds_read_b64_tr_b16 a[12:13], v15 offset:16920
    v_mfma_f32_16x16x32_bf16 v[104:107], a[0:3], a[36:39], v[104:107]
    ds_read_b64_tr_b16 a[14:15], v15 offset:17400
    s_waitcnt lgkmcnt(4)
    v_mfma_f32_16x16x32_bf16 v[64:67], a[0:3], a[40:43], v[64:67]
    ds_read_b64_tr_b16 a[16:17], v15 offset:16928
    v_mfma_f32_16x16x32_bf16 v[148:151], a[4:7], a[32:35], v[148:151]
    v_mfma_f32_16x16x32_bf16 v[108:111], a[4:7], a[36:39], v[108:111]
    ds_read_b64_tr_b16 a[18:19], v15 offset:17408
    s_waitcnt lgkmcnt(4)
    v_mfma_f32_16x16x32_bf16 v[68:71], a[4:7], a[40:43], v[68:71]
    ds_read_b64_tr_b16 a[20:21], v15 offset:17056
    v_mfma_f32_16x16x32_bf16 v[152:155], a[8:11], a[32:35], v[152:155]
    buffer_load_dwordx4 v3, s[12:15], s54 offen offset:1056  lds
    v_mfma_f32_16x16x32_bf16 v[112:115], a[8:11], a[36:39], v[112:115]
    ds_read_b64_tr_b16 a[22:23], v15 offset:17536
    s_waitcnt lgkmcnt(4)
    v_mfma_f32_16x16x32_bf16 v[72:75], a[8:11], a[40:43], v[72:75]
    ds_read_b64_tr_b16 a[0:1], v15 offset:17064
    v_mfma_f32_16x16x32_bf16 v[156:159], a[12:15], a[32:35], v[156:159]
    v_mfma_f32_16x16x32_bf16 v[116:119], a[12:15], a[36:39], v[116:119]
    ds_read_b64_tr_b16 a[2:3], v15 offset:17544
    s_waitcnt lgkmcnt(4)
    v_mfma_f32_16x16x32_bf16 v[76:79], a[12:15], a[40:43], v[76:79]
    ds_read_b128 a[44:47], v14 offset:1024
    v_mfma_f32_16x16x32_bf16 v[160:163], a[16:19], a[32:35], v[160:163]
    ds_read_b64_tr_b16 a[4:5], v15 offset:17072
    v_mfma_f32_16x16x32_bf16 v[120:123], a[16:19], a[36:39], v[120:123]
    s_waitcnt lgkmcnt(4)
    v_mfma_f32_16x16x32_bf16 v[80:83], a[16:19], a[40:43], v[80:83]
    ds_read_b64_tr_b16 a[6:7], v15 offset:17552
    v_mfma_f32_16x16x32_bf16 v[164:167], a[20:23], a[32:35], v[164:167]
    ds_read_b64_tr_b16 a[8:9], v15 offset:17080
    v_mfma_f32_16x16x32_bf16 v[124:127], a[20:23], a[36:39], v[124:127]
    ds_read_b64_tr_b16 a[10:11], v15 offset:17560
    s_waitcnt lgkmcnt(5)
    v_mfma_f32_16x16x32_bf16 v[84:87], a[20:23], a[40:43], v[84:87]
    buffer_load_dwordx4 v4, s[12:15], s54 offen offset:2112  lds
    v_mfma_f32_16x16x32_bf16 v[168:171], a[0:3], a[32:35], v[168:171]
    ds_read_b64_tr_b16 a[12:13], v15 offset:17088
    v_mfma_f32_16x16x32_bf16 v[128:131], a[0:3], a[36:39], v[128:131]
    s_waitcnt lgkmcnt(3)
    v_mfma_f32_16x16x32_bf16 v[88:91], a[0:3], a[40:43], v[88:91]
    ds_read_b64_tr_b16 a[14:15], v15 offset:17568
    v_mfma_f32_16x16x32_bf16 v[172:175], a[4:7], a[32:35], v[172:175]
    ds_read_b64_tr_b16 a[16:17], v17 offset:17216
    v_mfma_f32_16x16x32_bf16 v[132:135], a[4:7], a[36:39], v[132:135]
    ds_read_b64_tr_b16 a[18:19], v17 offset:17696
    s_waitcnt lgkmcnt(4)
    v_mfma_f32_16x16x32_bf16 v[92:95], a[4:7], a[40:43], v[92:95]
    ds_read_b64_tr_b16 a[20:21], v17 offset:17256
    v_mfma_f32_16x16x32_bf16 v[176:179], a[8:11], a[32:35], v[176:179]
    v_mfma_f32_16x16x32_bf16 v[136:139], a[8:11], a[36:39], v[136:139]
    ds_read_b64_tr_b16 a[22:23], v17 offset:17736
    s_waitcnt lgkmcnt(4)
    v_mfma_f32_16x16x32_bf16 v[96:99], a[8:11], a[40:43], v[96:99]
    ds_read_b64_tr_b16 a[0:1], v17 offset:17296
    v_mfma_f32_16x16x32_bf16 v[180:183], a[12:15], a[32:35], v[180:183]
    ds_read_b64_tr_b16 a[2:3], v17 offset:17776
    v_mfma_f32_16x16x32_bf16 v[140:143], a[12:15], a[36:39], v[140:143]
    ds_read_b64_tr_b16 a[4:5], v17 offset:17336
    s_waitcnt lgkmcnt(5)
    v_mfma_f32_16x16x32_bf16 v[100:103], a[12:15], a[40:43], v[100:103]
    buffer_load_dwordx4 v5, s[12:15], s54 offen offset:3168  lds
    v_mfma_f32_16x16x32_bf16 v[184:187], a[32:35], a[16:19], v[184:187]
    v_mfma_f32_16x16x32_bf16 v[188:191], a[36:39], a[16:19], v[188:191]
    ds_read_b64_tr_b16 a[6:7], v17 offset:17816
    s_waitcnt lgkmcnt(4)
    v_mfma_f32_16x16x32_bf16 v[192:195], a[40:43], a[16:19], v[192:195]
    ds_read_b64_tr_b16 a[8:9], v15 offset:17248
    v_mfma_f32_16x16x32_bf16 v[196:199], a[32:35], a[20:23], v[196:199]
    ds_read_b64_tr_b16 a[10:11], v15 offset:17728
    v_mfma_f32_16x16x32_bf16 v[200:203], a[36:39], a[20:23], v[200:203]
    s_waitcnt lgkmcnt(4)
    v_mfma_f32_16x16x32_bf16 v[204:207], a[40:43], a[20:23], v[204:207]
    s_waitcnt vmcnt(14)
    s_barrier
    v_mfma_f32_16x16x32_bf16 v[208:211], a[32:35], a[0:3], v[208:211]
    ds_read_b128 a[48:51], v13 offset:49152
    v_mfma_f32_16x16x32_bf16 v[212:215], a[36:39], a[0:3], v[212:215]
    ds_read_b64_tr_b16 a[12:13], v15 offset:33792
    v_mfma_f32_16x16x32_bf16 v[216:219], a[40:43], a[0:3], v[216:219]
    ds_read_b128 a[52:55], v13 offset:51200
    s_waitcnt lgkmcnt(5)
    v_mfma_f32_16x16x32_bf16 v[244:247], a[44:47], a[32:35], v[244:247]
    v_mfma_f32_16x16x32_bf16 v[220:223], a[32:35], a[4:7], v[220:223]
    ds_read_b64_tr_b16 a[14:15], v15 offset:34272
    v_mfma_f32_16x16x32_bf16 v[224:227], a[36:39], a[4:7], v[224:227]
    ds_read_b128 a[56:59], v13 offset:53248
    v_mfma_f32_16x16x32_bf16 v[228:231], a[40:43], a[4:7], v[228:231]
    ds_read_b64_tr_b16 a[16:17], v15 offset:33800
    s_waitcnt lgkmcnt(6)
    v_mfma_f32_16x16x32_bf16 v[248:251], a[44:47], a[36:39], v[248:251]
    v_mfma_f32_16x16x32_bf16 v[232:235], a[32:35], a[8:11], v[232:235]
    ds_read_b64_tr_b16 a[18:19], v15 offset:34280
    v_mfma_f32_16x16x32_bf16 v[236:239], a[36:39], a[8:11], v[236:239]
    ds_read_b64_tr_b16 a[20:21], v15 offset:33808
    v_mfma_f32_16x16x32_bf16 v[240:243], a[40:43], a[8:11], v[240:243]
    s_waitcnt lgkmcnt(3)
    v_mfma_f32_16x16x32_bf16 v[252:255], a[44:47], a[40:43], v[252:255]
    ds_read_b64_tr_b16 a[22:23], v15 offset:34288
    v_mfma_f32_16x16x32_bf16 v[144:147], a[12:15], a[48:51], v[144:147]
    ds_read_b64_tr_b16 a[0:1], v15 offset:33816
    v_mfma_f32_16x16x32_bf16 v[104:107], a[12:15], a[52:55], v[104:107]
    ds_read_b64_tr_b16 a[2:3], v15 offset:34296
    s_waitcnt lgkmcnt(4)
    v_mfma_f32_16x16x32_bf16 v[64:67], a[12:15], a[56:59], v[64:67]
    v_mfma_f32_16x16x32_bf16 v[148:151], a[16:19], a[48:51], v[148:151]
    ds_read_b64_tr_b16 a[4:5], v15 offset:33824
    v_mfma_f32_16x16x32_bf16 v[108:111], a[16:19], a[52:55], v[108:111]
    ds_read_b64_tr_b16 a[6:7], v15 offset:34304
    s_waitcnt lgkmcnt(4)
    v_mfma_f32_16x16x32_bf16 v[68:71], a[16:19], a[56:59], v[68:71]
    ds_read_b64_tr_b16 a[8:9], v15 offset:33952
    v_mfma_f32_16x16x32_bf16 v[152:155], a[20:23], a[48:51], v[152:155]
    v_mfma_f32_16x16x32_bf16 v[112:115], a[20:23], a[52:55], v[112:115]
    ds_read_b64_tr_b16 a[10:11], v15 offset:34432
    s_waitcnt lgkmcnt(4)
    v_mfma_f32_16x16x32_bf16 v[72:75], a[20:23], a[56:59], v[72:75]
    ds_read_b64_tr_b16 a[12:13], v15 offset:33960
    v_mfma_f32_16x16x32_bf16 v[156:159], a[0:3], a[48:51], v[156:159]
    v_mfma_f32_16x16x32_bf16 v[116:119], a[0:3], a[52:55], v[116:119]
    ds_read_b64_tr_b16 a[14:15], v15 offset:34440
    s_waitcnt lgkmcnt(4)
    v_mfma_f32_16x16x32_bf16 v[76:79], a[0:3], a[56:59], v[76:79]
    ds_read_b128 a[60:63], v14 offset:1088
    v_mfma_f32_16x16x32_bf16 v[160:163], a[4:7], a[48:51], v[160:163]
    ds_read_b64_tr_b16 a[16:17], v15 offset:33968
    v_mfma_f32_16x16x32_bf16 v[120:123], a[4:7], a[52:55], v[120:123]
    s_waitcnt lgkmcnt(4)
    v_mfma_f32_16x16x32_bf16 v[80:83], a[4:7], a[56:59], v[80:83]
    ds_read_b64_tr_b16 a[18:19], v15 offset:34448
    v_mfma_f32_16x16x32_bf16 v[164:167], a[8:11], a[48:51], v[164:167]
    ds_read_b64_tr_b16 a[20:21], v15 offset:33976
    v_mfma_f32_16x16x32_bf16 v[124:127], a[8:11], a[52:55], v[124:127]
    s_waitcnt lgkmcnt(4)
    v_mfma_f32_16x16x32_bf16 v[84:87], a[8:11], a[56:59], v[84:87]
    ds_read_b64_tr_b16 a[22:23], v15 offset:34456
    v_mfma_f32_16x16x32_bf16 v[168:171], a[12:15], a[48:51], v[168:171]
    ds_read_b64_tr_b16 a[0:1], v15 offset:33984
    v_mfma_f32_16x16x32_bf16 v[128:131], a[12:15], a[52:55], v[128:131]
    ds_read_b64_tr_b16 a[2:3], v15 offset:34464
    s_waitcnt lgkmcnt(4)
    v_mfma_f32_16x16x32_bf16 v[88:91], a[12:15], a[56:59], v[88:91]
    v_mfma_f32_16x16x32_bf16 v[172:175], a[16:19], a[48:51], v[172:175]
    ds_read_b64_tr_b16 a[4:5], v17 offset:34112
    v_mfma_f32_16x16x32_bf16 v[132:135], a[16:19], a[52:55], v[132:135]
    ds_read_b64_tr_b16 a[6:7], v17 offset:34592
    s_waitcnt lgkmcnt(4)
    v_mfma_f32_16x16x32_bf16 v[92:95], a[16:19], a[56:59], v[92:95]
    ds_read_b64_tr_b16 a[8:9], v17 offset:34152
    v_mfma_f32_16x16x32_bf16 v[176:179], a[20:23], a[48:51], v[176:179]
    v_mfma_f32_16x16x32_bf16 v[136:139], a[20:23], a[52:55], v[136:139]
    ds_read_b64_tr_b16 a[10:11], v17 offset:34632
    s_waitcnt lgkmcnt(4)
    v_mfma_f32_16x16x32_bf16 v[96:99], a[20:23], a[56:59], v[96:99]
    ds_read_b64_tr_b16 a[12:13], v17 offset:34192
    v_mfma_f32_16x16x32_bf16 v[180:183], a[0:3], a[48:51], v[180:183]
    v_mfma_f32_16x16x32_bf16 v[140:143], a[0:3], a[52:55], v[140:143]
    ds_read_b64_tr_b16 a[14:15], v17 offset:34672
    s_waitcnt lgkmcnt(4)
    v_mfma_f32_16x16x32_bf16 v[100:103], a[0:3], a[56:59], v[100:103]
    ds_read_b64_tr_b16 a[16:17], v17 offset:34232
    v_mfma_f32_16x16x32_bf16 v[184:187], a[48:51], a[4:7], v[184:187]
    ds_read_b64_tr_b16 a[18:19], v17 offset:34712
    v_mfma_f32_16x16x32_bf16 v[188:191], a[52:55], a[4:7], v[188:191]
    s_waitcnt lgkmcnt(4)
    v_mfma_f32_16x16x32_bf16 v[192:195], a[56:59], a[4:7], v[192:195]
    ds_read_b64_tr_b16 a[20:21], v15 offset:34144
    v_mfma_f32_16x16x32_bf16 v[196:199], a[48:51], a[8:11], v[196:199]
    ds_read_b64_tr_b16 a[22:23], v15 offset:34624
    v_mfma_f32_16x16x32_bf16 v[200:203], a[52:55], a[8:11], v[200:203]
    s_waitcnt lgkmcnt(4)
    v_mfma_f32_16x16x32_bf16 v[204:207], a[56:59], a[8:11], v[204:207]
    s_waitcnt vmcnt(4)
    s_barrier
    v_mfma_f32_16x16x32_bf16 v[208:211], a[48:51], a[12:15], v[208:211]
    ds_read_b128 a[32:35], v12 offset:0
    v_mfma_f32_16x16x32_bf16 v[212:215], a[52:55], a[12:15], v[212:215]
    ds_read_b64_tr_b16 a[0:1], v16 offset:0
    v_mfma_f32_16x16x32_bf16 v[216:219], a[56:59], a[12:15], v[216:219]
    ds_read_b128 a[36:39], v12 offset:2048
    s_waitcnt lgkmcnt(5)
    v_mfma_f32_16x16x32_bf16 v[244:247], a[60:63], a[48:51], v[244:247]
    v_mfma_f32_16x16x32_bf16 v[220:223], a[48:51], a[16:19], v[220:223]
    ds_read_b64_tr_b16 a[2:3], v16 offset:480
    v_mfma_f32_16x16x32_bf16 v[224:227], a[52:55], a[16:19], v[224:227]
    ds_read_b128 a[40:43], v12 offset:4096
    v_mfma_f32_16x16x32_bf16 v[228:231], a[56:59], a[16:19], v[228:231]
    ds_read_b64_tr_b16 a[4:5], v16 offset:8
    s_waitcnt lgkmcnt(6)
    v_mfma_f32_16x16x32_bf16 v[248:251], a[60:63], a[52:55], v[248:251]
    v_mfma_f32_16x16x32_bf16 v[232:235], a[48:51], a[20:23], v[232:235]
    ds_read_b64_tr_b16 a[6:7], v16 offset:488
    v_mfma_f32_16x16x32_bf16 v[236:239], a[52:55], a[20:23], v[236:239]
    ds_read_b64_tr_b16 a[8:9], v16 offset:16
    v_mfma_f32_16x16x32_bf16 v[240:243], a[56:59], a[20:23], v[240:243]
    s_waitcnt lgkmcnt(3)
    v_mfma_f32_16x16x32_bf16 v[252:255], a[60:63], a[56:59], v[252:255]
    ds_read_b64_tr_b16 a[10:11], v16 offset:496
    v_mfma_f32_16x16x32_bf16 v[144:147], a[0:3], a[32:35], v[144:147]
    ds_read_b64_tr_b16 a[12:13], v16 offset:24
    v_mfma_f32_16x16x32_bf16 v[104:107], a[0:3], a[36:39], v[104:107]
    ds_read_b64_tr_b16 a[14:15], v16 offset:504
    s_waitcnt lgkmcnt(4)
    v_mfma_f32_16x16x32_bf16 v[64:67], a[0:3], a[40:43], v[64:67]
    v_mfma_f32_16x16x32_bf16 v[148:151], a[4:7], a[32:35], v[148:151]
    ds_read_b64_tr_b16 a[16:17], v16 offset:32
    v_mfma_f32_16x16x32_bf16 v[108:111], a[4:7], a[36:39], v[108:111]
    ds_read_b64_tr_b16 a[18:19], v16 offset:512
    s_waitcnt lgkmcnt(4)
    v_mfma_f32_16x16x32_bf16 v[68:71], a[4:7], a[40:43], v[68:71]
    ds_read_b64_tr_b16 a[20:21], v16 offset:160
    v_mfma_f32_16x16x32_bf16 v[152:155], a[8:11], a[32:35], v[152:155]
    v_mfma_f32_16x16x32_bf16 v[112:115], a[8:11], a[36:39], v[112:115]
    ds_read_b64_tr_b16 a[22:23], v16 offset:640
    s_waitcnt lgkmcnt(4)
    v_mfma_f32_16x16x32_bf16 v[72:75], a[8:11], a[40:43], v[72:75]
    ds_read_b64_tr_b16 a[0:1], v16 offset:168
    v_mfma_f32_16x16x32_bf16 v[156:159], a[12:15], a[32:35], v[156:159]
    v_mfma_f32_16x16x32_bf16 v[116:119], a[12:15], a[36:39], v[116:119]
    ds_read_b64_tr_b16 a[2:3], v16 offset:648
    s_waitcnt lgkmcnt(4)
    v_mfma_f32_16x16x32_bf16 v[76:79], a[12:15], a[40:43], v[76:79]
    ds_read_b128 a[44:47], v14 offset:1152
    v_mfma_f32_16x16x32_bf16 v[160:163], a[16:19], a[32:35], v[160:163]
    ds_read_b64_tr_b16 a[4:5], v16 offset:176
    v_mfma_f32_16x16x32_bf16 v[120:123], a[16:19], a[36:39], v[120:123]
    s_waitcnt lgkmcnt(4)
    v_mfma_f32_16x16x32_bf16 v[80:83], a[16:19], a[40:43], v[80:83]
    ds_read_b64_tr_b16 a[6:7], v16 offset:656
    v_mfma_f32_16x16x32_bf16 v[164:167], a[20:23], a[32:35], v[164:167]
    ds_read_b64_tr_b16 a[8:9], v16 offset:184
    v_mfma_f32_16x16x32_bf16 v[124:127], a[20:23], a[36:39], v[124:127]
    s_waitcnt lgkmcnt(4)
    v_mfma_f32_16x16x32_bf16 v[84:87], a[20:23], a[40:43], v[84:87]
    ds_read_b64_tr_b16 a[10:11], v16 offset:664
    v_mfma_f32_16x16x32_bf16 v[168:171], a[0:3], a[32:35], v[168:171]
    ds_read_b64_tr_b16 a[12:13], v16 offset:192
    v_mfma_f32_16x16x32_bf16 v[128:131], a[0:3], a[36:39], v[128:131]
    ds_read_b64_tr_b16 a[14:15], v16 offset:672
    s_waitcnt lgkmcnt(4)
    v_mfma_f32_16x16x32_bf16 v[88:91], a[0:3], a[40:43], v[88:91]
    v_mfma_f32_16x16x32_bf16 v[172:175], a[4:7], a[32:35], v[172:175]
    ds_read_b64_tr_b16 a[16:17], v18 offset:320
    v_mfma_f32_16x16x32_bf16 v[132:135], a[4:7], a[36:39], v[132:135]
    ds_read_b64_tr_b16 a[18:19], v18 offset:800
    s_waitcnt lgkmcnt(4)
    v_mfma_f32_16x16x32_bf16 v[92:95], a[4:7], a[40:43], v[92:95]
    ds_read_b64_tr_b16 a[20:21], v18 offset:360
    v_mfma_f32_16x16x32_bf16 v[176:179], a[8:11], a[32:35], v[176:179]
    v_mfma_f32_16x16x32_bf16 v[136:139], a[8:11], a[36:39], v[136:139]
    ds_read_b64_tr_b16 a[22:23], v18 offset:840
    s_waitcnt lgkmcnt(4)
    v_mfma_f32_16x16x32_bf16 v[96:99], a[8:11], a[40:43], v[96:99]
    ds_read_b64_tr_b16 a[0:1], v18 offset:400
    v_mfma_f32_16x16x32_bf16 v[180:183], a[12:15], a[32:35], v[180:183]
    v_mfma_f32_16x16x32_bf16 v[140:143], a[12:15], a[36:39], v[140:143]
    ds_read_b64_tr_b16 a[2:3], v18 offset:880
    s_waitcnt lgkmcnt(4)
    v_mfma_f32_16x16x32_bf16 v[100:103], a[12:15], a[40:43], v[100:103]
    ds_read_b64_tr_b16 a[4:5], v18 offset:440
    v_mfma_f32_16x16x32_bf16 v[184:187], a[32:35], a[16:19], v[184:187]
    ds_read_b64_tr_b16 a[6:7], v18 offset:920
    v_mfma_f32_16x16x32_bf16 v[188:191], a[36:39], a[16:19], v[188:191]
    s_waitcnt lgkmcnt(4)
    v_mfma_f32_16x16x32_bf16 v[192:195], a[40:43], a[16:19], v[192:195]
    ds_read_b64_tr_b16 a[8:9], v16 offset:352
    v_mfma_f32_16x16x32_bf16 v[196:199], a[32:35], a[20:23], v[196:199]
    ds_read_b64_tr_b16 a[10:11], v16 offset:832
    v_mfma_f32_16x16x32_bf16 v[200:203], a[36:39], a[20:23], v[200:203]
    s_waitcnt lgkmcnt(4)
    v_mfma_f32_16x16x32_bf16 v[204:207], a[40:43], a[20:23], v[204:207]
    s_waitcnt vmcnt(0)
    s_barrier
    v_mfma_f32_16x16x32_bf16 v[208:211], a[32:35], a[0:3], v[208:211]
    ds_read_b128 a[48:51], v13 offset:0
    v_mfma_f32_16x16x32_bf16 v[212:215], a[36:39], a[0:3], v[212:215]
    ds_read_b64_tr_b16 a[12:13], v16 offset:16896
    v_mfma_f32_16x16x32_bf16 v[216:219], a[40:43], a[0:3], v[216:219]
    ds_read_b128 a[52:55], v13 offset:2048
    s_waitcnt lgkmcnt(5)
    v_mfma_f32_16x16x32_bf16 v[244:247], a[44:47], a[32:35], v[244:247]
    s_add_u32 s60, s48, 1
    s_mul_i32 s60, s60, 5120
    v_mfma_f32_16x16x32_bf16 v[220:223], a[32:35], a[4:7], v[220:223]
    ds_read_b64_tr_b16 a[14:15], v16 offset:17376
    s_add_u32 s60, s60, 109056
    v_mfma_f32_16x16x32_bf16 v[224:227], a[36:39], a[4:7], v[224:227]
    ds_read_b128 a[56:59], v13 offset:4096
    v_lshlrev_b32 v7, 3, v1
    v_mfma_f32_16x16x32_bf16 v[228:231], a[40:43], a[4:7], v[228:231]
    ds_read_b64_tr_b16 a[16:17], v16 offset:16904
    s_waitcnt lgkmcnt(6)
    v_mfma_f32_16x16x32_bf16 v[248:251], a[44:47], a[36:39], v[248:251]
    v_add_u32 v6, s60, v7
    v_lshlrev_b32 v2, 4, v1
    v_mfma_f32_16x16x32_bf16 v[232:235], a[32:35], a[8:11], v[232:235]
    ds_read_b64_tr_b16 a[18:19], v16 offset:17384
    v_and_b32 v3, 15, v1
    v_mfma_f32_16x16x32_bf16 v[236:239], a[36:39], a[8:11], v[236:239]
    ds_read_b64_tr_b16 a[20:21], v16 offset:16912
    v_lshlrev_b32 v3, 2, v3
    v_mfma_f32_16x16x32_bf16 v[240:243], a[40:43], a[8:11], v[240:243]
    s_waitcnt lgkmcnt(3)
    v_mfma_f32_16x16x32_bf16 v[252:255], a[44:47], a[40:43], v[252:255]
    ds_read_b64_tr_b16 a[22:23], v16 offset:17392
    v_mfma_f32_16x16x32_bf16 v[144:147], a[12:15], a[48:51], v[144:147]
    ds_read_b64_tr_b16 a[0:1], v16 offset:16920
    v_mfma_f32_16x16x32_bf16 v[104:107], a[12:15], a[52:55], v[104:107]
    ds_read_b64_tr_b16 a[2:3], v16 offset:17400
    s_waitcnt lgkmcnt(4)
    v_mfma_f32_16x16x32_bf16 v[64:67], a[12:15], a[56:59], v[64:67]
    v_mfma_f32_16x16x32_bf16 v[148:151], a[16:19], a[48:51], v[148:151]
    ds_read_b64_tr_b16 a[4:5], v16 offset:16928
    v_mfma_f32_16x16x32_bf16 v[108:111], a[16:19], a[52:55], v[108:111]
    ds_read_b64_tr_b16 a[6:7], v16 offset:17408
    s_waitcnt lgkmcnt(4)
    v_mfma_f32_16x16x32_bf16 v[68:71], a[16:19], a[56:59], v[68:71]
    ds_read_b64_tr_b16 a[8:9], v16 offset:17056
    v_cvt_pk_bf16_f32 v144, v144, v145
    v_mfma_f32_16x16x32_bf16 v[152:155], a[20:23], a[48:51], v[152:155]
    v_cvt_pk_bf16_f32 v145, v146, v147
    v_cvt_pk_bf16_f32 v104, v104, v105
    v_mfma_f32_16x16x32_bf16 v[112:115], a[20:23], a[52:55], v[112:115]
    ds_read_b64_tr_b16 a[10:11], v16 offset:17536
    s_waitcnt lgkmcnt(4)
    v_mfma_f32_16x16x32_bf16 v[72:75], a[20:23], a[56:59], v[72:75]
    ds_read_b64_tr_b16 a[12:13], v16 offset:17064
    v_cvt_pk_bf16_f32 v105, v106, v107
    v_mfma_f32_16x16x32_bf16 v[156:159], a[0:3], a[48:51], v[156:159]
    v_cvt_pk_bf16_f32 v64, v64, v65
    v_cvt_pk_bf16_f32 v65, v66, v67
    v_mfma_f32_16x16x32_bf16 v[116:119], a[0:3], a[52:55], v[116:119]
    ds_read_b64_tr_b16 a[14:15], v16 offset:17544
    s_waitcnt lgkmcnt(4)
    v_mfma_f32_16x16x32_bf16 v[76:79], a[0:3], a[56:59], v[76:79]
    ds_read_b128 a[60:63], v14 offset:1216
    v_cvt_pk_bf16_f32 v148, v148, v149
    v_mfma_f32_16x16x32_bf16 v[160:163], a[4:7], a[48:51], v[160:163]
    ds_read_b64_tr_b16 a[16:17], v16 offset:17072
    v_cvt_pk_bf16_f32 v149, v150, v151
    v_mfma_f32_16x16x32_bf16 v[120:123], a[4:7], a[52:55], v[120:123]
    s_waitcnt lgkmcnt(4)
    v_cvt_pk_bf16_f32 v108, v108, v109
    v_cvt_pk_bf16_f32 v109, v110, v111
    v_mfma_f32_16x16x32_bf16 v[80:83], a[4:7], a[56:59], v[80:83]
    ds_read_b64_tr_b16 a[18:19], v16 offset:17552
    v_cvt_pk_bf16_f32 v68, v68, v69
    v_mfma_f32_16x16x32_bf16 v[164:167], a[8:11], a[48:51], v[164:167]
    ds_read_b64_tr_b16 a[20:21], v16 offset:17080
    v_cvt_pk_bf16_f32 v69, v70, v71
    v_mfma_f32_16x16x32_bf16 v[124:127], a[8:11], a[52:55], v[124:127]
    s_waitcnt lgkmcnt(4)
    v_cvt_pk_bf16_f32 v152, v152, v153
    v_cvt_pk_bf16_f32 v153, v154, v155
    v_mfma_f32_16x16x32_bf16 v[84:87], a[8:11], a[56:59], v[84:87]
    ds_read_b64_tr_b16 a[22:23], v16 offset:17560
    v_cvt_pk_bf16_f32 v112, v112, v113
    v_mfma_f32_16x16x32_bf16 v[168:171], a[12:15], a[48:51], v[168:171]
    ds_read_b64_tr_b16 a[0:1], v16 offset:17088
    v_cvt_pk_bf16_f32 v113, v114, v115
    v_mfma_f32_16x16x32_bf16 v[128:131], a[12:15], a[52:55], v[128:131]
    ds_read_b64_tr_b16 a[2:3], v16 offset:17568
    s_waitcnt lgkmcnt(4)
    v_mfma_f32_16x16x32_bf16 v[88:91], a[12:15], a[56:59], v[88:91]
    v_cvt_pk_bf16_f32 v72, v72, v73
    v_cvt_pk_bf16_f32 v73, v74, v75
    v_mfma_f32_16x16x32_bf16 v[172:175], a[16:19], a[48:51], v[172:175]
    ds_read_b64_tr_b16 a[4:5], v18 offset:17216
    v_cvt_pk_bf16_f32 v156, v156, v157
    v_mfma_f32_16x16x32_bf16 v[132:135], a[16:19], a[52:55], v[132:135]
    ds_read_b64_tr_b16 a[6:7], v18 offset:17696
    s_waitcnt lgkmcnt(4)
    v_mfma_f32_16x16x32_bf16 v[92:95], a[16:19], a[56:59], v[92:95]
    ds_read_b64_tr_b16 a[8:9], v18 offset:17256
    v_cvt_pk_bf16_f32 v157, v158, v159
    v_mfma_f32_16x16x32_bf16 v[176:179], a[20:23], a[48:51], v[176:179]
    v_cvt_pk_bf16_f32 v116, v116, v117
    v_cvt_pk_bf16_f32 v117, v118, v119
    v_mfma_f32_16x16x32_bf16 v[136:139], a[20:23], a[52:55], v[136:139]
    ds_read_b64_tr_b16 a[10:11], v18 offset:17736
    s_waitcnt lgkmcnt(4)
    v_mfma_f32_16x16x32_bf16 v[96:99], a[20:23], a[56:59], v[96:99]
    ds_read_b64_tr_b16 a[12:13], v18 offset:17296
    v_cvt_pk_bf16_f32 v76, v76, v77
    v_mfma_f32_16x16x32_bf16 v[180:183], a[0:3], a[48:51], v[180:183]
    v_cvt_pk_bf16_f32 v77, v78, v79
    v_cvt_pk_bf16_f32 v160, v160, v161
    v_mfma_f32_16x16x32_bf16 v[140:143], a[0:3], a[52:55], v[140:143]
    ds_read_b64_tr_b16 a[14:15], v18 offset:17776
    s_waitcnt lgkmcnt(4)
    v_mfma_f32_16x16x32_bf16 v[100:103], a[0:3], a[56:59], v[100:103]
    ds_read_b64_tr_b16 a[16:17], v18 offset:17336
    v_cvt_pk_bf16_f32 v161, v162, v163
    v_mfma_f32_16x16x32_bf16 v[184:187], a[48:51], a[4:7], v[184:187]
    ds_read_b64_tr_b16 a[18:19], v18 offset:17816
    v_cvt_pk_bf16_f32 v120, v120, v121
    v_mfma_f32_16x16x32_bf16 v[188:191], a[52:55], a[4:7], v[188:191]
    s_waitcnt lgkmcnt(4)
    v_cvt_pk_bf16_f32 v121, v122, v123
    v_cvt_pk_bf16_f32 v80, v80, v81
    v_mfma_f32_16x16x32_bf16 v[192:195], a[56:59], a[4:7], v[192:195]
    ds_read_b64_tr_b16 a[20:21], v16 offset:17248
    v_cvt_pk_bf16_f32 v81, v82, v83
    v_mfma_f32_16x16x32_bf16 v[196:199], a[48:51], a[8:11], v[196:199]
    ds_read_b64_tr_b16 a[22:23], v16 offset:17728
    v_cvt_pk_bf16_f32 v164, v164, v165
    v_mfma_f32_16x16x32_bf16 v[200:203], a[52:55], a[8:11], v[200:203]
    s_waitcnt lgkmcnt(4)
    v_cvt_pk_bf16_f32 v165, v166, v167
    v_cvt_pk_bf16_f32 v124, v124, v125
    v_mfma_f32_16x16x32_bf16 v[204:207], a[56:59], a[8:11], v[204:207]
    v_cvt_pk_bf16_f32 v125, v126, v127
    v_cvt_pk_bf16_f32 v84, v84, v85
    v_mfma_f32_16x16x32_bf16 v[208:211], a[48:51], a[12:15], v[208:211]
    v_cvt_pk_bf16_f32 v85, v86, v87
    v_cvt_pk_bf16_f32 v168, v168, v169
    v_mfma_f32_16x16x32_bf16 v[212:215], a[52:55], a[12:15], v[212:215]
    v_cvt_pk_bf16_f32 v169, v170, v171
    v_cvt_pk_bf16_f32 v128, v128, v129
    v_mfma_f32_16x16x32_bf16 v[216:219], a[56:59], a[12:15], v[216:219]
    s_waitcnt lgkmcnt(2)
    v_cvt_pk_bf16_f32 v129, v130, v131
    v_cvt_pk_bf16_f32 v88, v88, v89
    v_mfma_f32_16x16x32_bf16 v[244:247], a[60:63], a[48:51], v[244:247]
    v_cvt_pk_bf16_f32 v89, v90, v91
    v_cvt_pk_bf16_f32 v172, v172, v173
    v_mfma_f32_16x16x32_bf16 v[220:223], a[48:51], a[16:19], v[220:223]
    v_cvt_pk_bf16_f32 v173, v174, v175
    v_cvt_pk_bf16_f32 v132, v132, v133
    v_mfma_f32_16x16x32_bf16 v[224:227], a[52:55], a[16:19], v[224:227]
    v_cvt_pk_bf16_f32 v133, v134, v135
    v_cvt_pk_bf16_f32 v92, v92, v93
    v_mfma_f32_16x16x32_bf16 v[228:231], a[56:59], a[16:19], v[228:231]
    s_waitcnt lgkmcnt(0)
    v_cvt_pk_bf16_f32 v93, v94, v95
    v_cvt_pk_bf16_f32 v176, v176, v177
    v_mfma_f32_16x16x32_bf16 v[248:251], a[60:63], a[52:55], v[248:251]
    v_cvt_pk_bf16_f32 v177, v178, v179
    v_cvt_pk_bf16_f32 v136, v136, v137
    v_mfma_f32_16x16x32_bf16 v[232:235], a[48:51], a[20:23], v[232:235]
    v_cvt_pk_bf16_f32 v137, v138, v139
    v_cvt_pk_bf16_f32 v96, v96, v97
    v_mfma_f32_16x16x32_bf16 v[236:239], a[52:55], a[20:23], v[236:239]
    v_cvt_pk_bf16_f32 v97, v98, v99
    v_cvt_pk_bf16_f32 v180, v180, v181
    v_mfma_f32_16x16x32_bf16 v[240:243], a[56:59], a[20:23], v[240:243]
    v_cvt_pk_bf16_f32 v181, v182, v183
    v_cvt_pk_bf16_f32 v140, v140, v141
    v_cvt_pk_bf16_f32 v141, v142, v143
    v_cvt_pk_bf16_f32 v100, v100, v101
    v_cvt_pk_bf16_f32 v101, v102, v103
    v_mfma_f32_16x16x32_bf16 v[252:255], a[60:63], a[56:59], v[252:255]
    v_mfma_f32_16x16x4_4b_bf16 v[32:47], v[84:85], v[64:65], 0
    ds_write_b64 v6, v[84:85] offset:0
    ds_write_b64 v6, v[88:89] offset:512
    ds_write_b64 v6, v[92:93] offset:1024
    ds_write_b64 v6, v[96:97] offset:1536
    v_mfma_f32_16x16x4_4b_bf16 v[48:63], v[124:125], v[64:65], 0
    ds_write_b64 v6, v[100:101] offset:2048
    v_cvt_pk_bf16_f32 v195, v194, v195
    v_cvt_pk_bf16_f32 v194, v192, v193
    ds_write_b64 v6, v[194:195] offset:2560
    v_mfma_f32_16x16x4_4b_bf16 v[32:47], v[88:89], v[68:69], v[32:47]
    v_cvt_pk_bf16_f32 v207, v206, v207
    v_cvt_pk_bf16_f32 v206, v204, v205
    ds_write_b64 v6, v[206:207] offset:3072
    v_cvt_pk_bf16_f32 v219, v218, v219
    v_mfma_f32_16x16x4_4b_bf16 v[48:63], v[128:129], v[68:69], v[48:63]
    v_cvt_pk_bf16_f32 v218, v216, v217
    ds_write_b64 v6, v[218:219] offset:3584
    v_cvt_pk_bf16_f32 v231, v230, v231
    v_cvt_pk_bf16_f32 v230, v228, v229
    v_mfma_f32_16x16x4_4b_bf16 v[32:47], v[92:93], v[72:73], v[32:47]
    ds_write_b64 v6, v[230:231] offset:4096
    v_cvt_pk_bf16_f32 v243, v242, v243
    v_cvt_pk_bf16_f32 v242, v240, v241
    ds_write_b64 v6, v[242:243] offset:4608
    v_mfma_f32_16x16x4_4b_bf16 v[48:63], v[132:133], v[72:73], v[48:63]
    v_cvt_pk_bf16_f32 v192, v188, v189
    v_cvt_pk_bf16_f32 v193, v190, v191
    v_cvt_pk_bf16_f32 v204, v200, v201
    v_cvt_pk_bf16_f32 v205, v202, v203
    v_mfma_f32_16x16x4_4b_bf16 v[32:47], v[96:97], v[76:77], v[32:47]
    v_cvt_pk_bf16_f32 v216, v212, v213
    v_cvt_pk_bf16_f32 v217, v214, v215
    v_cvt_pk_bf16_f32 v228, v224, v225
    v_cvt_pk_bf16_f32 v229, v226, v227
    v_mfma_f32_16x16x4_4b_bf16 v[48:63], v[136:137], v[76:77], v[48:63]
    v_cvt_pk_bf16_f32 v240, v236, v237
    v_cvt_pk_bf16_f32 v241, v238, v239
    v_cvt_pk_bf16_f32 v190, v184, v185
    v_cvt_pk_bf16_f32 v191, v186, v187
    v_mfma_f32_16x16x4_4b_bf16 v[32:47], v[100:101], v[80:81], v[32:47]
    v_cvt_pk_bf16_f32 v202, v196, v197
    v_cvt_pk_bf16_f32 v203, v198, v199
    v_cvt_pk_bf16_f32 v214, v208, v209
    v_cvt_pk_bf16_f32 v215, v210, v211
    v_mfma_f32_16x16x4_4b_bf16 v[48:63], v[140:141], v[80:81], v[48:63]
    v_cvt_pk_bf16_f32 v226, v220, v221
    v_cvt_pk_bf16_f32 v227, v222, v223
    v_cvt_pk_bf16_f32 v238, v232, v233
    v_cvt_pk_bf16_f32 v239, v234, v235
    v_subrev_u32 v6, 5120, v6
    s_waitcnt lgkmcnt(0)
    s_barrier
    ds_read_b64 v[8:9], v6 offset:0
    ds_read_b64 v[10:11], v6 offset:512
    ds_read_b64 v[12:13], v6 offset:1024
    ds_read_b64 v[14:15], v6 offset:1536
    ds_read_b64 v[16:17], v6 offset:2048
    ds_read_b64 v[188:189], v6 offset:2560
    ds_read_b64 v[200:201], v6 offset:3072
    ds_read_b64 v[212:213], v6 offset:3584
    ds_read_b64 v[224:225], v6 offset:4096
    ds_read_b64 v[236:237], v6 offset:4608
    v_mul_f32 v244, 0xbfb8aa3b, v244
    v_mul_f32 v248, 0xbfb8aa3b, v248
    v_mul_f32 v252, 0xbfb8aa3b, v252
    v_exp_f32 v244, v244
    v_exp_f32 v248, v248
    v_exp_f32 v252, v252
    v_add_f32 v244, 1.0, v244
    v_add_f32 v248, 1.0, v248
    v_add_f32 v252, 1.0, v252
    v_rcp_f32 v244, v244
    v_rcp_f32 v248, v248
    v_rcp_f32 v252, v252
    v_sub_f32 v245, 1.0, v244
    v_sub_f32 v249, 1.0, v248
    v_sub_f32 v253, 1.0, v252
    s_add_u32 s60, s73, s70
    buffer_store_dword v245, v3, s[16:19], s60 offen sc1
    s_add_u32 s60, s73, s71
    buffer_store_dword v249, v3, s[16:19], s60 offen sc1
    s_add_u32 s60, s73, s72
    buffer_store_dword v253, v3, s[16:19], s60 offen sc1
    v_cndmask_b32 v32, v32, v33, s[76:77]
    v_cndmask_b32 v34, v34, v35, s[76:77]
    v_cndmask_b32 v48, v48, v49, s[76:77]
    v_cndmask_b32 v50, v50, v51, s[76:77]
    v_cndmask_b32 v36, v36, v37, s[76:77]
    v_cndmask_b32 v38, v38, v39, s[76:77]
    v_cndmask_b32 v52, v52, v53, s[76:77]
    v_cndmask_b32 v54, v54, v55, s[76:77]
    v_cndmask_b32 v40, v40, v41, s[76:77]
    v_cndmask_b32 v42, v42, v43, s[76:77]
    v_cndmask_b32 v56, v56, v57, s[76:77]
    v_cndmask_b32 v58, v58, v59, s[76:77]
    v_mfma_f32_16x16x4_4b_bf16 v[64:79], v[124:125], v[104:105], 0
    v_cndmask_b32 v44, v44, v45, s[76:77]
    v_cndmask_b32 v46, v46, v47, s[76:77]
    v_cndmask_b32 v60, v60, v61, s[76:77]
    v_cndmask_b32 v62, v62, v63, s[76:77]
    v_cndmask_b32 v32, v48, v32, s[78:79]
    v_cndmask_b32 v36, v52, v36, s[78:79]
    v_cndmask_b32 v40, v56, v40, s[78:79]
    v_cndmask_b32 v44, v60, v44, s[78:79]
    v_mfma_f32_16x16x4_4b_bf16 v[80:95], v[164:165], v[104:105], 0
    v_cndmask_b32 v34, v50, v34, s[80:81]
    v_cndmask_b32 v38, v54, v38, s[80:81]
    v_cndmask_b32 v42, v58, v42, s[80:81]
    v_cndmask_b32 v46, v62, v46, s[80:81]
    v_permlane32_swap_b32 v32, v40
    v_permlane32_swap_b32 v36, v44
    v_permlane32_swap_b32 v34, v42
    v_permlane32_swap_b32 v38, v46
    v_mfma_f32_16x16x4_4b_bf16 v[64:79], v[128:129], v[108:109], v[64:79]
    v_permlane16_swap_b32 v32, v36
    v_permlane16_swap_b32 v40, v44
    v_permlane16_swap_b32 v34, v38
    v_permlane16_swap_b32 v42, v46
    v_max3_f32 v48, v32, v36, v40
    v_max3_f32 v49, v44, v34, v38
    v_max3_f32 v48, v48, v42, v46
    v_max_f32 v48, v48, v49
    v_mfma_f32_16x16x4_4b_bf16 v[80:95], v[168:169], v[108:109], v[80:95]
    v_mul_f32 v48, s95, v48
    v_fma_f32 v32, v32, s95, -v48
    v_fma_f32 v36, v36, s95, -v48
    v_fma_f32 v40, v40, s95, -v48
    v_fma_f32 v44, v44, s95, -v48
    v_fma_f32 v34, v34, s95, -v48
    v_fma_f32 v38, v38, s95, -v48
    v_mfma_f32_16x16x4_4b_bf16 v[64:79], v[132:133], v[112:113], v[64:79]
    v_fma_f32 v42, v42, s95, -v48
    v_fma_f32 v46, v46, s95, -v48
    v_exp_f32 v32, v32
    v_exp_f32 v36, v36
    v_exp_f32 v40, v40
    v_exp_f32 v44, v44
    v_exp_f32 v34, v34
    v_exp_f32 v38, v38
    v_mfma_f32_16x16x4_4b_bf16 v[80:95], v[172:173], v[112:113], v[80:95]
    v_exp_f32 v42, v42
    v_exp_f32 v46, v46
    v_add_f32 v48, v32, v36
    v_add_f32 v49, v40, v44
    v_add_f32 v50, v34, v38
    v_add_f32 v48, v48, v49
    v_add_f32 v51, v42, v46
    v_add_f32 v48, v48, v50
    v_mfma_f32_16x16x4_4b_bf16 v[64:79], v[136:137], v[116:117], v[64:79]
    v_add_f32 v48, v48, v51
    v_rcp_f32 v48, v48
    s_nop 0
    v_mul_f32 v48, v48, v252
    v_mul_f32 v32, v48, v32
    v_mul_f32 v34, v48, v34
    v_mul_f32 v40, v48, v40
    v_mul_f32 v42, v48, v42
    v_mul_f32 v36, v48, v36
    v_mfma_f32_16x16x4_4b_bf16 v[80:95], v[176:177], v[116:117], v[80:95]
    v_mul_f32 v38, v48, v38
    v_mul_f32 v44, v48, v44
    v_mul_f32 v46, v48, v46
    v_cvt_pk_bf16_f32 v52, v32, v34
    v_cvt_pk_bf16_f32 v54, v40, v42
    v_cvt_pk_bf16_f32 v53, v36, v38
    v_cvt_pk_bf16_f32 v55, v44, v46
    v_permlane32_swap_b32 v52, v54
    v_mfma_f32_16x16x4_4b_bf16 v[64:79], v[140:141], v[120:121], v[64:79]
    v_permlane32_swap_b32 v53, v55
    s_nop 1
    v_permlane16_swap_b32 v52, v53
    v_permlane16_swap_b32 v54, v55
    v_perm_b32 v32, v52, v52, v28
    v_perm_b32 v33, v52, v52, v29
    v_perm_b32 v34, v52, v52, v30
    v_perm_b32 v35, v52, v52, v31
    v_mfma_f32_16x16x4_4b_bf16 v[80:95], v[180:181], v[120:121], v[80:95]
    v_perm_b32 v36, v53, v53, v28
    v_perm_b32 v37, v53, v53, v29
    v_perm_b32 v38, v53, v53, v30
    v_perm_b32 v39, v53, v53, v31
    v_perm_b32 v40, v54, v54, v28
    v_perm_b32 v41, v54, v54, v29
    v_perm_b32 v42, v54, v54, v30
    v_perm_b32 v43, v54, v54, v31
    v_perm_b32 v44, v55, v55, v28
    v_perm_b32 v45, v55, v55, v29
    v_perm_b32 v46, v55, v55, v30
    v_perm_b32 v47, v55, v55, v31
    v_cndmask_b32 v64, v64, v65, s[76:77]
    v_cndmask_b32 v66, v66, v67, s[76:77]
    v_mfma_f32_16x16x32_bf16 v[104:107], v[192:195], v[32:35], 0
    v_cndmask_b32 v80, v80, v81, s[76:77]
    v_cndmask_b32 v82, v82, v83, s[76:77]
    v_mfma_f32_16x16x32_bf16 v[108:111], v[204:207], v[36:39], 0
    v_add_f32 v80, s94, v80
    v_add_f32 v82, s94, v82
    v_mfma_f32_16x16x32_bf16 v[112:115], v[216:219], v[40:43], 0
    v_cndmask_b32 v68, v68, v69, s[76:77]
    v_cndmask_b32 v70, v70, v71, s[76:77]
    v_mfma_f32_16x16x32_bf16 v[116:119], v[228:231], v[44:47], 0
    v_cndmask_b32 v84, v84, v85, s[76:77]
    v_cndmask_b32 v86, v86, v87, s[76:77]
    v_mfma_f32_16x16x32_bf16 v[120:123], v[240:243], v[32:35], 0
    v_add_f32 v84, s94, v84
    v_add_f32 v86, s94, v86
    v_mfma_f32_16x16x32_bf16 v[184:187], v[240:243], v[36:39], 0
    v_cndmask_b32 v72, v72, v73, s[76:77]
    v_cndmask_b32 v74, v74, v75, s[76:77]
    v_mfma_f32_16x16x32_bf16 v[196:199], v[240:243], v[40:43], 0
    v_cndmask_b32 v88, v88, v89, s[76:77]
    v_cndmask_b32 v90, v90, v91, s[76:77]
    v_mfma_f32_16x16x32_bf16 v[208:211], v[240:243], v[44:47], 0
    v_add_f32 v88, s94, v88
    v_add_f32 v90, s94, v90
    v_cndmask_b32 v76, v76, v77, s[76:77]
    v_cndmask_b32 v78, v78, v79, s[76:77]
    v_cvt_pk_bf16_f32 v56, v104, v105
    v_cvt_pk_bf16_f32 v57, v106, v107
    v_cvt_pk_bf16_f32 v58, v108, v109
    v_cvt_pk_bf16_f32 v59, v110, v111
    s_add_u32 s60, s92, s98
    buffer_store_dwordx4 v[56:59], v2, s[16:19], s60 offen sc1
    v_cvt_pk_bf16_f32 v60, v112, v113
    v_cvt_pk_bf16_f32 v61, v114, v115
    v_cvt_pk_bf16_f32 v62, v116, v117
    v_cvt_pk_bf16_f32 v63, v118, v119
    s_add_u32 s60, s93, s98
    buffer_store_dwordx4 v[60:63], v2, s[16:19], s60 offen sc1
    v_cvt_pk_bf16_f32 v48, v120, v121
    v_cvt_pk_bf16_f32 v49, v122, v123
    v_cvt_pk_bf16_f32 v50, v184, v185
    v_cvt_pk_bf16_f32 v51, v186, v187
    v_cvt_pk_bf16_f32 v52, v196, v197
    v_cvt_pk_bf16_f32 v53, v198, v199
    v_cvt_pk_bf16_f32 v54, v208, v209
    v_cvt_pk_bf16_f32 v55, v210, v211
    v_cndmask_b32 v48, v48, v50, s[82:83]
    v_cndmask_b32 v49, v49, v51, s[82:83]
    v_cndmask_b32 v48, v48, v52, s[84:85]
    v_cndmask_b32 v49, v49, v53, s[84:85]
    v_cndmask_b32 v48, v48, v54, s[86:87]
    v_cndmask_b32 v49, v49, v55, s[86:87]
    s_add_u32 s60, s91, s98
    buffer_store_dwordx2 v[48:49], v7, s[16:19], s60 offen sc1
    v_cndmask_b32 v92, v92, v93, s[76:77]
    v_cndmask_b32 v94, v94, v95, s[76:77]
    v_add_f32 v92, s94, v92
    v_add_f32 v94, s94, v94
    v_cndmask_b32 v64, v80, v64, s[78:79]
    v_cndmask_b32 v68, v84, v68, s[78:79]
    v_cndmask_b32 v72, v88, v72, s[78:79]
    v_cndmask_b32 v76, v92, v76, s[78:79]
    v_cndmask_b32 v66, v82, v66, s[80:81]
    v_mfma_f32_16x16x4_4b_bf16 v[32:47], v[164:165], v[144:145], 0
    v_cndmask_b32 v70, v86, v70, s[80:81]
    v_cndmask_b32 v74, v90, v74, s[80:81]
    v_cndmask_b32 v78, v94, v78, s[80:81]
    v_permlane32_swap_b32 v64, v72
    v_permlane32_swap_b32 v68, v76
    v_permlane32_swap_b32 v66, v74
    v_permlane32_swap_b32 v70, v78
    s_waitcnt lgkmcnt(9)
    v_mfma_f32_16x16x4_4b_bf16 v[48:63], v[8:9], v[144:145], 0
    v_permlane16_swap_b32 v64, v68
    v_permlane16_swap_b32 v72, v76
    v_permlane16_swap_b32 v66, v70
    v_permlane16_swap_b32 v74, v78
    v_max3_f32 v80, v64, v68, v72
    v_max3_f32 v81, v76, v66, v70
    v_max3_f32 v80, v80, v74, v78
    v_mfma_f32_16x16x4_4b_bf16 v[32:47], v[168:169], v[148:149], v[32:47]
    v_max_f32 v80, v80, v81
    v_mul_f32 v80, s95, v80
    v_fma_f32 v64, v64, s95, -v80
    v_fma_f32 v68, v68, s95, -v80
    v_fma_f32 v72, v72, s95, -v80
    v_fma_f32 v76, v76, s95, -v80
    v_fma_f32 v66, v66, s95, -v80
    s_waitcnt lgkmcnt(8)
    v_mfma_f32_16x16x4_4b_bf16 v[48:63], v[10:11], v[148:149], v[48:63]
    v_fma_f32 v70, v70, s95, -v80
    v_fma_f32 v74, v74, s95, -v80
    v_fma_f32 v78, v78, s95, -v80
    v_exp_f32 v64, v64
    v_exp_f32 v68, v68
    v_exp_f32 v72, v72
    v_mfma_f32_16x16x4_4b_bf16 v[32:47], v[172:173], v[152:153], v[32:47]
    v_exp_f32 v76, v76
    v_exp_f32 v66, v66
    v_exp_f32 v70, v70
    v_exp_f32 v74, v74
    v_exp_f32 v78, v78
    v_add_f32 v80, v64, v68
    v_add_f32 v81, v72, v76
    s_waitcnt lgkmcnt(7)
    v_mfma_f32_16x16x4_4b_bf16 v[48:63], v[12:13], v[152:153], v[48:63]
    v_add_f32 v82, v66, v70
    v_add_f32 v80, v80, v81
    v_add_f32 v83, v74, v78
    v_add_f32 v80, v80, v82
    v_add_f32 v80, v80, v83
    v_rcp_f32 v80, v80
    s_nop 0
    v_mul_f32 v80, v80, v248
    v_mfma_f32_16x16x4_4b_bf16 v[32:47], v[176:177], v[156:157], v[32:47]
    v_mul_f32 v64, v80, v64
    v_mul_f32 v66, v80, v66
    v_mul_f32 v72, v80, v72
    v_mul_f32 v74, v80, v74
    v_mul_f32 v68, v80, v68
    v_mul_f32 v70, v80, v70
    v_mul_f32 v76, v80, v76
    s_waitcnt lgkmcnt(6)
    v_mfma_f32_16x16x4_4b_bf16 v[48:63], v[14:15], v[156:157], v[48:63]
    v_mul_f32 v78, v80, v78
    v_cvt_pk_bf16_f32 v84, v64, v66
    v_cvt_pk_bf16_f32 v86, v72, v74
    v_cvt_pk_bf16_f32 v85, v68, v70
    v_cvt_pk_bf16_f32 v87, v76, v78
    v_permlane32_swap_b32 v84, v86
    s_nop 0
    v_permlane32_swap_b32 v85, v87
    v_mfma_f32_16x16x4_4b_bf16 v[32:47], v[180:181], v[160:161], v[32:47]
    s_nop 0
    v_permlane16_swap_b32 v84, v85
    v_permlane16_swap_b32 v86, v87
    v_perm_b32 v64, v84, v84, v28
    v_perm_b32 v65, v84, v84, v29
    v_perm_b32 v66, v84, v84, v30
    v_perm_b32 v67, v84, v84, v31
    s_waitcnt lgkmcnt(5)
    v_mfma_f32_16x16x4_4b_bf16 v[48:63], v[16:17], v[160:161], v[48:63]
    v_perm_b32 v68, v85, v85, v28
    v_perm_b32 v69, v85, v85, v29
    v_perm_b32 v70, v85, v85, v30
    v_perm_b32 v71, v85, v85, v31
    v_perm_b32 v72, v86, v86, v28
    v_perm_b32 v73, v86, v86, v29
    v_perm_b32 v74, v86, v86, v30
    v_perm_b32 v75, v86, v86, v31
    v_perm_b32 v76, v87, v87, v28
    v_perm_b32 v77, v87, v87, v29
    v_perm_b32 v78, v87, v87, v30
    v_perm_b32 v79, v87, v87, v31
    v_cndmask_b32 v32, v32, v33, s[76:77]
    v_cndmask_b32 v34, v34, v35, s[76:77]
    v_mfma_f32_16x16x32_bf16 v[104:107], v[190:193], v[64:67], 0
    v_cndmask_b32 v48, v48, v49, s[76:77]
    v_cndmask_b32 v50, v50, v51, s[76:77]
    v_mfma_f32_16x16x32_bf16 v[108:111], v[202:205], v[68:71], 0
    v_cndmask_b32 v36, v36, v37, s[76:77]
    v_cndmask_b32 v38, v38, v39, s[76:77]
    v_mfma_f32_16x16x32_bf16 v[112:115], v[214:217], v[72:75], 0
    v_cndmask_b32 v52, v52, v53, s[76:77]
    v_cndmask_b32 v54, v54, v55, s[76:77]
    v_mfma_f32_16x16x32_bf16 v[116:119], v[226:229], v[76:79], 0
    v_cndmask_b32 v40, v40, v41, s[76:77]
    v_cndmask_b32 v42, v42, v43, s[76:77]
    v_mfma_f32_16x16x32_bf16 v[120:123], v[238:241], v[64:67], 0
    v_cndmask_b32 v56, v56, v57, s[76:77]
    v_cndmask_b32 v58, v58, v59, s[76:77]
    v_mfma_f32_16x16x32_bf16 v[184:187], v[238:241], v[68:71], 0
    v_cndmask_b32 v44, v44, v45, s[76:77]
    v_cndmask_b32 v46, v46, v47, s[76:77]
    v_mfma_f32_16x16x32_bf16 v[196:199], v[238:241], v[72:75], 0
    v_cndmask_b32 v60, v60, v61, s[76:77]
    v_cndmask_b32 v62, v62, v63, s[76:77]
    v_mfma_f32_16x16x32_bf16 v[208:211], v[238:241], v[76:79], 0
    v_cndmask_b32 v32, v48, v32, s[78:79]
    v_cndmask_b32 v36, v52, v36, s[78:79]
    v_cndmask_b32 v40, v56, v40, s[78:79]
    v_cndmask_b32 v44, v60, v44, s[78:79]
    v_cvt_pk_bf16_f32 v88, v104, v105
    v_cvt_pk_bf16_f32 v89, v106, v107
    v_cvt_pk_bf16_f32 v90, v108, v109
    v_cvt_pk_bf16_f32 v91, v110, v111
    s_add_u32 s60, s92, s97
    buffer_store_dwordx4 v[88:91], v2, s[16:19], s60 offen sc1
    v_cvt_pk_bf16_f32 v92, v112, v113
    v_cvt_pk_bf16_f32 v93, v114, v115
    v_cvt_pk_bf16_f32 v94, v116, v117
    v_cvt_pk_bf16_f32 v95, v118, v119
    s_add_u32 s60, s93, s97
    buffer_store_dwordx4 v[92:95], v2, s[16:19], s60 offen sc1
    v_cvt_pk_bf16_f32 v80, v120, v121
    v_cvt_pk_bf16_f32 v81, v122, v123
    v_cvt_pk_bf16_f32 v82, v184, v185
    v_cvt_pk_bf16_f32 v83, v186, v187
    v_cvt_pk_bf16_f32 v84, v196, v197
    v_cvt_pk_bf16_f32 v85, v198, v199
    v_cvt_pk_bf16_f32 v86, v208, v209
    v_cvt_pk_bf16_f32 v87, v210, v211
    v_cndmask_b32 v80, v80, v82, s[82:83]
    v_cndmask_b32 v81, v81, v83, s[82:83]
    v_cndmask_b32 v80, v80, v84, s[84:85]
    v_cndmask_b32 v81, v81, v85, s[84:85]
    v_cndmask_b32 v80, v80, v86, s[86:87]
    v_cndmask_b32 v81, v81, v87, s[86:87]
    s_add_u32 s60, s91, s97
    buffer_store_dwordx2 v[80:81], v7, s[16:19], s60 offen sc1
    v_cndmask_b32 v34, v50, v34, s[80:81]
    v_cndmask_b32 v38, v54, v38, s[80:81]
    v_cndmask_b32 v42, v58, v42, s[80:81]
    v_cndmask_b32 v46, v62, v46, s[80:81]
    v_permlane32_swap_b32 v32, v40
    v_permlane32_swap_b32 v36, v44
    v_permlane32_swap_b32 v34, v42
    v_permlane32_swap_b32 v38, v46
    v_permlane16_swap_b32 v32, v36
    v_permlane16_swap_b32 v40, v44
    v_permlane16_swap_b32 v34, v38
    v_permlane16_swap_b32 v42, v46
    v_max3_f32 v48, v32, v36, v40
    v_max3_f32 v49, v44, v34, v38
    v_max3_f32 v48, v48, v42, v46
    v_max_f32 v48, v48, v49
    v_mul_f32 v48, s95, v48
    v_fma_f32 v32, v32, s95, -v48
    v_fma_f32 v36, v36, s95, -v48
    v_fma_f32 v40, v40, s95, -v48
    v_fma_f32 v44, v44, s95, -v48
    v_fma_f32 v34, v34, s95, -v48
    v_fma_f32 v38, v38, s95, -v48
    v_fma_f32 v42, v42, s95, -v48
    v_fma_f32 v46, v46, s95, -v48
    v_exp_f32 v32, v32
    v_exp_f32 v36, v36
    v_exp_f32 v40, v40
    v_exp_f32 v44, v44
    v_exp_f32 v34, v34
    v_exp_f32 v38, v38
    v_exp_f32 v42, v42
    v_exp_f32 v46, v46
    v_add_f32 v48, v32, v36
    v_add_f32 v49, v40, v44
    v_add_f32 v50, v34, v38
    v_add_f32 v48, v48, v49
    v_add_f32 v51, v42, v46
    v_add_f32 v48, v48, v50
    v_add_f32 v48, v48, v51
    v_rcp_f32 v48, v48
    s_nop 0
    v_mul_f32 v48, v48, v244
    v_mul_f32 v32, v48, v32
    v_mul_f32 v34, v48, v34
    v_mul_f32 v40, v48, v40
    v_mul_f32 v42, v48, v42
    v_mul_f32 v36, v48, v36
    v_mul_f32 v38, v48, v38
    v_mul_f32 v44, v48, v44
    v_mul_f32 v46, v48, v46
    v_cvt_pk_bf16_f32 v52, v32, v34
    v_cvt_pk_bf16_f32 v54, v40, v42
    v_cvt_pk_bf16_f32 v53, v36, v38
    v_cvt_pk_bf16_f32 v55, v44, v46
    v_permlane32_swap_b32 v52, v54
    s_nop 0
    v_permlane32_swap_b32 v53, v55
    s_nop 1
    v_permlane16_swap_b32 v52, v53
    v_permlane16_swap_b32 v54, v55
    v_perm_b32 v32, v52, v52, v28
    v_perm_b32 v33, v52, v52, v29
    v_perm_b32 v34, v52, v52, v30
    v_perm_b32 v35, v52, v52, v31
    v_perm_b32 v36, v53, v53, v28
    v_perm_b32 v37, v53, v53, v29
    v_perm_b32 v38, v53, v53, v30
    v_perm_b32 v39, v53, v53, v31
    v_perm_b32 v40, v54, v54, v28
    v_perm_b32 v41, v54, v54, v29
    v_perm_b32 v42, v54, v54, v30
    v_perm_b32 v43, v54, v54, v31
    v_perm_b32 v44, v55, v55, v28
    v_perm_b32 v45, v55, v55, v29
    v_perm_b32 v46, v55, v55, v30
    v_perm_b32 v47, v55, v55, v31
    s_waitcnt lgkmcnt(4)
    v_mfma_f32_16x16x32_bf16 v[104:107], v[188:191], v[32:35], 0
    s_waitcnt lgkmcnt(3)
    v_mfma_f32_16x16x32_bf16 v[108:111], v[200:203], v[36:39], 0
    s_waitcnt lgkmcnt(2)
    v_mfma_f32_16x16x32_bf16 v[112:115], v[212:215], v[40:43], 0
    s_waitcnt lgkmcnt(1)
    v_mfma_f32_16x16x32_bf16 v[116:119], v[224:227], v[44:47], 0
    s_waitcnt lgkmcnt(0)
    v_mfma_f32_16x16x32_bf16 v[120:123], v[236:239], v[32:35], 0
    v_mfma_f32_16x16x32_bf16 v[184:187], v[236:239], v[36:39], 0
    v_mfma_f32_16x16x32_bf16 v[196:199], v[236:239], v[40:43], 0
    v_mfma_f32_16x16x32_bf16 v[208:211], v[236:239], v[44:47], 0
    v_cvt_pk_bf16_f32 v56, v104, v105
    v_cvt_pk_bf16_f32 v57, v106, v107
    v_cvt_pk_bf16_f32 v58, v108, v109
    v_cvt_pk_bf16_f32 v59, v110, v111
    s_add_u32 s60, s92, s96
    buffer_store_dwordx4 v[56:59], v2, s[16:19], s60 offen sc1
    v_cvt_pk_bf16_f32 v60, v112, v113
    v_cvt_pk_bf16_f32 v61, v114, v115
    v_cvt_pk_bf16_f32 v62, v116, v117
    v_cvt_pk_bf16_f32 v63, v118, v119
    s_add_u32 s60, s93, s96
    buffer_store_dwordx4 v[60:63], v2, s[16:19], s60 offen sc1
    v_cvt_pk_bf16_f32 v48, v120, v121
    v_cvt_pk_bf16_f32 v49, v122, v123
    v_cvt_pk_bf16_f32 v50, v184, v185
    v_cvt_pk_bf16_f32 v51, v186, v187
    v_cvt_pk_bf16_f32 v52, v196, v197
    v_cvt_pk_bf16_f32 v53, v198, v199
    v_cvt_pk_bf16_f32 v54, v208, v209
    v_cvt_pk_bf16_f32 v55, v210, v211
    v_cndmask_b32 v48, v48, v50, s[82:83]
    v_cndmask_b32 v49, v49, v51, s[82:83]
    v_cndmask_b32 v48, v48, v52, s[84:85]
    v_cndmask_b32 v49, v49, v53, s[84:85]
    v_cndmask_b32 v48, v48, v54, s[86:87]
    v_cndmask_b32 v49, v49, v55, s[86:87]
    s_add_u32 s60, s91, s96
    buffer_store_dwordx2 v[48:49], v7, s[16:19], s60 offen sc1
    v_mov_b32 v24, 1
    s_waitcnt vmcnt(0)
    buffer_store_dword v24, v21, s[16:19], 0 offen sc1
    s_endpgm
L_P:
    s_mov_b32 s46, 2211840
    s_mov_b32 s47, 0x20000
    s_mov_b32 s14, 2457600
    s_mov_b32 s15, 0x20000
    s_lshl_b32 s60, s60, 1
    s_sub_u32 s61, s51, 30
    s_add_u32 s60, s60, s61
    s_lshl_b32 s60, s60, 2
    s_add_u32 s60, s60, s48
    s_mul_i32 s62, s60, 40960
    s_add_u32 s62, s62, 128
    v_lshrrev_b32 v24, 1, v1
    v_and_b32 v25, 0, v1
    v_mul_u32_u24 v24, 1280, v24
    v_lshl_add_u32 v24, v25, 7, v24
    s_lshl_b32 s63, s60, 13
    s_add_u32 s63, s63, 110592
    v_lshlrev_b32 v25, 7, v1
    s_waitcnt lgkmcnt(0)
    buffer_load_dword v253, v25, s[44:47], s63 offen
    buffer_load_dword v253, v24, s[8:11], s62 offen
    s_lshl_b32 s61, s61, 2
    s_add_u32 s61, s61, s48
    s_mul_i32 s61, s61, 26880
    s_and_b32 s62, s2, 3
    s_mul_i32 s62, s62, 320
    s_and_b32 s62, s62, 0xffffff80
    s_add_u32 s61, s61, s62
    s_add_u32 s61, s61, 122880
    v_min_u32 v24, 62, v1
    v_mul_u32_u24 v25, 57, v24
    v_lshrrev_b32 v25, 9, v25
    v_mad_i32_i24 v24, v25, -9, v24
    v_mul_u32_u24 v25, 3840, v25
    v_mul_u32_u24 v26, 11, v24
    v_lshrrev_b32 v26, 5, v26
    v_mul_u32_u24 v26, 896, v26
    v_lshl_add_u32 v24, v24, 7, v26
    v_add_u32 v24, v24, v25
    s_mul_i32 s66, s48, 4224
    v_mov_b32 v251, 2146435072
    s_mov_b32 s18, 268435456
    s_mov_b32 s19, 0x20000
    s_mov_b32 s42, 256
    s_mov_b32 s43, 0x20000
    s_mov_b32 s22, 2211840
    s_mov_b32 s23, 0x20000
    s_mov_b32 s26, 819200
    s_mov_b32 s27, 0x20000
    s_mov_b32 s30, 2621440
    s_mov_b32 s31, 0x20000
    s_mov_b32 s38, 7077888
    s_mov_b32 s39, 0x20000
    s_mov_b32 s36, s16
    s_mov_b32 s37, s17
    buffer_load_dword v253, v24, s[12:15], s61 offen
    s_add_u32 s61, s61, 215040
    buffer_load_dword v253, v24, s[12:15], s61 offen
    s_add_u32 s61, s61, 215040
    s_waitcnt vmcnt(1)
    buffer_load_dword v253, v24, s[12:15], s61 offen
    s_add_u32 s61, s61, 215040
    s_waitcnt vmcnt(1)
    buffer_load_dword v253, v24, s[12:15], s61 offen
    s_add_u32 s61, s61, 215040
    s_waitcnt vmcnt(1)
    buffer_load_dword v253, v24, s[12:15], s61 offen
    s_add_u32 s61, s61, 215040
    s_waitcnt vmcnt(1)
    buffer_load_dword v253, v24, s[12:15], s61 offen
    s_add_u32 s61, s61, 215040
    s_waitcnt vmcnt(1)
    buffer_load_dword v253, v24, s[12:15], s61 offen
    s_add_u32 s61, s61, 215040
    s_waitcnt vmcnt(1)
    buffer_load_dword v253, v24, s[12:15], s61 offen
    s_add_u32 s61, s61, 215040
    s_waitcnt vmcnt(1)
    buffer_load_dword v253, v24, s[12:15], s61 offen
    s_add_u32 s61, s61, 215040
    s_waitcnt vmcnt(1)
    buffer_load_dword v253, v24, s[12:15], s61 offen
    s_add_u32 s61, s61, 215040
    s_waitcnt vmcnt(1)
    buffer_load_dword v253, v24, s[12:15], s61 offen
    s_add_u32 s61, s61, 215040
    s_waitcnt vmcnt(1)
    s_sub_u32 s61, s51, 12
    s_mul_i32 s62, s61, 13
    s_lshr_b32 s62, s62, 6
    s_mul_i32 s63, s62, 5
    s_sub_u32 s65, s61, s63
    s_bitcmp1_b32 s2, 0
    s_cselect_b32 s63, 5, 0
    s_add_u32 s65, s65, s63
    s_bfe_u32 s60, s2, 0x20001
    s_lshl_b32 s60, s60, 2
    s_add_u32 s60, s60, s62
    s_lshl_b32 s64, s60, 3
    s_lshl_b32 s60, s65, 7
    v_lshrrev_b32 v24, 3, v1
    v_and_b32 v25, 7, v1
    v_lshrrev_b32 v26, 4, v1
    v_lshlrev_b32 v27, 1, v26
    v_xor_b32 v25, v25, v27
    v_lshl_add_u32 v25, v25, 4, s60
    v_mul_u32_u24 v27, 1280, v24
    v_add_u32 v240, v27, v25
    v_add_u32 v241, 9216, v240
    v_add_u32 v242, 18432, v240
    v_add_u32 v243, 27648, v240
    v_lshrrev_b32 v27, 2, v24
    v_mul_u32_u24 v27, 20480, v27
    v_add_u32 v244, v27, v240
    v_lshrrev_b32 v24, 2, v1
    v_lshrrev_b32 v25, 1, v24
    v_and_b32 v25, 3, v25
    v_and_b32 v26, 3, v1
    v_lshlrev_b32 v26, 3, v26
    v_lshl_add_u32 v26, v24, 7, v26
    v_add_u32 v26, s66, v26
    v_xor_b32 v27, 0, v25
    v_lshl_add_u32 v245, v27, 5, v26
    v_xor_b32 v27, 1, v25
    v_lshl_add_u32 v246, v27, 5, v26
    v_xor_b32 v27, 2, v25
    v_lshl_add_u32 v247, v27, 5, v26
    v_xor_b32 v27, 3, v25
    v_lshl_add_u32 v248, v27, 5, v26
    s_and_b32 s60, s51, 1
    s_lshl_b32 s61, s48, 1
    s_add_u32 s61, s61, s60
    s_mul_i32 s67, s61, 286720
    s_mul_i32 s68, s61, 917504
    s_mul_i32 s88, s60, -573440
    s_add_u32 s88, s88, 40960
    s_mul_i32 s89, s60, -1835008
    s_add_u32 s89, s89, 131072
    s_mul_i32 s69, s48, 204800
    s_mul_i32 s70, s48, 655360
    s_add_u32 s70, s70, 7077888
    s_add_u32 s71, s70, 131072
    s_add_u32 s72, s70, 262144
    s_add_u32 s73, s70, 393216
    s_add_u32 s74, s70, 524288
    s_lshr_b32 s60, s64, 3
    s_mul_i32 s60, s60, 1152
    s_add_u32 s60, s60, 9977856
    v_lshrrev_b32 v24, 2, v1
    v_min_u32 v24, 8, v24
    v_and_b32 v25, 3, v1
    v_lshlrev_b32 v25, 2, v25
    v_lshl_add_u32 v24, v24, 7, v25
    v_add_u32 v249, s60, v24
    s_mul_i32 s60, s64, 187
    s_lshr_b32 s60, s60, 11
    s_add_u32 s61, s64, 7
    s_mul_i32 s61, s61, 187
    s_lshr_b32 s61, s61, 11
    s_sub_u32 s61, s61, s60
    v_bfe_u32 v24, v1, 3, 1
    v_mul_u32_u24 v24, s61, v24
    v_add_u32 v24, s60, v24
    v_bfe_u32 v26, v1, 2, 1
    v_lshl_add_u32 v24, v24, 3, v26
    s_lshl_b32 s60, s48, 8
    s_add_u32 s60, s60, 9961472
    v_add_u32 v25, s60, v25
    v_lshl_add_u32 v250, v24, 7, v25
    v_and_b32 v26, 15, v1
    v_lshlrev_b32 v26, 4, v26
    s_add_u32 m0, s66, 0
    s_nop 0
    buffer_load_dwordx4 v240, s[20:23], s67 offen offset:0 lds
    buffer_load_dwordx4 v241, s[20:23], s67 offen offset:1024 lds
    buffer_load_dwordx4 v242, s[20:23], s67 offen offset:2048 lds
    buffer_load_dwordx4 v243, s[20:23], s67 offen offset:3072 lds
    s_add_u32 m0, s66, 16896
    s_add_u32 s67, s67, 40960
    buffer_load_dwordx4 v240, s[20:23], s67 offen offset:0 lds
    buffer_load_dwordx4 v241, s[20:23], s67 offen offset:1024 lds
    buffer_load_dwordx4 v242, s[20:23], s67 offen offset:2048 lds
    buffer_load_dwordx4 v243, s[20:23], s67 offen offset:3072 lds
    s_add_u32 m0, s66, 33792
    s_add_u32 s67, s67, 40960
    buffer_load_dwordx4 v240, s[20:23], s67 offen offset:0 lds
    buffer_load_dwordx4 v241, s[20:23], s67 offen offset:1024 lds
    buffer_load_dwordx4 v242, s[20:23], s67 offen offset:2048 lds
    buffer_load_dwordx4 v243, s[20:23], s67 offen offset:3072 lds
    s_add_u32 m0, s66, 50688
    s_add_u32 s67, s67, 40960
    buffer_load_dwordx4 v240, s[20:23], s67 offen offset:0 lds
    buffer_load_dwordx4 v241, s[20:23], s67 offen offset:1024 lds
    buffer_load_dwordx4 v242, s[20:23], s67 offen offset:2048 lds
    buffer_load_dwordx4 v243, s[20:23], s67 offen offset:3072 lds
    buffer_load_dword v252, v26, s[40:43], 0 offen sc1
    s_waitcnt vmcnt(0)
    v_cmp_gt_u32 vcc, 15, v252
    s_nop 0
    s_cbranch_vccz P_poll1_ok
    s_mov_b32 s3, 0
P_poll1_spin:
    s_add_u32 s3, s3, 1
    s_cmp_gt_u32 s3, 0x8000
    s_cbranch_scc1 P_poll1_ok
    s_sleep 32
    buffer_load_dword v252, v26, s[40:43], 0 offen sc1
    s_waitcnt vmcnt(0)
    v_cmp_gt_u32 vcc, 15, v252
    s_nop 0
    s_cbranch_vccnz P_poll1_spin
P_poll1_ok:
    s_branch L_post
L_done:
    s_endpgm
.fill ((65536 + 512 - (. - gated_mix__sliding_local_dilated__dense_activation_relu__prompt_kernel)) / 4), 4, 0xbf810000
.section .rodata,"a"
.p2align 6
.amdhsa_kernel gated_mix__sliding_local_dilated__dense_activation_relu__prompt_kernel
  .amdhsa_next_free_vgpr 512
  .amdhsa_next_free_sgpr 102
  .amdhsa_accum_offset 256
  .amdhsa_group_segment_fixed_size 0
  .amdhsa_kernarg_size 80
  .amdhsa_user_sgpr_count 2
  .amdhsa_user_sgpr_kernarg_segment_ptr 1
  .amdhsa_system_sgpr_workgroup_id_x 1
.end_amdhsa_kernel
.text
```
